```python
import torch

def _softmax(x, axis=-1):
    return torch.softmax(x, dim=axis)
def _gelu(x):
    return torch.nn.functional.gelu(x, approximate="tanh")
def _silu(x):
    return torch.nn.functional.silu(x)
def _sigmoid(x):
    return torch.sigmoid(x)
def _layernorm(x, axis=-1, eps=1e-5):
    m = x.mean(dim=axis, keepdim=True)
    v = x.var(dim=axis, keepdim=True, unbiased=False)
    return (x - m) / torch.sqrt(v + eps)
def _scatter_add(tgt, idx, src, axis=0):
    return tgt.clone().index_add_(axis, idx, src)
def _segment_sum(src, seg, n):
    out = torch.zeros((n,) + src.shape[1:], dtype=src.dtype)
    return out.index_add_(0, seg, src)
def _pad(x, pw):
    flat = tuple(v for pair in reversed(pw) for v in pair)
    return torch.nn.functional.pad(x, flat)

kernel_name = 'gated_mix__sliding_block__linear_kernel_hedgehog__prompt'

def setup_inputs():

    _w = (lambda a: (lambda t: t.to(torch.bfloat16) if t.is_floating_point() else t)(torch.as_tensor(a)))
    def _A_setup():
        B, S, D = 1, 2048, 576
        return {
            "x": _w((lambda *s: torch.randn(*s, dtype=torch.bfloat16) * 0.05)(B, S, D)),
            "wqkv": _w((lambda *s: torch.randn(*s, dtype=torch.bfloat16) * 0.8)(D, 3 * D)),
            "wo": _w((lambda *s: torch.randn(*s, dtype=torch.bfloat16) * 0.05)(D, D)),
        }
    _A_in = _A_setup()

    def _B_setup():
        B, S, D, H = 1, 2048, 576, 32
        Dh = D // H
        return {
            "x": _w((lambda *s: torch.randn(*s, dtype=torch.bfloat16) * 0.05)(B, S, D)),
            "wqkv": _w((lambda *s: torch.randn(*s, dtype=torch.bfloat16) * 1.6)(D, 3 * D)),
            "w_phi": _w((lambda *s: torch.randn(*s, dtype=torch.bfloat16) * 1.6)(H, Dh, Dh) * (Dh ** -0.5)),
            "wo": _w((lambda *s: torch.randn(*s, dtype=torch.bfloat16) * 0.1)(D, D)),
        }
    _B_in = _B_setup()

    return {
        "A_x": _A_in["x"],
        "A_wqkv": _A_in["wqkv"],
        "A_wo": _A_in["wo"],
        "B_x": _B_in["x"],
        "B_wqkv": _B_in["wqkv"],
        "B_w_phi": _B_in["w_phi"],
        "B_wo": _B_in["wo"],
        "gate_w": _w((lambda *s: torch.randn(*s, dtype=torch.bfloat16) * 0.05)(576) * 16.0),
    }

def reference(A_x, A_wqkv, A_wo, B_x, B_wqkv, B_w_phi, B_wo, gate_w):
    def _A_ref(x, wqkv, wo):
        B, S, D = x.shape
        H = 32; Dh = D // H; W = 256
        qkv = (lambda x, *d: x.permute(*d))((x @ wqkv).reshape(B, S, 3, H, Dh), 2, 0, 3, 1, 4)
        q, k, v = qkv[0], qkv[1], qkv[2]
        scores = torch.einsum("bhqd,bhkd->bhqk", q, k) * (Dh ** -0.5)
        idx = torch.arange(S)
        mask = (idx[:, None] - idx[None, :] >= 0) & (idx[:, None] - idx[None, :] < W)
        scores = torch.where(mask[None, None], scores, -1e9)
        p = _softmax(scores, axis=-1)
        o = torch.einsum("bhqk,bhkd->bhqd", p, v)
        return (lambda x, *d: x.permute(*d))(o, 0, 2, 1, 3).reshape(B, S, D) @ wo

    def _B_ref(x, wqkv, w_phi, wo):
        B, S, D = x.shape
        H = 32; Dh = D // H
        qkv = (lambda x, *d: x.permute(*d))((x @ wqkv).reshape(B, S, 3, H, Dh), 2, 0, 3, 1, 4)
        q, k, v = qkv[0], qkv[1], qkv[2]
        pq = torch.einsum("bhsd,hdf->bhsf", q, w_phi)
        pk = torch.einsum("bhsd,hdf->bhsf", k, w_phi)
        phi_q = torch.concatenate([_softmax(pq, axis=-1), _softmax(-pq, axis=-1)], axis=-1)
        phi_k = torch.concatenate([_softmax(pk, axis=-1), _softmax(-pk, axis=-1)], axis=-1)
        kv = torch.einsum("bhsf,bhsd->bhfd", phi_k, v)
        z  = torch.einsum("bhsf->bhf", phi_k)
        num = torch.einsum("bhqf,bhfd->bhqd", phi_q, kv)
        den = torch.einsum("bhqf,bhf->bhq", phi_q, z)[..., None] + 1e-6
        o = num / den
        return (lambda x, *d: x.permute(*d))(o, 0, 2, 1, 3).reshape(B, S, D) @ wo

    x = A_x
    g = _sigmoid((x * gate_w).sum(-1, keepdims=True))
    a = _A_ref(x, A_wqkv, A_wo)
    b = _B_ref(x, B_wqkv, B_w_phi, B_wo)
    return g * a + (1 - g) * b
```

```asm
; @launch grid=(256,1,1) block=(512,1,1) lds=163840
.amdgcn_target "amdgcn-amd-amdhsa--gfx950"
.text
.globl gated_mix__sliding_block__linear_kernel_hedgehog__prompt_kernel
.p2align 8
.type gated_mix__sliding_block__linear_kernel_hedgehog__prompt_kernel,@function
gated_mix__sliding_block__linear_kernel_hedgehog__prompt_kernel:
L12_first:
    s_cmp_ge_u32 s2, 256
    s_cbranch_scc1 L12_end
    s_load_dwordx4 s[44:47], s[0:1], 0
    s_load_dwordx4 s[48:51], s[0:1], 32
    s_load_dwordx2 s[52:53], s[0:1], 56
    s_load_dwordx4 s[56:59], s[0:1], 72
    s_load_dwordx2 s[4:5], s[0:1], 16
    s_load_dwordx2 s[6:7], s[0:1], 48
    s_load_dwordx2 s[54:55], s[0:1], 64
    v_lshrrev_b32 v1, 6, v0
    v_and_b32 v255, 63, v0
    v_readfirstlane_b32 s28, v1
    s_getpc_b64 s[60:61]
L12_pc:
    s_sub_u32 s60, s60, L12_pc-L12_first
    s_subb_u32 s61, s61, 0
    s_mov_b32 s62, L12_last-L12_first
    s_mov_b32 s63, 0x20000
    s_lshr_b32 s3, s2, 3
    s_lshl_b32 s3, s3, 11
    v_lshlrev_b32 v2, 7, v0
    v_cmp_gt_u32 vcc, 16, v0
    s_nop 0
    s_and_saveexec_b64 s[64:65], vcc
    s_cbranch_execz L12_nopfc
    buffer_load_dword v254, v2, s[60:63], s3 offen
L12_nopfc:
    s_mov_b64 exec, -1
    s_cmp_lt_u32 s28, 4
    s_cbranch_scc1 L12_compute
    s_branch L12_loader
L12_compute:
    v_lshlrev_b32 v239, 4, v255
    v_lshlrev_b32 v248, 4, v255
    s_and_b32 s30, s2, 7
    s_lshr_b32 s31, s2, 3
    s_bfe_u32 s26, s31, 0x10003
    s_and_b32 s24, s31, 7
    s_lshr_b32 s32, s31, 4
    s_lshl_b32 s32, s32, 3
    s_add_u32 s24, s24, s32
    s_mov_b32 s27, s30
    s_lshl_b32 s25, s26, 3
    s_add_u32 s25, s25, s27
    s_and_b32 s29, s28, 3
    s_waitcnt lgkmcnt(0)
    s_and_b32 s30, s2, 7
    s_lshr_b32 s31, s2, 3
    s_and_b32 s32, s31, 7
    s_lshr_b32 s33, s31, 4
    s_lshl_b32 s33, s33, 3
    s_add_u32 s32, s32, s33
    s_lshl_b32 s33, s30, 4
    s_add_u32 s33, s33, s32
    s_mul_i32 s34, s30, 12
    s_min_u32 s35, s30, 3
    s_add_u32 s34, s34, s35
    s_add_u32 s34, s34, s32
    s_cmp_lt_u32 s30, 3
    s_cselect_b32 s35, 13, 12
    s_cmp_lt_u32 s32, s35
    s_cselect_b32 s43, 1, 0
    s_cmp_lt_u32 s33, 126
    s_cselect_b32 s35, 1, 0
    s_cmp_eq_u32 s26, 0
    s_cselect_b32 s85, s34, s33
    s_cselect_b32 s43, s43, s35
    s_cselect_b32 s33, 64, 96
    s_cselect_b32 s34, 1344, 0
    s_mul_i32 s32, s85, 7282
    s_lshr_b32 s32, s32, 16
    s_mul_i32 s35, s32, 9
    s_sub_u32 s85, s85, s35
    s_mul_i32 s84, s32, s33
    s_add_u32 s84, s84, s34
    v_mov_b32 v241, 0
    v_mov_b32 v242, 0
    v_mov_b32 v243, 0
    v_mov_b32 v244, 0
    v_mov_b32 v245, 0
    v_mov_b32 v246, 0
    v_mov_b32 v247, 0
    v_mov_b32 v249, 0
    v_mov_b32 v250, 0
    v_mov_b32 v251, 0
    v_mov_b32 v252, 0
    s_mov_b32 s40, 0
    s_mov_b32 s41, -1
    s_mov_b32 s16, s58
    s_mov_b32 s17, s59
    s_mov_b32 s18, 268435456
    s_mov_b32 s19, 0x20000
    s_mov_b32 s44, s58
    s_mov_b32 s45, s59
    s_mov_b32 s46, 0
    s_mov_b32 s47, 0x20000
    s_mov_b32 s20, s52
    s_mov_b32 s21, s53
    s_mov_b32 s22, 1152
    s_mov_b32 s23, 0x20000
    s_mov_b32 s8, s6
    s_mov_b32 s9, s7
    s_mov_b32 s10, 663552
    s_mov_b32 s11, 0x20000
    s_cmp_eq_u32 s26, 0
    s_cbranch_scc1 L12_nophi
    s_mov_b32 s20, s50
    s_mov_b32 s21, s51
    s_mov_b32 s22, 20736
    s_mov_b32 s23, 0x20000
    s_mul_i32 s31, s27, 2592
    s_lshl_b32 s30, s29, 8
    s_add_u32 s30, s30, 0
    v_add_u32 v1, s30, v255
    v_mul_u32_u24 v2, 1093, v1
    v_lshrrev_b32 v2, 18, v2
    v_mul_u32_u24 v3, 240, v2
    v_sub_u32 v3, v1, v3
    v_mul_u32_u24 v4, 205, v3
    v_lshrrev_b32 v4, 11, v4
    v_mul_u32_u24 v5, 10, v4
    v_sub_u32 v5, v3, v5
    v_cmp_gt_u32 vcc, 18, v4
    v_cmp_gt_u32 s[32:33], 9, v5
    s_nop 0
    s_and_b64 vcc, vcc, s[32:33]
    v_cmp_gt_u32 s[32:33], 4, v2
    s_nop 0
    s_and_b64 vcc, vcc, s[32:33]
    v_mul_u32_u24 v2, 648, v2
    v_mul_u32_u24 v4, 36, v4
    v_lshl_add_u32 v4, v5, 2, v4
    v_add3_u32 v2, v2, v4, s31
    v_mov_b32 v3, 0x7ffffff0
    v_cndmask_b32 v2, v3, v2, vcc
    s_lshl_b32 s30, s30, 2
    s_add_u32 m0, s30, 151552
    s_nop 0
    buffer_load_dword v2, s[20:23], 0 offen lds
    s_lshl_b32 s30, s29, 8
    s_add_u32 s30, s30, 64
    v_add_u32 v1, s30, v255
    v_mul_u32_u24 v2, 1093, v1
    v_lshrrev_b32 v2, 18, v2
    v_mul_u32_u24 v3, 240, v2
    v_sub_u32 v3, v1, v3
    v_mul_u32_u24 v4, 205, v3
    v_lshrrev_b32 v4, 11, v4
    v_mul_u32_u24 v5, 10, v4
    v_sub_u32 v5, v3, v5
    v_cmp_gt_u32 vcc, 18, v4
    v_cmp_gt_u32 s[32:33], 9, v5
    s_nop 0
    s_and_b64 vcc, vcc, s[32:33]
    v_cmp_gt_u32 s[32:33], 4, v2
    s_nop 0
    s_and_b64 vcc, vcc, s[32:33]
    v_mul_u32_u24 v2, 648, v2
    v_mul_u32_u24 v4, 36, v4
    v_lshl_add_u32 v4, v5, 2, v4
    v_add3_u32 v2, v2, v4, s31
    v_mov_b32 v3, 0x7ffffff0
    v_cndmask_b32 v2, v3, v2, vcc
    s_lshl_b32 s30, s30, 2
    s_add_u32 m0, s30, 151552
    s_nop 0
    buffer_load_dword v2, s[20:23], 0 offen lds
    s_lshl_b32 s30, s29, 8
    s_add_u32 s30, s30, 128
    v_add_u32 v1, s30, v255
    v_mul_u32_u24 v2, 1093, v1
    v_lshrrev_b32 v2, 18, v2
    v_mul_u32_u24 v3, 240, v2
    v_sub_u32 v3, v1, v3
    v_mul_u32_u24 v4, 205, v3
    v_lshrrev_b32 v4, 11, v4
    v_mul_u32_u24 v5, 10, v4
    v_sub_u32 v5, v3, v5
    v_cmp_gt_u32 vcc, 18, v4
    v_cmp_gt_u32 s[32:33], 9, v5
    s_nop 0
    s_and_b64 vcc, vcc, s[32:33]
    v_cmp_gt_u32 s[32:33], 4, v2
    s_nop 0
    s_and_b64 vcc, vcc, s[32:33]
    v_mul_u32_u24 v2, 648, v2
    v_mul_u32_u24 v4, 36, v4
    v_lshl_add_u32 v4, v5, 2, v4
    v_add3_u32 v2, v2, v4, s31
    v_mov_b32 v3, 0x7ffffff0
    v_cndmask_b32 v2, v3, v2, vcc
    s_lshl_b32 s30, s30, 2
    s_add_u32 m0, s30, 151552
    s_nop 0
    buffer_load_dword v2, s[20:23], 0 offen lds
    s_lshl_b32 s30, s29, 8
    s_add_u32 s30, s30, 192
    v_add_u32 v1, s30, v255
    v_mul_u32_u24 v2, 1093, v1
    v_lshrrev_b32 v2, 18, v2
    v_mul_u32_u24 v3, 240, v2
    v_sub_u32 v3, v1, v3
    v_mul_u32_u24 v4, 205, v3
    v_lshrrev_b32 v4, 11, v4
    v_mul_u32_u24 v5, 10, v4
    v_sub_u32 v5, v3, v5
    v_cmp_gt_u32 vcc, 18, v4
    v_cmp_gt_u32 s[32:33], 9, v5
    s_nop 0
    s_and_b64 vcc, vcc, s[32:33]
    v_cmp_gt_u32 s[32:33], 4, v2
    s_nop 0
    s_and_b64 vcc, vcc, s[32:33]
    v_mul_u32_u24 v2, 648, v2
    v_mul_u32_u24 v4, 36, v4
    v_lshl_add_u32 v4, v5, 2, v4
    v_add3_u32 v2, v2, v4, s31
    v_mov_b32 v3, 0x7ffffff0
    v_cndmask_b32 v2, v3, v2, vcc
    s_lshl_b32 s30, s30, 2
    s_add_u32 m0, s30, 151552
    s_nop 0
    buffer_load_dword v2, s[20:23], 0 offen lds
    v_mov_b32 v2, 0
    v_mov_b32 v3, 0
    v_lshlrev_b32 v1, 3, v255
    s_mul_i32 s30, s29, 448
    s_add_u32 s30, s30, 148544
    v_add_u32 v1, s30, v1
    s_mov_b32 exec_hi, 0xffffff
    ds_write_b64 v1, v[2:3]
    s_mov_b64 exec, -1
L12_nophi:
    s_lshl_b32 s79, s26, 2
    s_add_u32 s79, s79, s28
    s_lshl_b32 s79, s79, 2
    s_sub_u32 s79, s79, 1
    s_mov_b64 exec, 0
L_dry_ret:
    s_add_u32 s79, s79, 1
    s_cmp_eq_u32 s79, 0
    s_cbranch_scc1 L_dry_Ae1
    s_cmp_eq_u32 s79, 4
    s_cbranch_scc1 L_dry_Ae2
    s_cmp_eq_u32 s79, 8
    s_cbranch_scc1 L_dry_PA0
    s_cmp_eq_u32 s79, 12
    s_cbranch_scc1 L_dry_PA1
    s_cmp_eq_u32 s79, 16
    s_cbranch_scc1 L_dry_Bk
    s_cmp_eq_u32 s79, 20
    s_cbranch_scc1 L_dry_Bo
    s_cmp_eq_u32 s79, 24
    s_cbranch_scc1 L_dry_PB0
    s_cmp_eq_u32 s79, 28
    s_cbranch_scc1 L_dry_PB1
    s_mov_b64 exec, -1
    s_waitcnt lgkmcnt(0)
    s_nop 15
    v_lshlrev_b32 v239, 4, v255
    v_mov_b32 v189, 0
    s_cmp_lg_u32 s26, 0
    s_cbranch_scc1 L12_setupB
    s_mov_b32 s36, s29
    s_cmp_lt_u32 s28, 4
    s_cselect_b32 s37, 2, 0
    s_add_u32 s38, s37, 1
    v_and_b32 v1, 31, v255
    v_lshrrev_b32 v2, 5, v255
    v_lshlrev_b32 v240, 4, v2
    v_and_b32 v3, 16, v255
    v_and_b32 v4, 3, v255
    v_lshl_add_u32 v3, v4, 2, v3
    v_bfe_u32 v5, v255, 2, 2
    v_add_u32 v3, v3, v5
    v_lshlrev_b32 v3, 4, v3
    v_add_u32 v3, 12320, v3
    v_lshl_add_u32 v5, v5, 2, v2
    v_lshlrev_b32 v5, 4, v5
    v_lshrrev_b32 v6, 1, v4
    v_mul_u32_u24 v6, 6160, v6
    v_and_b32 v4, 1, v4
    v_lshl_add_u32 v4, v4, 3, v6
    v_and_b32 v6, 16, v255
    v_cmp_ne_u32 vcc, 0, v6
    v_mov_b32 v6, 12320
    s_nop 0
    v_cndmask_b32 v4, v4, v6, vcc
    v_add_u32 v5, v5, v4
    s_mul_i32 s30, s36, 30800
    s_lshl_b32 s31, s37, 9
    s_add_u32 s30, s30, s31
    v_add_u32 v223, s30, v3
    v_mul_u32_u24 v6, 6160, v2
    s_mov_b32 s31, 6160
    v_add3_u32 v222, v223, v6, s31
    v_add_u32 v224, s30, v5
    s_lshl_b32 s30, s37, 5
    v_add_u32 v6, s30, v1
    v_mul_u32_u24 v7, 144, v6
    s_mul_i32 s30, s36, 36
    s_add_u32 s30, s30, 123200
    s_and_b32 s31, s36, 1
    s_lshl_b32 s32, s31, 2
    s_add_u32 s32, s32, s30
    s_lshl_b32 s31, s31, 5
    s_sub_u32 s30, s30, s31
    v_add_u32 v226, s30, v7
    v_add_u32 v225, s32, v7
    v_lshl_add_u32 v225, v2, 3, v225
    v_mul_u32_u24 v7, 48, v6
    s_mul_i32 s30, s36, 6144
    s_add_u32 s30, s30, 123200
    v_add_u32 v227, s30, v7
    v_lshlrev_b32 v7, 2, v6
    v_add_u32 v228, 148032, v7
    s_lshl_b32 s30, s38, 5
    v_add_u32 v6, s30, v1
    v_mul_u32_u24 v7, 144, v6
    s_mul_i32 s30, s36, 36
    s_add_u32 s30, s30, 123200
    s_and_b32 s31, s36, 1
    s_lshl_b32 s32, s31, 2
    s_add_u32 s32, s32, s30
    s_lshl_b32 s31, s31, 5
    s_sub_u32 s30, s30, s31
    v_add_u32 v233, s30, v7
    v_add_u32 v232, s32, v7
    v_lshl_add_u32 v232, v2, 3, v232
    v_mul_u32_u24 v7, 48, v6
    s_mul_i32 s30, s36, 6144
    s_add_u32 s30, s30, 123200
    v_add_u32 v234, s30, v7
    v_lshlrev_b32 v7, 2, v6
    v_add_u32 v235, 148032, v7
    v_sub_u32 v3, v1, v2
    v_mov_b32 v4, 0xf149f2ca
    v_cmp_le_i32 vcc, 0, v3
    s_nop 1
    v_cndmask_b32 v190, v4, 0, vcc
    v_cndmask_b32 v206, 0, v4, vcc
    v_cmp_le_i32 vcc, 4, v3
    s_nop 1
    v_cndmask_b32 v191, v4, 0, vcc
    v_cndmask_b32 v207, 0, v4, vcc
    v_cmp_le_i32 vcc, 8, v3
    s_nop 1
    v_cndmask_b32 v192, v4, 0, vcc
    v_cndmask_b32 v208, 0, v4, vcc
    v_cmp_le_i32 vcc, 12, v3
    s_nop 1
    v_cndmask_b32 v193, v4, 0, vcc
    v_cndmask_b32 v209, 0, v4, vcc
    v_cmp_le_i32 vcc, 2, v3
    s_nop 1
    v_cndmask_b32 v194, v4, 0, vcc
    v_cndmask_b32 v210, 0, v4, vcc
    v_cmp_le_i32 vcc, 6, v3
    s_nop 1
    v_cndmask_b32 v195, v4, 0, vcc
    v_cndmask_b32 v211, 0, v4, vcc
    v_cmp_le_i32 vcc, 10, v3
    s_nop 1
    v_cndmask_b32 v196, v4, 0, vcc
    v_cndmask_b32 v212, 0, v4, vcc
    v_cmp_le_i32 vcc, 14, v3
    s_nop 1
    v_cndmask_b32 v197, v4, 0, vcc
    v_cndmask_b32 v213, 0, v4, vcc
    v_cmp_le_i32 vcc, 16, v3
    s_nop 1
    v_cndmask_b32 v198, v4, 0, vcc
    v_cndmask_b32 v214, 0, v4, vcc
    v_cmp_le_i32 vcc, 20, v3
    s_nop 1
    v_cndmask_b32 v199, v4, 0, vcc
    v_cndmask_b32 v215, 0, v4, vcc
    v_cmp_le_i32 vcc, 24, v3
    s_nop 1
    v_cndmask_b32 v200, v4, 0, vcc
    v_cndmask_b32 v216, 0, v4, vcc
    v_cmp_le_i32 vcc, 28, v3
    s_nop 1
    v_cndmask_b32 v201, v4, 0, vcc
    v_cndmask_b32 v217, 0, v4, vcc
    v_cmp_le_i32 vcc, 18, v3
    s_nop 1
    v_cndmask_b32 v202, v4, 0, vcc
    v_cndmask_b32 v218, 0, v4, vcc
    v_cmp_le_i32 vcc, 22, v3
    s_nop 1
    v_cndmask_b32 v203, v4, 0, vcc
    v_cndmask_b32 v219, 0, v4, vcc
    v_cmp_le_i32 vcc, 26, v3
    s_nop 1
    v_cndmask_b32 v204, v4, 0, vcc
    v_cndmask_b32 v220, 0, v4, vcc
    v_cmp_le_i32 vcc, 30, v3
    s_nop 1
    v_cndmask_b32 v205, v4, 0, vcc
    v_cndmask_b32 v221, 0, v4, vcc
    s_lshr_b32 s32, s28, 1
    s_and_b32 s33, s28, 1
    v_lshlrev_b32 v4, 4, v1
    v_mul_u32_u24 v5, 6160, v2
    s_mul_i32 s30, s33, 61600
    s_lshl_b32 s31, s32, 10
    s_add_u32 s30, s30, s31
    s_add_u32 s30, s30, 4096
    v_add3_u32 v236, v4, v5, s30
    s_add_u32 s30, s30, 12320
    v_add_u32 v188, s30, v248
    v_lshl_add_u32 v189, v2, 11, v4
    s_mul_i32 s30, s27, 655360
    s_mul_i32 s34, s24, 10240
    s_add_u32 s30, s30, s34
    s_mul_i32 s34, s33, 327680
    s_add_u32 s30, s30, s34
    s_add_u32 s30, s30, s31
    s_add_u32 s20, s58, s30
    s_addc_u32 s21, s59, 0
    s_mov_b32 s22, 174080
    s_mov_b32 s23, 0x20000
    s_mov_b32 s60, 0
    s_mov_b32 s61, 4096
    s_mov_b32 s62, 6144
    s_mov_b32 s63, 163840
    s_mov_b32 s64, 167936
    s_mov_b32 s65, 169984
    v_mul_u32_u24 v4, 48, v1
    s_mul_i32 s30, s33, 12288
    s_mul_i32 s31, s32, 3072
    s_add_u32 s30, s30, s31
    s_add_u32 s30, s30, 123200
    v_add3_u32 v237, v4, v240, s30
    v_mul_u32_u24 v4, 48, v255
    v_add_u32 v187, s30, v4
    s_lshl_b32 s31, s32, 8
    s_add_u32 s31, s31, 148032
    v_lshl_add_u32 v238, v255, 2, s31
    v_mov_b32 v4, 0x3eae1a93
    v_cmp_gt_u32 vcc, 16, v255
    s_nop 1
    v_cndmask_b32 v184, 1.0, v4, vcc
    v_lshrrev_b32 v1, 3, v255
    v_mul_u32_u24 v1, 1152, v1
    v_bfe_u32 v2, v255, 4, 1
    v_lshlrev_b32 v2, 2, v2
    v_xor_b32 v2, v2, v255
    v_and_b32 v2, 7, v2
    v_lshl_add_u32 v1, v2, 4, v1
    s_lshl_b32 s30, s85, 7
    s_mul_i32 s31, s29, 9216
    s_add_u32 s30, s30, s31
    v_add_u32 v241, s30, v1
    s_lshl_b32 s77, s29, 10
    s_mul_i32 s71, s29, 30800
    s_mov_b32 s80, 0x3eae1a93
    s_branch L12_setup_done
L12_setupB:
    s_mov_b32 s80, 0x3fb8aa3b
    s_mov_b32 s81, 0x3fb8aa3b
    s_mov_b32 s82, 0xbfb8aa3b
    s_mov_b32 s83, 0xbfb8aa3b
    v_lshrrev_b32 v1, 5, v255
    v_mov_b32 v8, 148544
    v_and_b32 v2, 1, v255
    v_bfe_u32 v3, v255, 4, 1
    v_bfe_u32 v4, v255, 1, 1
    v_lshl_add_u32 v3, v3, 1, v4
    v_bfe_u32 v4, v255, 2, 2
    v_mul_u32_u24 v4, 40, v4
    s_and_b32 s34, s28, 1
    s_mul_i32 s30, s34, 1920
    s_add_u32 s30, s30, 151552
    v_add_u32 v4, s30, v4
    v_cmp_eq_u32 s[32:33], v1, v2
    v_lshl_add_u32 v5, v3, 3, v4
    s_nop 0
    v_cndmask_b32 v242, v8, v5, s[32:33]
    v_cmp_eq_u32 vcc, 0, v3
    s_nop 0
    s_and_b64 vcc, vcc, s[32:33]
    v_add_u32 v5, 32, v4
    v_cndmask_b32 v243, v8, v5, vcc
    v_cmp_eq_u32 vcc, 1, v3
    s_nop 0
    s_and_b64 vcc, vcc, s[32:33]
    v_add_u32 v5, 992, v4
    v_cndmask_b32 v244, v8, v5, vcc
    v_bfe_u32 v2, v255, 2, 1
    v_bfe_u32 v3, v255, 3, 2
    v_and_b32 v4, 3, v255
    s_mul_i32 s30, s34, 3072
    s_add_u32 s30, s30, 141632
    v_mov_b32 v5, s30
    v_cmp_eq_u32 s[32:33], v1, v2
    v_lshl_add_u32 v6, v3, 2, v4
    v_mul_u32_u24 v6, 80, v6
    v_add_u32 v6, v6, v5
    v_cndmask_b32 v249, v8, v6, s[32:33]
    v_cmp_gt_u32 vcc, 3, v4
    s_nop 0
    s_and_b64 s[32:33], s[32:33], vcc
    v_mul_u32_u24 v6, 80, v4
    v_add_u32 v6, v6, v5
    v_cmp_eq_u32 vcc, 0, v3
    s_nop 0
    s_and_b64 vcc, vcc, s[32:33]
    v_add_u32 v7, 1280, v6
    v_cndmask_b32 v250, v8, v7, vcc
    v_cmp_eq_u32 vcc, 1, v3
    s_nop 0
    s_and_b64 vcc, vcc, s[32:33]
    v_add_u32 v7, 2816, v6
    v_cndmask_b32 v251, v8, v7, vcc
    s_lshr_b32 s30, s28, 1
    s_lshl_b32 s30, s30, 6
    v_add_u32 v2, s30, v255
    v_mul_u32_u24 v3, 112, v2
    s_mul_i32 s30, s34, 28672
    v_add_u32 v245, s30, v3
    v_mul_u32_u24 v3, 144, v2
    s_mul_i32 s30, s34, 72
    s_add_u32 s30, s30, 123200
    v_add_u32 v252, s30, v3
    v_lshrrev_b32 v2, 4, v255
    v_bfe_u32 v3, v255, 2, 2
    v_lshlrev_b32 v4, 3, v2
    v_lshl_add_u32 v4, v3, 1, v4
    v_mul_u32_u24 v4, 112, v4
    v_and_b32 v3, 3, v255
    v_lshl_add_u32 v4, v3, 3, v4
    s_mul_i32 s30, s28, 14336
    v_add_u32 v246, s30, v4
    v_and_b32 v3, 15, v255
    v_mul_u32_u24 v3, 80, v3
    v_lshl_add_u32 v3, v2, 3, v3
    s_mul_i32 s30, s28, 1536
    s_add_u32 s30, s30, 141632
    v_add_u32 v247, s30, v3
L12_setup_done:
    v_and_b32 v1, 15, v255
    v_lshrrev_b32 v2, 4, v255
    v_bfe_u32 v3, v255, 1, 3
    v_xor_b32 v3, v3, v2
    s_lshr_b32 s30, s28, 1
    s_lshl_b32 s30, s30, 13
    v_lshl_add_u32 v4, v1, 7, s30
    v_lshl_add_u32 v172, v3, 4, v4
    v_xor_b32 v3, 4, v3
    v_lshl_add_u32 v173, v3, 4, v4
    v_bfe_u32 v1, v255, 2, 2
    v_lshl_add_u32 v3, v2, 3, v1
    v_mul_u32_u24 v3, 448, v3
    v_add_u32 v3, 16384, v3
    v_and_b32 v2, 1, v2
    v_lshlrev_b32 v2, 5, v2
    v_and_b32 v4, 3, v255
    s_and_b32 s30, s28, 1
    s_mul_i32 s30, s30, 72
    v_lshl_add_u32 v5, v4, 3, v2
    v_add_u32 v5, s30, v5
    v_add_u32 v174, v5, v3
    v_add_u32 v5, 328, v5
    v_mul_u32_u24 v6, 144, v4
    v_add_u32 v6, v6, v2
    s_add_u32 s30, s30, 32
    v_add_u32 v7, s30, v6
    v_cmp_eq_u32 vcc, 3, v4
    s_nop 1
    v_cndmask_b32 v6, v7, v6, vcc
    v_subrev_u32 v7, 448, v5
    v_cmp_le_u32 vcc, 448, v5
    s_nop 1
    v_cndmask_b32 v5, v5, v7, vcc
    v_add_u32 v175, v5, v3
    v_subrev_u32 v7, 448, v6
    v_cmp_le_u32 vcc, 448, v6
    s_nop 1
    v_cndmask_b32 v6, v6, v7, vcc
    v_add_u32 v176, v6, v3
    s_mov_b32 s74, 0
    s_mov_b32 s75, 0
    s_mov_b32 s76, 0xfffea000
    s_waitcnt vmcnt(0) lgkmcnt(0)
    s_barrier
    ds_read_b128 v[140:143], v172 offset:0
    ds_read_b128 v[144:147], v172 offset:2048
    ds_read_b128 v[148:151], v172 offset:4096
    ds_read_b128 v[152:155], v172 offset:6144
    ds_read_b64_tr_b16 v[120:121], v174 offset:144
    ds_read_b64_tr_b16 v[122:123], v174 offset:1936
    ds_read_b64_tr_b16 v[124:125], v174 offset:184
    ds_read_b64_tr_b16 v[126:127], v174 offset:1976
    ds_read_b64_tr_b16 v[136:137], v176 offset:0
    ds_read_b64_tr_b16 v[138:139], v176 offset:1792
    ds_read_b64_tr_b16 v[128:129], v174 offset:288
    ds_read_b64_tr_b16 v[130:131], v174 offset:2080
    ds_read_b64_tr_b16 v[132:133], v175 offset:0
    ds_read_b64_tr_b16 v[134:135], v175 offset:1792
    ds_read_b64_tr_b16 v[112:113], v174 offset:0
    ds_read_b64_tr_b16 v[114:115], v174 offset:1792
    s_cmp_eq_u32 s26, 0
    s_cbranch_scc1 L12_kpre
    ds_read_b64_tr_b16 v[186:187], v242 offset:0
    ds_read_b64_tr_b16 v[188:189], v242 offset:160
    ds_read_b64_tr_b16 v[190:191], v242 offset:320
    ds_read_b64_tr_b16 v[192:193], v242 offset:480
    ds_read_b64_tr_b16 v[194:195], v242 offset:640
    ds_read_b64_tr_b16 v[196:197], v242 offset:800
    ds_read_b64_tr_b16 v[198:199], v242 offset:960
    ds_read_b64_tr_b16 v[200:201], v242 offset:1120
    ds_read_b64_tr_b16 v[202:203], v242 offset:1280
    ds_read_b64_tr_b16 v[204:205], v242 offset:1440
    ds_read_b64_tr_b16 v[206:207], v242 offset:1600
    ds_read_b64_tr_b16 v[208:209], v242 offset:1760
    ds_read_b64_tr_b16 v[210:211], v243 offset:0
    ds_read_b64_tr_b16 v[212:213], v243 offset:160
    ds_read_b64_tr_b16 v[214:215], v243 offset:320
    ds_read_b64_tr_b16 v[216:217], v243 offset:480
    ds_read_b64_tr_b16 v[218:219], v243 offset:640
    ds_read_b64_tr_b16 v[220:221], v243 offset:800
    ds_read_b64_tr_b16 v[222:223], v244 offset:0
    ds_read_b64_tr_b16 v[224:225], v244 offset:160
    ds_read_b64_tr_b16 v[226:227], v244 offset:320
    ds_read_b64_tr_b16 v[228:229], v244 offset:480
    ds_read_b64_tr_b16 v[230:231], v244 offset:640
    ds_read_b64_tr_b16 v[232:233], v244 offset:800
L12_kpre:
    s_waitcnt lgkmcnt(0)
    s_waitcnt lgkmcnt(10)
    v_mfma_f32_16x16x32_bf16 v[32:35], v[120:123], v[140:143], 0
    ds_read_b64_tr_b16 v[116:117], v174 offset:40
    v_mfma_f32_16x16x32_bf16 v[36:39], v[120:123], v[144:147], 0
    ds_read_b64_tr_b16 v[118:119], v174 offset:1832
    v_mfma_f32_16x16x32_bf16 v[40:43], v[120:123], v[148:151], 0
    ds_read_b128 v[156:159], v173 offset:0
    v_mfma_f32_16x16x32_bf16 v[44:47], v[120:123], v[152:155], 0
    s_waitcnt lgkmcnt(11)
    v_mfma_f32_16x16x32_bf16 v[48:51], v[124:127], v[140:143], 0
    ds_read_b64_tr_b16 v[120:121], v174 offset:14480
    v_mfma_f32_16x16x32_bf16 v[52:55], v[124:127], v[144:147], 0
    ds_read_b64_tr_b16 v[122:123], v174 offset:16272
    v_mfma_f32_16x16x32_bf16 v[56:59], v[124:127], v[148:151], 0
    ds_read_b128 v[160:163], v173 offset:2048
    v_mfma_f32_16x16x32_bf16 v[60:63], v[124:127], v[152:155], 0
    s_waitcnt lgkmcnt(12)
    v_mfma_f32_16x16x32_bf16 v[96:99], v[136:139], v[140:143], 0
    ds_read_b64_tr_b16 v[124:125], v174 offset:14520
    v_mfma_f32_16x16x32_bf16 v[100:103], v[136:139], v[144:147], 0
    ds_read_b64_tr_b16 v[126:127], v174 offset:16312
    v_mfma_f32_16x16x32_bf16 v[104:107], v[136:139], v[148:151], 0
    ds_read_b128 v[164:167], v173 offset:4096
    v_mfma_f32_16x16x32_bf16 v[108:111], v[136:139], v[152:155], 0
    s_waitcnt lgkmcnt(13)
    v_mfma_f32_16x16x32_bf16 v[64:67], v[128:131], v[140:143], 0
    ds_read_b64_tr_b16 v[136:137], v176 offset:14336
    v_mfma_f32_16x16x32_bf16 v[68:71], v[128:131], v[144:147], 0
    ds_read_b64_tr_b16 v[138:139], v176 offset:16128
    v_mfma_f32_16x16x32_bf16 v[72:75], v[128:131], v[148:151], 0
    ds_read_b128 v[168:171], v173 offset:6144
    v_mfma_f32_16x16x32_bf16 v[76:79], v[128:131], v[152:155], 0
    s_waitcnt lgkmcnt(14)
    v_mfma_f32_16x16x32_bf16 v[80:83], v[132:135], v[140:143], 0
    ds_read_b64_tr_b16 v[128:129], v174 offset:14624
    v_mfma_f32_16x16x32_bf16 v[84:87], v[132:135], v[144:147], 0
    ds_read_b64_tr_b16 v[130:131], v174 offset:16416
    v_mfma_f32_16x16x32_bf16 v[88:91], v[132:135], v[148:151], 0
    v_mfma_f32_16x16x32_bf16 v[92:95], v[132:135], v[152:155], 0
    s_waitcnt lgkmcnt(14)
    v_mfma_f32_16x16x32_bf16 v[0:3], v[112:115], v[140:143], 0
    ds_read_b64_tr_b16 v[132:133], v175 offset:14336
    v_mfma_f32_16x16x32_bf16 v[4:7], v[112:115], v[144:147], 0
    ds_read_b64_tr_b16 v[134:135], v175 offset:16128
    v_mfma_f32_16x16x32_bf16 v[8:11], v[112:115], v[148:151], 0
    v_mfma_f32_16x16x32_bf16 v[12:15], v[112:115], v[152:155], 0
    s_waitcnt lgkmcnt(14)
    v_mfma_f32_16x16x32_bf16 v[16:19], v[116:119], v[140:143], 0
    ds_read_b64_tr_b16 v[112:113], v174 offset:14336
    v_mfma_f32_16x16x32_bf16 v[20:23], v[116:119], v[144:147], 0
    ds_read_b64_tr_b16 v[114:115], v174 offset:16128
    v_mfma_f32_16x16x32_bf16 v[24:27], v[116:119], v[148:151], 0
    v_mfma_f32_16x16x32_bf16 v[28:31], v[116:119], v[152:155], 0
    s_branch L12_kloop1
    .p2align 6
    s_nop 0
    s_nop 0
    s_nop 0
    s_nop 0
    s_nop 0
    s_nop 0
    s_nop 0
    s_nop 0
    s_nop 0
    s_nop 0
    s_nop 0
    s_nop 0
    s_nop 0
L12_kloop:
    s_waitcnt lgkmcnt(10)
    v_mfma_f32_16x16x32_bf16 v[32:35], v[120:123], v[140:143], v[32:35]
    ds_read_b64_tr_b16 v[116:117], v174 offset:40
    v_mfma_f32_16x16x32_bf16 v[36:39], v[120:123], v[144:147], v[36:39]
    ds_read_b64_tr_b16 v[118:119], v174 offset:1832
    v_mfma_f32_16x16x32_bf16 v[40:43], v[120:123], v[148:151], v[40:43]
    ds_read_b128 v[156:159], v173 offset:0
    v_mfma_f32_16x16x32_bf16 v[44:47], v[120:123], v[152:155], v[44:47]
    s_waitcnt lgkmcnt(11)
    v_mfma_f32_16x16x32_bf16 v[48:51], v[124:127], v[140:143], v[48:51]
    ds_read_b64_tr_b16 v[120:121], v174 offset:14480
    v_mfma_f32_16x16x32_bf16 v[52:55], v[124:127], v[144:147], v[52:55]
    ds_read_b64_tr_b16 v[122:123], v174 offset:16272
    v_mfma_f32_16x16x32_bf16 v[56:59], v[124:127], v[148:151], v[56:59]
    ds_read_b128 v[160:163], v173 offset:2048
    v_mfma_f32_16x16x32_bf16 v[60:63], v[124:127], v[152:155], v[60:63]
    s_waitcnt lgkmcnt(12)
    v_mfma_f32_16x16x32_bf16 v[96:99], v[136:139], v[140:143], v[96:99]
    ds_read_b64_tr_b16 v[124:125], v174 offset:14520
    v_mfma_f32_16x16x32_bf16 v[100:103], v[136:139], v[144:147], v[100:103]
    ds_read_b64_tr_b16 v[126:127], v174 offset:16312
    v_mfma_f32_16x16x32_bf16 v[104:107], v[136:139], v[148:151], v[104:107]
    ds_read_b128 v[164:167], v173 offset:4096
    v_mfma_f32_16x16x32_bf16 v[108:111], v[136:139], v[152:155], v[108:111]
    s_waitcnt lgkmcnt(13)
    v_mfma_f32_16x16x32_bf16 v[64:67], v[128:131], v[140:143], v[64:67]
    ds_read_b64_tr_b16 v[136:137], v176 offset:14336
    v_mfma_f32_16x16x32_bf16 v[68:71], v[128:131], v[144:147], v[68:71]
    ds_read_b64_tr_b16 v[138:139], v176 offset:16128
    v_mfma_f32_16x16x32_bf16 v[72:75], v[128:131], v[148:151], v[72:75]
    ds_read_b128 v[168:171], v173 offset:6144
    v_mfma_f32_16x16x32_bf16 v[76:79], v[128:131], v[152:155], v[76:79]
    s_waitcnt lgkmcnt(14)
    v_mfma_f32_16x16x32_bf16 v[80:83], v[132:135], v[140:143], v[80:83]
    ds_read_b64_tr_b16 v[128:129], v174 offset:14624
    v_mfma_f32_16x16x32_bf16 v[84:87], v[132:135], v[144:147], v[84:87]
    ds_read_b64_tr_b16 v[130:131], v174 offset:16416
    v_mfma_f32_16x16x32_bf16 v[88:91], v[132:135], v[148:151], v[88:91]
    v_mfma_f32_16x16x32_bf16 v[92:95], v[132:135], v[152:155], v[92:95]
    s_waitcnt lgkmcnt(14)
    v_mfma_f32_16x16x32_bf16 v[0:3], v[112:115], v[140:143], v[0:3]
    ds_read_b64_tr_b16 v[132:133], v175 offset:14336
    v_mfma_f32_16x16x32_bf16 v[4:7], v[112:115], v[144:147], v[4:7]
    ds_read_b64_tr_b16 v[134:135], v175 offset:16128
    v_mfma_f32_16x16x32_bf16 v[8:11], v[112:115], v[148:151], v[8:11]
    v_mfma_f32_16x16x32_bf16 v[12:15], v[112:115], v[152:155], v[12:15]
    s_waitcnt lgkmcnt(14)
    v_mfma_f32_16x16x32_bf16 v[16:19], v[116:119], v[140:143], v[16:19]
    ds_read_b64_tr_b16 v[112:113], v174 offset:14336
    v_mfma_f32_16x16x32_bf16 v[20:23], v[116:119], v[144:147], v[20:23]
    ds_read_b64_tr_b16 v[114:115], v174 offset:16128
    v_mfma_f32_16x16x32_bf16 v[24:27], v[116:119], v[148:151], v[24:27]
    v_mfma_f32_16x16x32_bf16 v[28:31], v[116:119], v[152:155], v[28:31]
L12_kloop1:
    s_add_u32 s75, s75, 1
    s_cmp_eq_u32 s75, 3
    s_cselect_b32 s30, s76, 45056
    s_cselect_b32 s75, 0, s75
    s_waitcnt lgkmcnt(6)
    v_mfma_f32_16x16x32_bf16 v[32:35], v[120:123], v[156:159], v[32:35]
    ds_read_b64_tr_b16 v[116:117], v174 offset:14376
    v_mfma_f32_16x16x32_bf16 v[36:39], v[120:123], v[160:163], v[36:39]
    ds_read_b64_tr_b16 v[118:119], v174 offset:16168
    v_mfma_f32_16x16x32_bf16 v[40:43], v[120:123], v[164:167], v[40:43]
    v_mfma_f32_16x16x32_bf16 v[44:47], v[120:123], v[168:171], v[44:47]
    v_mfma_f32_16x16x32_bf16 v[48:51], v[124:127], v[156:159], v[48:51]
    v_mfma_f32_16x16x32_bf16 v[52:55], v[124:127], v[160:163], v[52:55]
    v_mfma_f32_16x16x32_bf16 v[56:59], v[124:127], v[164:167], v[56:59]
    v_mfma_f32_16x16x32_bf16 v[60:63], v[124:127], v[168:171], v[60:63]
    v_mfma_f32_16x16x32_bf16 v[96:99], v[136:139], v[156:159], v[96:99]
    v_mfma_f32_16x16x32_bf16 v[100:103], v[136:139], v[160:163], v[100:103]
    v_mfma_f32_16x16x32_bf16 v[104:107], v[136:139], v[164:167], v[104:107]
    v_mfma_f32_16x16x32_bf16 v[108:111], v[136:139], v[168:171], v[108:111]
    s_waitcnt lgkmcnt(6)
    v_mfma_f32_16x16x32_bf16 v[64:67], v[128:131], v[156:159], v[64:67]
    v_mfma_f32_16x16x32_bf16 v[68:71], v[128:131], v[160:163], v[68:71]
    v_mfma_f32_16x16x32_bf16 v[72:75], v[128:131], v[164:167], v[72:75]
    v_mfma_f32_16x16x32_bf16 v[76:79], v[128:131], v[168:171], v[76:79]
    s_waitcnt lgkmcnt(4)
    v_mfma_f32_16x16x32_bf16 v[80:83], v[132:135], v[156:159], v[80:83]
    v_mfma_f32_16x16x32_bf16 v[84:87], v[132:135], v[160:163], v[84:87]
    v_mfma_f32_16x16x32_bf16 v[88:91], v[132:135], v[164:167], v[88:91]
    v_mfma_f32_16x16x32_bf16 v[92:95], v[132:135], v[168:171], v[92:95]
    v_add_u32 v172, s30, v172
    v_add_u32 v173, s30, v173
    v_add_u32 v174, s30, v174
    v_add_u32 v175, s30, v175
    v_add_u32 v176, s30, v176
    s_add_u32 s74, s74, 1
    s_cmp_eq_u32 s74, 9
    s_waitcnt lgkmcnt(0)
    s_barrier
    s_cbranch_scc1 L12_klast
    v_mfma_f32_16x16x32_bf16 v[0:3], v[112:115], v[156:159], v[0:3]
    ds_read_b128 v[140:143], v172 offset:0
    ds_read_b128 v[144:147], v172 offset:2048
    v_mfma_f32_16x16x32_bf16 v[4:7], v[112:115], v[160:163], v[4:7]
    ds_read_b128 v[148:151], v172 offset:4096
    ds_read_b128 v[152:155], v172 offset:6144
    v_mfma_f32_16x16x32_bf16 v[8:11], v[112:115], v[164:167], v[8:11]
    ds_read_b64_tr_b16 v[120:121], v174 offset:144
    ds_read_b64_tr_b16 v[122:123], v174 offset:1936
    v_mfma_f32_16x16x32_bf16 v[12:15], v[112:115], v[168:171], v[12:15]
    ds_read_b64_tr_b16 v[124:125], v174 offset:184
    ds_read_b64_tr_b16 v[126:127], v174 offset:1976
    v_mfma_f32_16x16x32_bf16 v[16:19], v[116:119], v[156:159], v[16:19]
    ds_read_b64_tr_b16 v[136:137], v176 offset:0
    ds_read_b64_tr_b16 v[138:139], v176 offset:1792
    v_mfma_f32_16x16x32_bf16 v[20:23], v[116:119], v[160:163], v[20:23]
    ds_read_b64_tr_b16 v[128:129], v174 offset:288
    ds_read_b64_tr_b16 v[130:131], v174 offset:2080
    v_mfma_f32_16x16x32_bf16 v[24:27], v[116:119], v[164:167], v[24:27]
    ds_read_b64_tr_b16 v[132:133], v175 offset:0
    ds_read_b64_tr_b16 v[134:135], v175 offset:1792
    v_mfma_f32_16x16x32_bf16 v[28:31], v[116:119], v[168:171], v[28:31]
    ds_read_b64_tr_b16 v[112:113], v174 offset:0
    ds_read_b64_tr_b16 v[114:115], v174 offset:1792
    s_branch L12_kloop
L12_klast:
    v_mfma_f32_16x16x32_bf16 v[0:3], v[112:115], v[156:159], v[0:3]
    v_mfma_f32_16x16x32_bf16 v[4:7], v[112:115], v[160:163], v[4:7]
    v_mfma_f32_16x16x32_bf16 v[8:11], v[112:115], v[164:167], v[8:11]
    v_mfma_f32_16x16x32_bf16 v[12:15], v[112:115], v[168:171], v[12:15]
    v_mfma_f32_16x16x32_bf16 v[16:19], v[116:119], v[156:159], v[16:19]
    v_mfma_f32_16x16x32_bf16 v[20:23], v[116:119], v[160:163], v[20:23]
    v_mfma_f32_16x16x32_bf16 v[24:27], v[116:119], v[164:167], v[24:27]
    v_mfma_f32_16x16x32_bf16 v[28:31], v[116:119], v[168:171], v[28:31]
    s_cmp_lg_u32 s26, 0
    s_cbranch_scc1 L12_B_compute
L_dry_Ae1:
    v_cvt_pk_bf16_f32 v112, v32, v33
    v_cvt_pk_bf16_f32 v113, v34, v35
    v_cvt_pk_bf16_f32 v114, v36, v37
    v_cvt_pk_bf16_f32 v115, v38, v39
    v_cvt_pk_bf16_f32 v116, v40, v41
    v_cvt_pk_bf16_f32 v117, v42, v43
    v_cvt_pk_bf16_f32 v118, v44, v45
    v_cvt_pk_bf16_f32 v119, v46, v47
    v_cvt_pk_bf16_f32 v120, v48, v49
    v_cvt_pk_bf16_f32 v121, v50, v51
    v_cvt_pk_bf16_f32 v122, v52, v53
    v_cvt_pk_bf16_f32 v123, v54, v55
    v_cvt_pk_bf16_f32 v124, v56, v57
    v_cvt_pk_bf16_f32 v125, v58, v59
    v_cvt_pk_bf16_f32 v126, v60, v61
    v_cvt_pk_bf16_f32 v127, v62, v63
    v_permlane16_swap_b32 v112, v114
    v_permlane16_swap_b32 v113, v115
    v_permlane16_swap_b32 v116, v118
    v_permlane16_swap_b32 v117, v119
    v_permlane16_swap_b32 v120, v122
    v_permlane16_swap_b32 v121, v123
    v_permlane16_swap_b32 v124, v126
    v_permlane16_swap_b32 v125, v127
    s_cbranch_execz L12_A_rok
    buffer_store_dwordx4 v[112:115], v189, s[20:23], s62 offen offset:0 sc1
    buffer_store_dwordx4 v[116:119], v189, s[20:23], s62 offen offset:512 sc1
    buffer_store_dwordx4 v[120:123], v189, s[20:23], s65 offen offset:0 sc1
    buffer_store_dwordx4 v[124:127], v189, s[20:23], s65 offen offset:512 sc1
L12_A_rok:
    ds_write_b128 v236, v[112:115] offset:18480
    ds_write_b128 v236, v[116:119] offset:18992
    ds_write_b128 v236, v[120:123] offset:49280
    ds_write_b128 v236, v[124:127] offset:49792
    v_cvt_pk_bf16_f32 v128, v64, v65
    v_cvt_pk_bf16_f32 v129, v66, v67
    v_cvt_pk_bf16_f32 v130, v68, v69
    v_cvt_pk_bf16_f32 v131, v70, v71
    v_cvt_pk_bf16_f32 v132, v72, v73
    v_cvt_pk_bf16_f32 v133, v74, v75
    v_cvt_pk_bf16_f32 v134, v76, v77
    v_cvt_pk_bf16_f32 v135, v78, v79
    v_cvt_pk_bf16_f32 v136, v80, v81
    v_cvt_pk_bf16_f32 v137, v82, v83
    v_cvt_pk_bf16_f32 v138, v84, v85
    v_cvt_pk_bf16_f32 v139, v86, v87
    v_cvt_pk_bf16_f32 v140, v88, v89
    v_cvt_pk_bf16_f32 v141, v90, v91
    v_cvt_pk_bf16_f32 v142, v92, v93
    v_cvt_pk_bf16_f32 v143, v94, v95
    v_permlane16_swap_b32 v128, v130
    v_permlane16_swap_b32 v129, v131
    v_permlane16_swap_b32 v132, v134
    v_permlane16_swap_b32 v133, v135
    v_permlane16_swap_b32 v136, v138
    v_permlane16_swap_b32 v137, v139
    v_permlane16_swap_b32 v140, v142
    v_permlane16_swap_b32 v141, v143
    s_cbranch_execz L12_A_rov
    buffer_store_dwordx4 v[128:131], v189, s[20:23], s60 offen offset:0 sc1
    buffer_store_dwordx4 v[132:135], v189, s[20:23], s60 offen offset:512 sc1
    buffer_store_dwordx4 v[136:139], v189, s[20:23], s63 offen offset:0 sc1
    buffer_store_dwordx4 v[140:143], v189, s[20:23], s63 offen offset:512 sc1
L12_A_rov:
    ds_write_b128 v236, v[128:131] offset:0
    ds_write_b128 v236, v[132:135] offset:512
    ds_write_b128 v236, v[136:139] offset:30800
    ds_write_b128 v236, v[140:143] offset:31312
    v_pk_mul_f32 v[96:97], v[96:97], v[184:185] op_sel_hi:[1,0]
    v_pk_mul_f32 v[98:99], v[98:99], v[184:185] op_sel_hi:[1,0]
    v_pk_mul_f32 v[100:101], v[100:101], v[184:185] op_sel_hi:[1,0]
    v_pk_mul_f32 v[102:103], v[102:103], v[184:185] op_sel_hi:[1,0]
    v_pk_mul_f32 v[104:105], v[104:105], v[184:185] op_sel_hi:[1,0]
    v_pk_mul_f32 v[106:107], v[106:107], v[184:185] op_sel_hi:[1,0]
    v_pk_mul_f32 v[108:109], v[108:109], v[184:185] op_sel_hi:[1,0]
    v_pk_mul_f32 v[110:111], v[110:111], v[184:185] op_sel_hi:[1,0]
    v_cvt_pk_bf16_f32 v168, v96, v97
    v_cvt_pk_bf16_f32 v169, v98, v99
    v_cvt_pk_bf16_f32 v162, v100, v101
    v_cvt_pk_bf16_f32 v166, v102, v103
    v_cvt_pk_bf16_f32 v160, v104, v105
    v_cvt_pk_bf16_f32 v164, v106, v107
    v_cvt_pk_bf16_f32 v170, v108, v109
    v_cvt_pk_bf16_f32 v171, v110, v111
    v_mov_b32 v161, 0x3f80
    v_mov_b32 v163, 0
    v_mov_b32 v165, 0x3f80
    v_mov_b32 v167, 0
    v_permlane32_swap_b32 v168, v160
    v_permlane32_swap_b32 v169, v164
    v_permlane32_swap_b32 v162, v170
    v_permlane32_swap_b32 v166, v171
    s_nop 0
    v_permlane16_swap_b32 v168, v162
    v_permlane16_swap_b32 v169, v166
    v_permlane16_swap_b32 v160, v170
    v_permlane16_swap_b32 v164, v171
    s_cbranch_execz L12_A_roe
    buffer_store_dwordx4 v[160:163], v248, s[20:23], s61 offen sc1
    buffer_store_dwordx4 v[164:167], v248, s[20:23], s64 offen sc1
L12_A_roe:
    ds_write_b128 v188, v[160:163] offset:0
    ds_write_b128 v188, v[164:167] offset:30800
    s_cbranch_execz L_dry_ret
L_dry_Ae2:
    v_pk_mul_f32 v[0:1], v[0:1], s[80:81] op_sel_hi:[1,0]
    v_pk_mul_f32 v[2:3], v[2:3], s[80:81] op_sel_hi:[1,0]
    v_pk_mul_f32 v[4:5], v[4:5], s[80:81] op_sel_hi:[1,0]
    v_pk_mul_f32 v[6:7], v[6:7], s[80:81] op_sel_hi:[1,0]
    v_pk_mul_f32 v[8:9], v[8:9], s[80:81] op_sel_hi:[1,0]
    v_pk_mul_f32 v[10:11], v[10:11], s[80:81] op_sel_hi:[1,0]
    v_pk_mul_f32 v[12:13], v[12:13], s[80:81] op_sel_hi:[1,0]
    v_pk_mul_f32 v[14:15], v[14:15], s[80:81] op_sel_hi:[1,0]
    v_pk_mul_f32 v[16:17], v[16:17], s[80:81] op_sel_hi:[1,0]
    v_pk_mul_f32 v[18:19], v[18:19], s[80:81] op_sel_hi:[1,0]
    v_pk_mul_f32 v[20:21], v[20:21], s[80:81] op_sel_hi:[1,0]
    v_pk_mul_f32 v[22:23], v[22:23], s[80:81] op_sel_hi:[1,0]
    v_pk_mul_f32 v[24:25], v[24:25], s[80:81] op_sel_hi:[1,0]
    v_pk_mul_f32 v[26:27], v[26:27], s[80:81] op_sel_hi:[1,0]
    v_pk_mul_f32 v[28:29], v[28:29], s[80:81] op_sel_hi:[1,0]
    v_pk_mul_f32 v[30:31], v[30:31], s[80:81] op_sel_hi:[1,0]
    v_permlane32_swap_b32 v96, v104
    v_permlane32_swap_b32 v100, v108
    v_cvt_pk_bf16_f32 v144, v0, v1
    v_cvt_pk_bf16_f32 v145, v2, v3
    v_cvt_pk_bf16_f32 v146, v4, v5
    v_cvt_pk_bf16_f32 v147, v6, v7
    v_cvt_pk_bf16_f32 v148, v8, v9
    v_cvt_pk_bf16_f32 v149, v10, v11
    v_cvt_pk_bf16_f32 v150, v12, v13
    v_cvt_pk_bf16_f32 v151, v14, v15
    v_permlane16_swap_b32 v104, v108
    v_cvt_pk_bf16_f32 v152, v16, v17
    v_cvt_pk_bf16_f32 v153, v18, v19
    v_cvt_pk_bf16_f32 v154, v20, v21
    v_cvt_pk_bf16_f32 v155, v22, v23
    v_cvt_pk_bf16_f32 v156, v24, v25
    v_cvt_pk_bf16_f32 v157, v26, v27
    v_cvt_pk_bf16_f32 v158, v28, v29
    v_cvt_pk_bf16_f32 v159, v30, v31
    v_mul_f32 v172, 0xbfb8aa3b, v108
    v_exp_f32 v172, v172
    s_nop 0
    v_add_f32 v172, 1.0, v172
    v_rcp_f32 v172, v172
    v_permlane16_swap_b32 v144, v146
    v_permlane16_swap_b32 v145, v147
    v_permlane16_swap_b32 v148, v150
    v_permlane16_swap_b32 v149, v151
    v_permlane16_swap_b32 v152, v154
    v_permlane16_swap_b32 v153, v155
    v_permlane16_swap_b32 v156, v158
    v_permlane16_swap_b32 v157, v159
    ds_write_b128 v237, v[144:147] offset:0
    ds_write_b128 v237, v[148:151] offset:1536
    ds_write_b32 v187, v168 offset:32
    ds_write_b128 v237, v[152:155] offset:6144
    ds_write_b128 v237, v[156:159] offset:7680
    ds_write_b32 v187, v169 offset:6176
    ds_write_b32 v238, v172
    s_waitcnt lgkmcnt(0)
    s_cbranch_execz L_dry_ret
    s_barrier
L12_A_common:
    v_mov_b32 v122, 147968
    ds_read_b32 v123, v122
    v_add_u32 v124, v227, v240
    ds_read_b128 v[104:107], v124
    ds_read_b32 v110, v227 offset:32
    ds_read_b32 v120, v228
    v_add_u32 v125, v234, v240
    ds_read_b128 v[112:115], v125
    ds_read_b32 v118, v234 offset:32
    ds_read_b32 v121, v235
    v_mov_b32 v108, 0
    v_mov_b32 v109, 0
    v_mov_b32 v111, 0
    v_mov_b32 v116, 0
    v_mov_b32 v117, 0
    v_mov_b32 v119, 0
    s_waitcnt lgkmcnt(0)
    v_readfirstlane_b32 s42, v123
    s_lshl_b32 s30, s25, 4
    s_add_u32 s30, s30, s24
    s_lshl_b32 s30, s30, 7
    s_add_u32 s30, s30, 11534336
    v_mov_b32 v132, 262144
    v_cmp_gt_u32 vcc, 4, v255
    v_mov_b32 v133, s42
    v_and_b32 v134, 3, v255
    v_cndmask_b32 v132, 0, v132, vcc
    v_lshl_add_u32 v132, v134, 2, v132
    v_add_u32 v132, s30, v132
    v_cndmask_b32 v110, v110, 0, s[40:41]
    v_cndmask_b32 v118, v118, 0, s[40:41]
    ds_read_b128 v[72:75], v222 offset:4608
    ds_read_b128 v[76:79], v223 offset:4608
    ds_read_b64_tr_b16 v[88:89], v224 offset:4608
    ds_read_b64_tr_b16 v[90:91], v224 offset:4640
    ds_read_b64_tr_b16 v[92:93], v224 offset:4864
    ds_read_b64_tr_b16 v[94:95], v224 offset:4896
    s_waitcnt lgkmcnt(4)
    v_mfma_f32_32x32x16_bf16 v[0:15], v[72:75], v[112:115], v[190:205]
    v_mfma_f32_32x32x16_bf16 v[0:15], v[76:79], v[116:119], v[0:15]
    s_nop 11
    v_exp_f32 v0, v0
    v_exp_f32 v1, v1
    v_exp_f32 v2, v2
    v_exp_f32 v3, v3
    v_cvt_pk_bf16_f32 v64, v0, v1
    v_cvt_pk_bf16_f32 v65, v2, v3
    v_exp_f32 v4, v4
    v_exp_f32 v5, v5
    v_exp_f32 v6, v6
    v_exp_f32 v7, v7
    v_cvt_pk_bf16_f32 v66, v4, v5
    v_cvt_pk_bf16_f32 v67, v6, v7
    v_exp_f32 v8, v8
    v_exp_f32 v9, v9
    v_exp_f32 v10, v10
    v_exp_f32 v11, v11
    v_cvt_pk_bf16_f32 v68, v8, v9
    v_cvt_pk_bf16_f32 v69, v10, v11
    s_waitcnt lgkmcnt(0)
    v_mfma_f32_32x32x16_bf16 v[48:63], v[88:91], v[64:67], 0
    v_exp_f32 v12, v12
    v_exp_f32 v13, v13
    v_exp_f32 v14, v14
    v_exp_f32 v15, v15
    v_cvt_pk_bf16_f32 v70, v12, v13
    v_cvt_pk_bf16_f32 v71, v14, v15
    s_nop 1
    v_mfma_f32_32x32x16_bf16 v[48:63], v[92:95], v[68:71], v[48:63]
    s_cmp_ge_u32 s28, 4
    s_cbranch_scc1 L12_A_noflag
    s_lshl_b32 s30, 1, s28
    s_mov_b32 exec_hi, 0
    s_waitcnt vmcnt(0)
    s_mov_b32 exec_lo, s30
    buffer_store_dword v133, v132, s[16:19], 0 offen
    s_mov_b64 exec, -1
L12_A_noflag:
    ds_read_b128 v[72:75], v222 offset:4096
    ds_read_b128 v[76:79], v223 offset:4096
    ds_read_b64_tr_b16 v[88:89], v224 offset:4096
    ds_read_b64_tr_b16 v[90:91], v224 offset:4128
    ds_read_b64_tr_b16 v[92:93], v224 offset:4352
    ds_read_b64_tr_b16 v[94:95], v224 offset:4384
    s_waitcnt lgkmcnt(4)
    v_mfma_f32_32x32x16_bf16 v[0:15], v[72:75], v[112:115], 0
    v_mfma_f32_32x32x16_bf16 v[0:15], v[76:79], v[116:119], v[0:15]
    v_mfma_f32_32x32x16_bf16 v[16:31], v[72:75], v[104:107], v[190:205]
    s_nop 10
    v_exp_f32 v0, v0
    v_exp_f32 v1, v1
    v_exp_f32 v2, v2
    v_exp_f32 v3, v3
    v_cvt_pk_bf16_f32 v64, v0, v1
    v_cvt_pk_bf16_f32 v65, v2, v3
    v_mfma_f32_32x32x16_bf16 v[16:31], v[76:79], v[108:111], v[16:31]
    v_exp_f32 v4, v4
    v_exp_f32 v5, v5
    v_exp_f32 v6, v6
    v_exp_f32 v7, v7
    v_cvt_pk_bf16_f32 v66, v4, v5
    v_cvt_pk_bf16_f32 v67, v6, v7
    v_exp_f32 v8, v8
    v_exp_f32 v9, v9
    v_exp_f32 v10, v10
    v_exp_f32 v11, v11
    v_cvt_pk_bf16_f32 v68, v8, v9
    v_cvt_pk_bf16_f32 v69, v10, v11
    s_waitcnt lgkmcnt(0)
    v_mfma_f32_32x32x16_bf16 v[48:63], v[88:91], v[64:67], v[48:63]
    v_exp_f32 v12, v12
    v_exp_f32 v13, v13
    v_exp_f32 v14, v14
    v_exp_f32 v15, v15
    v_cvt_pk_bf16_f32 v70, v12, v13
    v_cvt_pk_bf16_f32 v71, v14, v15
    v_exp_f32 v16, v16
    v_exp_f32 v17, v17
    v_exp_f32 v18, v18
    v_exp_f32 v19, v19
    v_cvt_pk_bf16_f32 v64, v16, v17
    v_cvt_pk_bf16_f32 v65, v18, v19
    v_exp_f32 v20, v20
    v_exp_f32 v21, v21
    v_exp_f32 v22, v22
    v_exp_f32 v23, v23
    v_cvt_pk_bf16_f32 v66, v20, v21
    v_cvt_pk_bf16_f32 v67, v22, v23
    v_mfma_f32_32x32x16_bf16 v[48:63], v[92:95], v[68:71], v[48:63]
    v_exp_f32 v24, v24
    v_exp_f32 v25, v25
    v_exp_f32 v26, v26
    v_exp_f32 v27, v27
    v_cvt_pk_bf16_f32 v68, v24, v25
    v_cvt_pk_bf16_f32 v69, v26, v27
    v_mfma_f32_32x32x16_bf16 v[32:47], v[88:91], v[64:67], 0
    v_exp_f32 v28, v28
    v_exp_f32 v29, v29
    v_exp_f32 v30, v30
    v_exp_f32 v31, v31
    v_cvt_pk_bf16_f32 v70, v28, v29
    v_cvt_pk_bf16_f32 v71, v30, v31
    s_nop 1
    v_mfma_f32_32x32x16_bf16 v[32:47], v[92:95], v[68:71], v[32:47]
    s_cmp_lt_u32 s28, 4
    s_cbranch_scc1 L12_A_h1
    s_barrier
    s_setprio 1
L12_A_h1:
    ds_read_b128 v[72:75], v222 offset:3584
    ds_read_b128 v[76:79], v223 offset:3584
    ds_read_b64_tr_b16 v[88:89], v224 offset:3584
    ds_read_b64_tr_b16 v[90:91], v224 offset:3616
    ds_read_b64_tr_b16 v[92:93], v224 offset:3840
    ds_read_b64_tr_b16 v[94:95], v224 offset:3872
    s_waitcnt lgkmcnt(4)
    v_mfma_f32_32x32x16_bf16 v[0:15], v[72:75], v[112:115], 0
    v_mfma_f32_32x32x16_bf16 v[0:15], v[76:79], v[116:119], v[0:15]
    v_mfma_f32_32x32x16_bf16 v[16:31], v[72:75], v[104:107], 0
    s_nop 10
    v_exp_f32 v0, v0
    v_exp_f32 v1, v1
    v_exp_f32 v2, v2
    v_exp_f32 v3, v3
    v_cvt_pk_bf16_f32 v64, v0, v1
    v_cvt_pk_bf16_f32 v65, v2, v3
    v_mfma_f32_32x32x16_bf16 v[16:31], v[76:79], v[108:111], v[16:31]
    ds_read_b128 v[80:83], v222 offset:3072
    ds_read_b128 v[84:87], v223 offset:3072
    v_exp_f32 v4, v4
    v_exp_f32 v5, v5
    v_exp_f32 v6, v6
    v_exp_f32 v7, v7
    v_cvt_pk_bf16_f32 v66, v4, v5
    v_cvt_pk_bf16_f32 v67, v6, v7
    ds_read_b64_tr_b16 v[96:97], v224 offset:3072
    ds_read_b64_tr_b16 v[98:99], v224 offset:3104
    ds_read_b64_tr_b16 v[100:101], v224 offset:3328
    ds_read_b64_tr_b16 v[102:103], v224 offset:3360
    v_exp_f32 v8, v8
    v_exp_f32 v9, v9
    v_exp_f32 v10, v10
    v_exp_f32 v11, v11
    v_cvt_pk_bf16_f32 v68, v8, v9
    v_cvt_pk_bf16_f32 v69, v10, v11
    s_waitcnt lgkmcnt(6)
    v_mfma_f32_32x32x16_bf16 v[48:63], v[88:91], v[64:67], v[48:63]
    v_exp_f32 v12, v12
    v_exp_f32 v13, v13
    v_exp_f32 v14, v14
    v_exp_f32 v15, v15
    v_cvt_pk_bf16_f32 v70, v12, v13
    v_cvt_pk_bf16_f32 v71, v14, v15
    s_waitcnt lgkmcnt(4)
    v_mfma_f32_32x32x16_bf16 v[0:15], v[80:83], v[112:115], 0
    v_exp_f32 v16, v16
    v_exp_f32 v17, v17
    v_exp_f32 v18, v18
    v_exp_f32 v19, v19
    v_cvt_pk_bf16_f32 v64, v16, v17
    v_cvt_pk_bf16_f32 v65, v18, v19
    v_mfma_f32_32x32x16_bf16 v[0:15], v[84:87], v[116:119], v[0:15]
    v_exp_f32 v20, v20
    v_exp_f32 v21, v21
    v_exp_f32 v22, v22
    v_exp_f32 v23, v23
    v_cvt_pk_bf16_f32 v66, v20, v21
    v_cvt_pk_bf16_f32 v67, v22, v23
    v_mfma_f32_32x32x16_bf16 v[48:63], v[92:95], v[68:71], v[48:63]
    v_exp_f32 v24, v24
    v_exp_f32 v25, v25
    v_exp_f32 v26, v26
    v_exp_f32 v27, v27
    v_cvt_pk_bf16_f32 v68, v24, v25
    v_cvt_pk_bf16_f32 v69, v26, v27
    v_mfma_f32_32x32x16_bf16 v[32:47], v[88:91], v[64:67], v[32:47]
    v_exp_f32 v28, v28
    v_exp_f32 v29, v29
    v_exp_f32 v30, v30
    v_exp_f32 v31, v31
    v_cvt_pk_bf16_f32 v70, v28, v29
    v_cvt_pk_bf16_f32 v71, v30, v31
    v_mfma_f32_32x32x16_bf16 v[16:31], v[80:83], v[104:107], 0
    v_exp_f32 v0, v0
    v_exp_f32 v1, v1
    v_exp_f32 v2, v2
    v_exp_f32 v3, v3
    v_cvt_pk_bf16_f32 v64, v0, v1
    v_cvt_pk_bf16_f32 v65, v2, v3
    v_mfma_f32_32x32x16_bf16 v[16:31], v[84:87], v[108:111], v[16:31]
    v_exp_f32 v4, v4
    v_exp_f32 v5, v5
    v_exp_f32 v6, v6
    v_exp_f32 v7, v7
    v_cvt_pk_bf16_f32 v66, v4, v5
    v_cvt_pk_bf16_f32 v67, v6, v7
    v_mfma_f32_32x32x16_bf16 v[32:47], v[92:95], v[68:71], v[32:47]
    v_exp_f32 v8, v8
    v_exp_f32 v9, v9
    v_exp_f32 v10, v10
    v_exp_f32 v11, v11
    v_cvt_pk_bf16_f32 v68, v8, v9
    v_cvt_pk_bf16_f32 v69, v10, v11
    s_waitcnt lgkmcnt(0)
    v_mfma_f32_32x32x16_bf16 v[48:63], v[96:99], v[64:67], v[48:63]
    v_exp_f32 v12, v12
    v_exp_f32 v13, v13
    v_exp_f32 v14, v14
    v_exp_f32 v15, v15
    v_cvt_pk_bf16_f32 v70, v12, v13
    v_cvt_pk_bf16_f32 v71, v14, v15
    v_exp_f32 v16, v16
    v_exp_f32 v17, v17
    v_exp_f32 v18, v18
    v_exp_f32 v19, v19
    v_cvt_pk_bf16_f32 v64, v16, v17
    v_cvt_pk_bf16_f32 v65, v18, v19
    v_exp_f32 v20, v20
    v_exp_f32 v21, v21
    v_exp_f32 v22, v22
    v_exp_f32 v23, v23
    v_cvt_pk_bf16_f32 v66, v20, v21
    v_cvt_pk_bf16_f32 v67, v22, v23
    v_mfma_f32_32x32x16_bf16 v[48:63], v[100:103], v[68:71], v[48:63]
    v_exp_f32 v24, v24
    v_exp_f32 v25, v25
    v_exp_f32 v26, v26
    v_exp_f32 v27, v27
    v_cvt_pk_bf16_f32 v68, v24, v25
    v_cvt_pk_bf16_f32 v69, v26, v27
    v_mfma_f32_32x32x16_bf16 v[32:47], v[96:99], v[64:67], v[32:47]
    v_exp_f32 v28, v28
    v_exp_f32 v29, v29
    v_exp_f32 v30, v30
    v_exp_f32 v31, v31
    v_cvt_pk_bf16_f32 v70, v28, v29
    v_cvt_pk_bf16_f32 v71, v30, v31
    s_nop 1
    v_mfma_f32_32x32x16_bf16 v[32:47], v[100:103], v[68:71], v[32:47]
    s_cmp_ge_u32 s28, 4
    s_cbranch_scc1 L12_A_h2
    s_cmp_lt_u32 s24, 1
    s_cbranch_scc1 L12_A_go1y
    v_subrev_u32 v124, 128, v132
    s_mov_b32 s30, 80000
    s_mov_b32 exec_hi, 0
L_poll_A1y:
    s_mov_b32 exec_lo, 0xf
    buffer_load_dword v130, v124, s[16:19], 0 offen nt
    s_waitcnt vmcnt(0)
    v_cmp_ne_u32 vcc, v133, v130
    s_cbranch_vccz L_polled_A1y
    s_sub_u32 s30, s30, 1
    s_and_b32 vcc_lo, s30, 15
    s_cbranch_scc1 L_poll_A1y
    s_lshl_b32 exec_lo, 16, s28
    buffer_store_dword v133, v132, s[16:19], 0 offen sc1
    s_mov_b32 exec_lo, 0xf0
    buffer_load_dword v130, v124, s[16:19], 0 offen sc1
    s_waitcnt vmcnt(0)
    v_cmp_ne_u32 vcc, v133, v130
    s_cbranch_vccz L_polled_A1y
    s_cmp_lg_u32 s30, 0
    s_cbranch_scc1 L_poll_A1y
L_polled_A1y:
    s_cmp_eq_u32 exec_lo, 0xf
    s_mov_b64 exec, -1
L12_A_go1y:
    s_mov_b32 s20, s58
    s_mov_b32 s21, s59
    s_mov_b32 s23, 0x20000
    s_lshl_b32 s35, s27, 2
    s_add_u32 s35, s35, s36
    s_mul_i32 s35, s35, 163840
    s_mul_i32 s33, s36, 30800
    s_cmp_ge_u32 s24, 1
    s_cselect_b32 s22, 268435456, 0
    s_cselect_b32 s32, s24, 1
    s_sub_u32 s32, s32, 1
    s_mul_i32 s32, s32, 10240
    s_add_u32 s32, s32, s35
    s_add_u32 m0, s33, 2048
    s_nop 0
    buffer_load_dwordx4 v239, s[20:23], s32 offen sc1 lds
    s_add_u32 s32, s32, 1024
    s_add_u32 m0, s33, 3072
    s_nop 0
    buffer_load_dwordx4 v239, s[20:23], s32 offen sc1 lds
    s_add_u32 s32, s32, 1024
    s_add_u32 m0, s33, 8208
    s_nop 0
    buffer_load_dwordx4 v239, s[20:23], s32 offen sc1 lds
    s_add_u32 s32, s32, 1024
    s_add_u32 m0, s33, 9232
    s_nop 0
    buffer_load_dwordx4 v239, s[20:23], s32 offen sc1 lds
    s_add_u32 s32, s32, 1024
    s_add_u32 m0, s33, 14368
    s_nop 0
    buffer_load_dwordx4 v239, s[20:23], s32 offen sc1 lds
    s_add_u32 s32, s32, 1024
    s_add_u32 m0, s33, 15392
    s_nop 0
    buffer_load_dwordx4 v239, s[20:23], s32 offen sc1 lds
    s_add_u32 s32, s32, 1024
    s_add_u32 m0, s33, 20528
    s_nop 0
    buffer_load_dwordx4 v239, s[20:23], s32 offen sc1 lds
    s_add_u32 s32, s32, 1024
    s_add_u32 m0, s33, 21552
    s_nop 0
    buffer_load_dwordx4 v239, s[20:23], s32 offen sc1 lds
    s_add_u32 s32, s32, 1024
    s_add_u32 m0, s33, 26688
    s_nop 0
    buffer_load_dwordx4 v239, s[20:23], s32 offen sc1 lds
    s_add_u32 s32, s32, 1024
    s_add_u32 m0, s33, 27712
    s_nop 0
    buffer_load_dwordx4 v239, s[20:23], s32 offen sc1 lds
    s_waitcnt vmcnt(0)
    s_barrier
    s_cmp_lt_u32 s24, 2
    s_cbranch_scc1 L12_A_go2y
    v_subrev_u32 v124, 256, v132
    s_mov_b32 s30, 80000
    s_mov_b32 exec_hi, 0
L_poll_A2y:
    s_mov_b32 exec_lo, 0xf
    buffer_load_dword v130, v124, s[16:19], 0 offen nt
    s_waitcnt vmcnt(0)
    v_cmp_ne_u32 vcc, v133, v130
    s_cbranch_vccz L_polled_A2y
    s_sub_u32 s30, s30, 1
    s_and_b32 vcc_lo, s30, 15
    s_cbranch_scc1 L_poll_A2y
    s_lshl_b32 exec_lo, 16, s28
    buffer_store_dword v133, v132, s[16:19], 0 offen sc1
    s_mov_b32 exec_lo, 0xf0
    buffer_load_dword v130, v124, s[16:19], 0 offen sc1
    s_waitcnt vmcnt(0)
    v_cmp_ne_u32 vcc, v133, v130
    s_cbranch_vccz L_polled_A2y
    s_cmp_lg_u32 s30, 0
    s_cbranch_scc1 L_poll_A2y
L_polled_A2y:
    s_cmp_eq_u32 exec_lo, 0xf
    s_mov_b64 exec, -1
L12_A_go2y:
    s_mov_b32 s20, s58
    s_mov_b32 s21, s59
    s_mov_b32 s23, 0x20000
    s_lshl_b32 s35, s27, 2
    s_add_u32 s35, s35, s36
    s_mul_i32 s35, s35, 163840
    s_mul_i32 s33, s36, 30800
    s_cmp_ge_u32 s24, 2
    s_cselect_b32 s22, 268435456, 0
    s_cselect_b32 s32, s24, 2
    s_sub_u32 s32, s32, 2
    s_mul_i32 s32, s32, 10240
    s_add_u32 s32, s32, s35
    s_add_u32 m0, s33, 0
    s_nop 0
    buffer_load_dwordx4 v239, s[20:23], s32 offen sc1 lds
    s_add_u32 s32, s32, 1024
    s_add_u32 m0, s33, 1024
    s_nop 0
    buffer_load_dwordx4 v239, s[20:23], s32 offen sc1 lds
    s_add_u32 s32, s32, 1024
    s_add_u32 m0, s33, 6160
    s_nop 0
    buffer_load_dwordx4 v239, s[20:23], s32 offen sc1 lds
    s_add_u32 s32, s32, 1024
    s_add_u32 m0, s33, 7184
    s_nop 0
    buffer_load_dwordx4 v239, s[20:23], s32 offen sc1 lds
    s_add_u32 s32, s32, 1024
    s_add_u32 m0, s33, 12320
    s_nop 0
    buffer_load_dwordx4 v239, s[20:23], s32 offen sc1 lds
    s_add_u32 s32, s32, 1024
    s_add_u32 m0, s33, 13344
    s_nop 0
    buffer_load_dwordx4 v239, s[20:23], s32 offen sc1 lds
    s_add_u32 s32, s32, 1024
    s_add_u32 m0, s33, 18480
    s_nop 0
    buffer_load_dwordx4 v239, s[20:23], s32 offen sc1 lds
    s_add_u32 s32, s32, 1024
    s_add_u32 m0, s33, 19504
    s_nop 0
    buffer_load_dwordx4 v239, s[20:23], s32 offen sc1 lds
    s_add_u32 s32, s32, 1024
    s_add_u32 m0, s33, 24640
    s_nop 0
    buffer_load_dwordx4 v239, s[20:23], s32 offen sc1 lds
    s_add_u32 s32, s32, 1024
    s_add_u32 m0, s33, 25664
    s_nop 0
    buffer_load_dwordx4 v239, s[20:23], s32 offen sc1 lds
    s_mov_b32 exec_hi, 0
    s_lshl_b32 exec_lo, 16, s28
    buffer_store_dword v133, v132, s[16:19], 0 offen sc1
    s_mov_b64 exec, -1
    s_mov_b32 s8, s6
    s_mov_b32 s9, s7
    s_mov_b32 s10, 663552
    s_mov_b32 s11, 0x20000
L12_A_h2:
    ds_read_b128 v[72:75], v222 offset:2560
    ds_read_b128 v[76:79], v223 offset:2560
    ds_read_b64_tr_b16 v[88:89], v224 offset:2560
    ds_read_b64_tr_b16 v[90:91], v224 offset:2592
    ds_read_b64_tr_b16 v[92:93], v224 offset:2816
    ds_read_b64_tr_b16 v[94:95], v224 offset:2848
    s_waitcnt lgkmcnt(4)
    v_mfma_f32_32x32x16_bf16 v[0:15], v[72:75], v[112:115], 0
    v_mfma_f32_32x32x16_bf16 v[0:15], v[76:79], v[116:119], v[0:15]
    v_mfma_f32_32x32x16_bf16 v[16:31], v[72:75], v[104:107], 0
    s_nop 10
    v_exp_f32 v0, v0
    v_exp_f32 v1, v1
    v_exp_f32 v2, v2
    v_exp_f32 v3, v3
    v_cvt_pk_bf16_f32 v64, v0, v1
    v_cvt_pk_bf16_f32 v65, v2, v3
    v_mfma_f32_32x32x16_bf16 v[16:31], v[76:79], v[108:111], v[16:31]
    ds_read_b128 v[80:83], v222 offset:2048
    ds_read_b128 v[84:87], v223 offset:2048
    v_exp_f32 v4, v4
    v_exp_f32 v5, v5
    v_exp_f32 v6, v6
    v_exp_f32 v7, v7
    v_cvt_pk_bf16_f32 v66, v4, v5
    v_cvt_pk_bf16_f32 v67, v6, v7
    ds_read_b64_tr_b16 v[96:97], v224 offset:2048
    ds_read_b64_tr_b16 v[98:99], v224 offset:2080
    ds_read_b64_tr_b16 v[100:101], v224 offset:2304
    ds_read_b64_tr_b16 v[102:103], v224 offset:2336
    v_exp_f32 v8, v8
    v_exp_f32 v9, v9
    v_exp_f32 v10, v10
    v_exp_f32 v11, v11
    v_cvt_pk_bf16_f32 v68, v8, v9
    v_cvt_pk_bf16_f32 v69, v10, v11
    s_waitcnt lgkmcnt(6)
    v_mfma_f32_32x32x16_bf16 v[48:63], v[88:91], v[64:67], v[48:63]
    v_exp_f32 v12, v12
    v_exp_f32 v13, v13
    v_exp_f32 v14, v14
    v_exp_f32 v15, v15
    v_cvt_pk_bf16_f32 v70, v12, v13
    v_cvt_pk_bf16_f32 v71, v14, v15
    s_waitcnt lgkmcnt(4)
    v_mfma_f32_32x32x16_bf16 v[0:15], v[80:83], v[112:115], 0
    v_exp_f32 v16, v16
    v_exp_f32 v17, v17
    v_exp_f32 v18, v18
    v_exp_f32 v19, v19
    v_cvt_pk_bf16_f32 v64, v16, v17
    v_cvt_pk_bf16_f32 v65, v18, v19
    v_mfma_f32_32x32x16_bf16 v[0:15], v[84:87], v[116:119], v[0:15]
    v_exp_f32 v20, v20
    v_exp_f32 v21, v21
    v_exp_f32 v22, v22
    v_exp_f32 v23, v23
    v_cvt_pk_bf16_f32 v66, v20, v21
    v_cvt_pk_bf16_f32 v67, v22, v23
    v_mfma_f32_32x32x16_bf16 v[48:63], v[92:95], v[68:71], v[48:63]
    v_exp_f32 v24, v24
    v_exp_f32 v25, v25
    v_exp_f32 v26, v26
    v_exp_f32 v27, v27
    v_cvt_pk_bf16_f32 v68, v24, v25
    v_cvt_pk_bf16_f32 v69, v26, v27
    v_mfma_f32_32x32x16_bf16 v[32:47], v[88:91], v[64:67], v[32:47]
    v_exp_f32 v28, v28
    v_exp_f32 v29, v29
    v_exp_f32 v30, v30
    v_exp_f32 v31, v31
    v_cvt_pk_bf16_f32 v70, v28, v29
    v_cvt_pk_bf16_f32 v71, v30, v31
    v_mfma_f32_32x32x16_bf16 v[16:31], v[80:83], v[104:107], 0
    v_exp_f32 v0, v0
    v_exp_f32 v1, v1
    v_exp_f32 v2, v2
    v_exp_f32 v3, v3
    v_cvt_pk_bf16_f32 v64, v0, v1
    v_cvt_pk_bf16_f32 v65, v2, v3
    v_mfma_f32_32x32x16_bf16 v[16:31], v[84:87], v[108:111], v[16:31]
    s_cmp_lt_u32 s28, 4
    s_cbranch_scc1 L12_A_y3
    s_barrier
L12_A_y3:
    ds_read_b128 v[72:75], v222 offset:1536
    ds_read_b128 v[76:79], v223 offset:1536
    v_exp_f32 v4, v4
    v_exp_f32 v5, v5
    v_exp_f32 v6, v6
    v_exp_f32 v7, v7
    v_cvt_pk_bf16_f32 v66, v4, v5
    v_cvt_pk_bf16_f32 v67, v6, v7
    v_mfma_f32_32x32x16_bf16 v[32:47], v[92:95], v[68:71], v[32:47]
    ds_read_b64_tr_b16 v[88:89], v224 offset:1536
    ds_read_b64_tr_b16 v[90:91], v224 offset:1568
    ds_read_b64_tr_b16 v[92:93], v224 offset:1792
    ds_read_b64_tr_b16 v[94:95], v224 offset:1824
    v_exp_f32 v8, v8
    v_exp_f32 v9, v9
    v_exp_f32 v10, v10
    v_exp_f32 v11, v11
    v_cvt_pk_bf16_f32 v68, v8, v9
    v_cvt_pk_bf16_f32 v69, v10, v11
    s_waitcnt lgkmcnt(6)
    v_mfma_f32_32x32x16_bf16 v[48:63], v[96:99], v[64:67], v[48:63]
    v_exp_f32 v12, v12
    v_exp_f32 v13, v13
    v_exp_f32 v14, v14
    v_exp_f32 v15, v15
    v_cvt_pk_bf16_f32 v70, v12, v13
    v_cvt_pk_bf16_f32 v71, v14, v15
    s_waitcnt lgkmcnt(4)
    v_mfma_f32_32x32x16_bf16 v[0:15], v[72:75], v[112:115], 0
    v_exp_f32 v16, v16
    v_exp_f32 v17, v17
    v_exp_f32 v18, v18
    v_exp_f32 v19, v19
    v_cvt_pk_bf16_f32 v64, v16, v17
    v_cvt_pk_bf16_f32 v65, v18, v19
    v_mfma_f32_32x32x16_bf16 v[0:15], v[76:79], v[116:119], v[0:15]
    v_exp_f32 v20, v20
    v_exp_f32 v21, v21
    v_exp_f32 v22, v22
    v_exp_f32 v23, v23
    v_cvt_pk_bf16_f32 v66, v20, v21
    v_cvt_pk_bf16_f32 v67, v22, v23
    v_mfma_f32_32x32x16_bf16 v[48:63], v[100:103], v[68:71], v[48:63]
    v_exp_f32 v24, v24
    v_exp_f32 v25, v25
    v_exp_f32 v26, v26
    v_exp_f32 v27, v27
    v_cvt_pk_bf16_f32 v68, v24, v25
    v_cvt_pk_bf16_f32 v69, v26, v27
    v_mfma_f32_32x32x16_bf16 v[32:47], v[96:99], v[64:67], v[32:47]
    v_exp_f32 v28, v28
    v_exp_f32 v29, v29
    v_exp_f32 v30, v30
    v_exp_f32 v31, v31
    v_cvt_pk_bf16_f32 v70, v28, v29
    v_cvt_pk_bf16_f32 v71, v30, v31
    v_mfma_f32_32x32x16_bf16 v[16:31], v[72:75], v[104:107], 0
    v_exp_f32 v0, v0
    v_exp_f32 v1, v1
    v_exp_f32 v2, v2
    v_exp_f32 v3, v3
    v_cvt_pk_bf16_f32 v64, v0, v1
    v_cvt_pk_bf16_f32 v65, v2, v3
    v_mfma_f32_32x32x16_bf16 v[16:31], v[76:79], v[108:111], v[16:31]
    ds_read_b128 v[80:83], v222 offset:1024
    ds_read_b128 v[84:87], v223 offset:1024
    v_exp_f32 v4, v4
    v_exp_f32 v5, v5
    v_exp_f32 v6, v6
    v_exp_f32 v7, v7
    v_cvt_pk_bf16_f32 v66, v4, v5
    v_cvt_pk_bf16_f32 v67, v6, v7
    v_mfma_f32_32x32x16_bf16 v[32:47], v[100:103], v[68:71], v[32:47]
    ds_read_b64_tr_b16 v[96:97], v224 offset:1024
    ds_read_b64_tr_b16 v[98:99], v224 offset:1056
    ds_read_b64_tr_b16 v[100:101], v224 offset:1280
    ds_read_b64_tr_b16 v[102:103], v224 offset:1312
    v_exp_f32 v8, v8
    v_exp_f32 v9, v9
    v_exp_f32 v10, v10
    v_exp_f32 v11, v11
    v_cvt_pk_bf16_f32 v68, v8, v9
    v_cvt_pk_bf16_f32 v69, v10, v11
    s_waitcnt lgkmcnt(6)
    v_mfma_f32_32x32x16_bf16 v[48:63], v[88:91], v[64:67], v[48:63]
    v_exp_f32 v12, v12
    v_exp_f32 v13, v13
    v_exp_f32 v14, v14
    v_exp_f32 v15, v15
    v_cvt_pk_bf16_f32 v70, v12, v13
    v_cvt_pk_bf16_f32 v71, v14, v15
    s_waitcnt lgkmcnt(4)
    v_mfma_f32_32x32x16_bf16 v[0:15], v[80:83], v[112:115], 0
    v_exp_f32 v16, v16
    v_exp_f32 v17, v17
    v_exp_f32 v18, v18
    v_exp_f32 v19, v19
    v_cvt_pk_bf16_f32 v64, v16, v17
    v_cvt_pk_bf16_f32 v65, v18, v19
    v_mfma_f32_32x32x16_bf16 v[0:15], v[84:87], v[116:119], v[0:15]
    v_exp_f32 v20, v20
    v_exp_f32 v21, v21
    v_exp_f32 v22, v22
    v_exp_f32 v23, v23
    v_cvt_pk_bf16_f32 v66, v20, v21
    v_cvt_pk_bf16_f32 v67, v22, v23
    v_mfma_f32_32x32x16_bf16 v[48:63], v[92:95], v[68:71], v[48:63]
    v_exp_f32 v24, v24
    v_exp_f32 v25, v25
    v_exp_f32 v26, v26
    v_exp_f32 v27, v27
    v_cvt_pk_bf16_f32 v68, v24, v25
    v_cvt_pk_bf16_f32 v69, v26, v27
    v_mfma_f32_32x32x16_bf16 v[32:47], v[88:91], v[64:67], v[32:47]
    v_exp_f32 v28, v28
    v_exp_f32 v29, v29
    v_exp_f32 v30, v30
    v_exp_f32 v31, v31
    v_cvt_pk_bf16_f32 v70, v28, v29
    v_cvt_pk_bf16_f32 v71, v30, v31
    v_mfma_f32_32x32x16_bf16 v[16:31], v[80:83], v[104:107], 0
    v_exp_f32 v0, v0
    v_exp_f32 v1, v1
    v_exp_f32 v2, v2
    v_exp_f32 v3, v3
    v_cvt_pk_bf16_f32 v64, v0, v1
    v_cvt_pk_bf16_f32 v65, v2, v3
    v_mfma_f32_32x32x16_bf16 v[16:31], v[84:87], v[108:111], v[16:31]
    s_cmp_lt_u32 s28, 4
    s_cbranch_scc0 L12_A_y1
    s_waitcnt vmcnt(1)
    s_barrier
    s_mov_b32 s75, 0
    s_add_u32 m0, s77, 151552
    s_nop 0
    buffer_load_dwordx4 v241, s[8:11], s75 offen lds
    s_mov_b32 s75, 36864
    s_add_u32 m0, s77, 155648
    s_nop 0
    buffer_load_dwordx4 v241, s[8:11], s75 offen lds
    s_mov_b32 s75, 73728
    s_add_u32 m0, s77, 159744
    s_nop 0
    buffer_load_dwordx4 v241, s[8:11], s75 offen lds
    s_mov_b32 s75, 110592
    s_add_u32 m0, s71, 2560
    s_nop 0
    buffer_load_dwordx4 v241, s[8:11], s75 offen lds
    s_mov_b32 s75, 147456
    s_add_u32 m0, s71, 3584
    s_nop 0
    buffer_load_dwordx4 v241, s[8:11], s75 offen lds
    s_mov_b32 s75, 184320
    s_add_u32 m0, s71, 4608
    s_nop 0
    buffer_load_dwordx4 v241, s[8:11], s75 offen lds
    s_mov_b32 s75, 221184
    s_add_u32 m0, s71, 8720
    s_nop 0
    buffer_load_dwordx4 v241, s[8:11], s75 offen lds
    s_mov_b32 s75, 258048
    s_add_u32 m0, s71, 9744
    s_nop 0
    buffer_load_dwordx4 v241, s[8:11], s75 offen lds
    s_mov_b32 s75, 294912
    s_add_u32 m0, s71, 10768
    s_nop 0
    buffer_load_dwordx4 v241, s[8:11], s75 offen lds
L12_A_y1:
    ds_read_b128 v[72:75], v222 offset:512
    ds_read_b128 v[76:79], v223 offset:512
    v_exp_f32 v4, v4
    v_exp_f32 v5, v5
    v_exp_f32 v6, v6
    v_exp_f32 v7, v7
    v_cvt_pk_bf16_f32 v66, v4, v5
    v_cvt_pk_bf16_f32 v67, v6, v7
    v_mfma_f32_32x32x16_bf16 v[32:47], v[92:95], v[68:71], v[32:47]
    ds_read_b64_tr_b16 v[88:89], v224 offset:512
    ds_read_b64_tr_b16 v[90:91], v224 offset:544
    ds_read_b64_tr_b16 v[92:93], v224 offset:768
    ds_read_b64_tr_b16 v[94:95], v224 offset:800
    v_exp_f32 v8, v8
    v_exp_f32 v9, v9
    v_exp_f32 v10, v10
    v_exp_f32 v11, v11
    v_cvt_pk_bf16_f32 v68, v8, v9
    v_cvt_pk_bf16_f32 v69, v10, v11
    s_waitcnt lgkmcnt(6)
    v_mfma_f32_32x32x16_bf16 v[48:63], v[96:99], v[64:67], v[48:63]
    v_exp_f32 v12, v12
    v_exp_f32 v13, v13
    v_exp_f32 v14, v14
    v_exp_f32 v15, v15
    v_cvt_pk_bf16_f32 v70, v12, v13
    v_cvt_pk_bf16_f32 v71, v14, v15
    s_waitcnt lgkmcnt(4)
    v_mfma_f32_32x32x16_bf16 v[0:15], v[72:75], v[112:115], v[206:221]
    v_exp_f32 v16, v16
    v_exp_f32 v17, v17
    v_exp_f32 v18, v18
    v_exp_f32 v19, v19
    v_cvt_pk_bf16_f32 v64, v16, v17
    v_cvt_pk_bf16_f32 v65, v18, v19
    v_mfma_f32_32x32x16_bf16 v[0:15], v[76:79], v[116:119], v[0:15]
    v_exp_f32 v20, v20
    v_exp_f32 v21, v21
    v_exp_f32 v22, v22
    v_exp_f32 v23, v23
    v_cvt_pk_bf16_f32 v66, v20, v21
    v_cvt_pk_bf16_f32 v67, v22, v23
    v_mfma_f32_32x32x16_bf16 v[48:63], v[100:103], v[68:71], v[48:63]
    v_exp_f32 v24, v24
    v_exp_f32 v25, v25
    v_exp_f32 v26, v26
    v_exp_f32 v27, v27
    v_cvt_pk_bf16_f32 v68, v24, v25
    v_cvt_pk_bf16_f32 v69, v26, v27
    v_mfma_f32_32x32x16_bf16 v[32:47], v[96:99], v[64:67], v[32:47]
    v_exp_f32 v28, v28
    v_exp_f32 v29, v29
    v_exp_f32 v30, v30
    v_exp_f32 v31, v31
    v_cvt_pk_bf16_f32 v70, v28, v29
    v_cvt_pk_bf16_f32 v71, v30, v31
    v_mfma_f32_32x32x16_bf16 v[16:31], v[72:75], v[104:107], 0
    v_exp_f32 v0, v0
    v_exp_f32 v1, v1
    v_exp_f32 v2, v2
    v_exp_f32 v3, v3
    v_cvt_pk_bf16_f32 v64, v0, v1
    v_cvt_pk_bf16_f32 v65, v2, v3
    v_mfma_f32_32x32x16_bf16 v[16:31], v[76:79], v[108:111], v[16:31]
    s_cmp_lt_u32 s28, 4
    s_cbranch_scc0 L12_A_y0
    s_mov_b32 s75, 331776
    s_add_u32 m0, s71, 14880
    s_nop 0
    buffer_load_dwordx4 v241, s[8:11], s75 offen lds
    s_mov_b32 s75, 368640
    s_add_u32 m0, s71, 15904
    s_nop 0
    buffer_load_dwordx4 v241, s[8:11], s75 offen lds
    s_mov_b32 s75, 405504
    s_add_u32 m0, s71, 16928
    s_nop 0
    buffer_load_dwordx4 v241, s[8:11], s75 offen lds
    s_mov_b32 s75, 442368
    s_add_u32 m0, s71, 21040
    s_nop 0
    buffer_load_dwordx4 v241, s[8:11], s75 offen lds
    s_mov_b32 s75, 479232
    s_add_u32 m0, s71, 22064
    s_nop 0
    buffer_load_dwordx4 v241, s[8:11], s75 offen lds
    s_mov_b32 s75, 516096
    s_add_u32 m0, s71, 23088
    s_nop 0
    buffer_load_dwordx4 v241, s[8:11], s75 offen lds
    s_mov_b32 s75, 552960
    s_add_u32 m0, s71, 27200
    s_nop 0
    buffer_load_dwordx4 v241, s[8:11], s75 offen lds
    s_mov_b32 s75, 589824
    s_add_u32 m0, s71, 28224
    s_nop 0
    buffer_load_dwordx4 v241, s[8:11], s75 offen lds
    s_mov_b32 s75, 626688
    s_add_u32 m0, s71, 29248
    s_nop 0
    buffer_load_dwordx4 v241, s[8:11], s75 offen lds
L12_A_y0:
    ds_read_b128 v[80:83], v222 offset:0
    ds_read_b128 v[84:87], v223 offset:0
    v_exp_f32 v4, v4
    v_exp_f32 v5, v5
    v_exp_f32 v6, v6
    v_exp_f32 v7, v7
    v_cvt_pk_bf16_f32 v66, v4, v5
    v_cvt_pk_bf16_f32 v67, v6, v7
    v_mfma_f32_32x32x16_bf16 v[32:47], v[100:103], v[68:71], v[32:47]
    ds_read_b64_tr_b16 v[96:97], v224 offset:0
    ds_read_b64_tr_b16 v[98:99], v224 offset:32
    ds_read_b64_tr_b16 v[100:101], v224 offset:256
    ds_read_b64_tr_b16 v[102:103], v224 offset:288
    v_exp_f32 v8, v8
    v_exp_f32 v9, v9
    v_exp_f32 v10, v10
    v_exp_f32 v11, v11
    v_cvt_pk_bf16_f32 v68, v8, v9
    v_cvt_pk_bf16_f32 v69, v10, v11
    s_waitcnt lgkmcnt(6)
    v_mfma_f32_32x32x16_bf16 v[48:63], v[88:91], v[64:67], v[48:63]
    v_exp_f32 v12, v12
    v_exp_f32 v13, v13
    v_exp_f32 v14, v14
    v_exp_f32 v15, v15
    v_cvt_pk_bf16_f32 v70, v12, v13
    v_cvt_pk_bf16_f32 v71, v14, v15
    s_waitcnt lgkmcnt(4)
    v_mfma_f32_32x32x16_bf16 v[0:15], v[80:83], v[104:107], v[206:221]
    v_exp_f32 v16, v16
    v_exp_f32 v17, v17
    v_exp_f32 v18, v18
    v_exp_f32 v19, v19
    v_cvt_pk_bf16_f32 v64, v16, v17
    v_cvt_pk_bf16_f32 v65, v18, v19
    v_mfma_f32_32x32x16_bf16 v[0:15], v[84:87], v[108:111], v[0:15]
    v_exp_f32 v20, v20
    v_exp_f32 v21, v21
    v_exp_f32 v22, v22
    v_exp_f32 v23, v23
    v_cvt_pk_bf16_f32 v66, v20, v21
    v_cvt_pk_bf16_f32 v67, v22, v23
    v_mfma_f32_32x32x16_bf16 v[48:63], v[92:95], v[68:71], v[48:63]
    v_exp_f32 v24, v24
    v_exp_f32 v25, v25
    v_exp_f32 v26, v26
    v_exp_f32 v27, v27
    v_cvt_pk_bf16_f32 v68, v24, v25
    v_cvt_pk_bf16_f32 v69, v26, v27
    v_mfma_f32_32x32x16_bf16 v[32:47], v[88:91], v[64:67], v[32:47]
    v_exp_f32 v28, v28
    v_exp_f32 v29, v29
    v_exp_f32 v30, v30
    v_exp_f32 v31, v31
    v_cvt_pk_bf16_f32 v70, v28, v29
    v_cvt_pk_bf16_f32 v71, v30, v31
    v_exp_f32 v0, v0
    v_exp_f32 v1, v1
    v_exp_f32 v2, v2
    v_exp_f32 v3, v3
    v_cvt_pk_bf16_f32 v64, v0, v1
    v_cvt_pk_bf16_f32 v65, v2, v3
    v_exp_f32 v4, v4
    v_exp_f32 v5, v5
    v_exp_f32 v6, v6
    v_exp_f32 v7, v7
    v_cvt_pk_bf16_f32 v66, v4, v5
    v_cvt_pk_bf16_f32 v67, v6, v7
    v_mfma_f32_32x32x16_bf16 v[32:47], v[92:95], v[68:71], v[32:47]
    v_exp_f32 v8, v8
    v_exp_f32 v9, v9
    v_exp_f32 v10, v10
    v_exp_f32 v11, v11
    v_cvt_pk_bf16_f32 v68, v8, v9
    v_cvt_pk_bf16_f32 v69, v10, v11
    s_waitcnt lgkmcnt(0)
    v_mfma_f32_32x32x16_bf16 v[32:47], v[96:99], v[64:67], v[32:47]
    v_exp_f32 v12, v12
    v_exp_f32 v13, v13
    v_exp_f32 v14, v14
    v_exp_f32 v15, v15
    v_cvt_pk_bf16_f32 v70, v12, v13
    v_cvt_pk_bf16_f32 v71, v14, v15
    s_nop 1
    v_mfma_f32_32x32x16_bf16 v[32:47], v[100:103], v[68:71], v[32:47]
    s_cmp_ge_u32 s28, 4
    s_cbranch_scc1 L12_A_noslab
L12_A_noslab:
    s_mov_b32 s30, 0x21800000
    s_mov_b32 s31, 0x5d800000
    v_mov_b32 v122, 147972
    s_nop 8
    v_rcp_f32 v126, v42
    s_nop 0
    v_mul_f32 v126, v126, v120
    v_pk_mul_f32 v[32:33], v[32:33], v[126:127] op_sel_hi:[1,0]
    v_pk_mul_f32 v[34:35], v[34:35], v[126:127] op_sel_hi:[1,0]
    v_pk_mul_f32 v[36:37], v[36:37], v[126:127] op_sel_hi:[1,0]
    v_pk_mul_f32 v[38:39], v[38:39], v[126:127] op_sel_hi:[1,0]
    v_pk_mul_f32 v[40:41], v[40:41], v[126:127] op_sel_hi:[1,0]
    v_cvt_pk_bf16_f32 v64, v32, v33
    v_cvt_pk_bf16_f32 v65, v34, v35
    v_cvt_pk_bf16_f32 v66, v36, v37
    v_cvt_pk_bf16_f32 v67, v38, v39
    v_cvt_pk_bf16_f32 v68, v40, v41
    ds_write2_b32 v225, v64, v65 offset0:0 offset1:1
    ds_write2_b32 v225, v66, v67 offset0:4 offset1:5
    ds_write_b32 v226, v68 offset:32
    v_cmp_le_f32 vcc, s30, v42
    v_cmp_ge_f32 s[32:33], s31, v42
    v_cmp_le_f32 s[34:35], s30, v58
    s_and_b64 vcc, vcc, s[32:33]
    v_cmp_ge_f32 s[32:33], s31, v58
    s_and_b64 vcc, vcc, s[34:35]
    v_rcp_f32 v126, v58
    s_nop 0
    v_mul_f32 v126, v126, v121
    v_pk_mul_f32 v[48:49], v[48:49], v[126:127] op_sel_hi:[1,0]
    v_pk_mul_f32 v[50:51], v[50:51], v[126:127] op_sel_hi:[1,0]
    v_pk_mul_f32 v[52:53], v[52:53], v[126:127] op_sel_hi:[1,0]
    v_pk_mul_f32 v[54:55], v[54:55], v[126:127] op_sel_hi:[1,0]
    v_pk_mul_f32 v[56:57], v[56:57], v[126:127] op_sel_hi:[1,0]
    v_cvt_pk_bf16_f32 v64, v48, v49
    v_cvt_pk_bf16_f32 v65, v50, v51
    v_cvt_pk_bf16_f32 v66, v52, v53
    v_cvt_pk_bf16_f32 v67, v54, v55
    v_cvt_pk_bf16_f32 v68, v56, v57
    ds_write2_b32 v232, v64, v65 offset0:0 offset1:1
    ds_write2_b32 v232, v66, v67 offset0:4 offset1:5
    ds_write_b32 v233, v68 offset:32
    s_and_b64 vcc, vcc, s[32:33]
    s_cmp_eq_u64 vcc, -1
    s_cbranch_scc1 L12_A_safe
    ds_write_b32 v122, v122
L12_A_safe:
    s_setprio 0
    s_waitcnt vmcnt(0) lgkmcnt(0)
    s_barrier
    ds_read_b32 v123, v122
    s_waitcnt lgkmcnt(0)
    v_readfirstlane_b32 s30, v123
    s_nop 0
    s_cmp_lg_u32 s30, 0
    s_cbranch_scc1 L12_recover
L12_A_done:
    s_cmp_ge_u32 s28, 4
    s_cbranch_scc1 L12_P3A_loader
L12_P3A_compute:
    s_cmp_eq_u32 s43, 0
    s_cbranch_scc1 L12_P3_fin
    v_and_b32 v20, 31, v255
    v_lshrrev_b32 v245, 5, v255
    v_bfe_u32 v21, v255, 2, 2
    v_lshlrev_b32 v23, 7, v21
    v_lshrrev_b32 v21, 1, v21
    s_and_b32 s30, s28, 1
    v_xor_b32 v21, s30, v21
    v_lshl_add_u32 v23, v21, 6, v23
    v_bfe_u32 v21, v255, 4, 1
    v_lshl_add_u32 v23, v21, 5, v23
    v_and_b32 v21, 3, v255
    v_lshl_add_u32 v244, v21, 3, v23
    s_cmp_ge_u32 s28, 2
    s_cbranch_scc1 L12_P3A_sp1
L_dry_PA0:
    s_mov_b32 s30, 9216
    v_mad_i32_i24 v24, v245, s30, v244
    v_add_u32 v24, 151552, v24
    ds_read_b64_tr_b16 v[96:97], v24 offset:0
    ds_read_b64_tr_b16 v[98:99], v24 offset:512
    s_mov_b32 s30, 9216
    v_mad_i32_i24 v25, v245, s30, v244
    v_add_u32 v25, 153600, v25
    ds_read_b64_tr_b16 v[100:101], v25 offset:0
    ds_read_b64_tr_b16 v[102:103], v25 offset:512
    s_mov_b32 s30, -122288
    v_mad_i32_i24 v26, v245, s30, v244
    v_add_u32 v26, 155648, v26
    ds_read_b64_tr_b16 v[104:105], v26 offset:0
    ds_read_b64_tr_b16 v[106:107], v26 offset:512
    s_mov_b32 s30, -62736
    v_mad_i32_i24 v27, v245, s30, v244
    v_add_u32 v27, 157696, v27
    ds_read_b64_tr_b16 v[108:109], v27 offset:0
    ds_read_b64_tr_b16 v[110:111], v27 offset:512
    s_mov_b32 s30, -125360
    v_mad_i32_i24 v28, v245, s30, v244
    v_add_u32 v28, 159744, v28
    ds_read_b64_tr_b16 v[112:113], v28 offset:0
    ds_read_b64_tr_b16 v[114:115], v28 offset:512
    s_mov_b32 s30, -86240
    v_mad_i32_i24 v29, v245, s30, v244
    v_add_u32 v29, 95984, v29
    ds_read_b64_tr_b16 v[116:117], v29 offset:0
    ds_read_b64_tr_b16 v[118:119], v29 offset:512
    s_mov_b32 s30, 35936
    v_mad_i32_i24 v30, v245, s30, v244
    v_add_u32 v30, 35408, v30
    ds_read_b64_tr_b16 v[120:121], v30 offset:0
    ds_read_b64_tr_b16 v[122:123], v30 offset:512
    s_mov_b32 s30, -86240
    v_mad_i32_i24 v31, v245, s30, v244
    v_add_u32 v31, 97008, v31
    ds_read_b64_tr_b16 v[124:125], v31 offset:0
    ds_read_b64_tr_b16 v[126:127], v31 offset:512
    s_mov_b32 s30, 32848
    v_mad_i32_i24 v24, v245, s30, v244
    v_add_u32 v24, 39520, v24
    ds_read_b64_tr_b16 v[128:129], v24 offset:0
    ds_read_b64_tr_b16 v[130:131], v24 offset:512
    s_mov_b32 s30, 32848
    v_mad_i32_i24 v25, v245, s30, v244
    v_add_u32 v25, 14880, v25
    ds_read_b64_tr_b16 v[132:133], v25 offset:0
    ds_read_b64_tr_b16 v[134:135], v25 offset:512
    s_mov_b32 s30, 32848
    v_mad_i32_i24 v26, v245, s30, v244
    v_add_u32 v26, 76480, v26
    ds_read_b64_tr_b16 v[136:137], v26 offset:0
    ds_read_b64_tr_b16 v[138:139], v26 offset:512
    s_mov_b32 s30, 35936
    v_mad_i32_i24 v27, v245, s30, v244
    v_add_u32 v27, 15904, v27
    ds_read_b64_tr_b16 v[140:141], v27 offset:0
    ds_read_b64_tr_b16 v[142:143], v27 offset:512
    s_mov_b32 s30, 35936
    v_mad_i32_i24 v28, v245, s30, v244
    v_add_u32 v28, 77504, v28
    ds_read_b64_tr_b16 v[144:145], v28 offset:0
    ds_read_b64_tr_b16 v[146:147], v28 offset:512
    s_mov_b32 s30, 35936
    v_mad_i32_i24 v29, v245, s30, v244
    v_add_u32 v29, 16928, v29
    ds_read_b64_tr_b16 v[148:149], v29 offset:0
    ds_read_b64_tr_b16 v[150:151], v29 offset:512
    s_mov_b32 s30, -86240
    v_mad_i32_i24 v30, v245, s30, v244
    v_add_u32 v30, 114464, v30
    ds_read_b64_tr_b16 v[152:153], v30 offset:0
    ds_read_b64_tr_b16 v[154:155], v30 offset:512
    s_mov_b32 s30, 35936
    v_mad_i32_i24 v31, v245, s30, v244
    v_add_u32 v31, 53888, v31
    ds_read_b64_tr_b16 v[156:157], v31 offset:0
    ds_read_b64_tr_b16 v[158:159], v31 offset:512
    s_mov_b32 s30, -86240
    v_mad_i32_i24 v24, v245, s30, v244
    v_add_u32 v24, 115488, v24
    ds_read_b64_tr_b16 v[160:161], v24 offset:0
    ds_read_b64_tr_b16 v[162:163], v24 offset:512
    s_mov_b32 s30, 32848
    v_mad_i32_i24 v25, v245, s30, v244
    v_add_u32 v25, 58000, v25
    ds_read_b64_tr_b16 v[164:165], v25 offset:0
    ds_read_b64_tr_b16 v[166:167], v25 offset:512
    s_waitcnt lgkmcnt(0)
    s_cbranch_execz L_dry_ret
    s_barrier
L12_P3A_pb0:
    v_mul_u32_u24 v21, 9216, v245
    s_mov_b32 s30, 49152
    v_add3_u32 v246, v244, v21, s30
    v_mul_u32_u24 v20, 144, v20
    v_mul_u32_u24 v21, 9216, v245
    v_add_u32 v240, v20, v21
    v_add_u32 v241, 49152, v240
    v_add_u32 v242, 98304, v240
    v_mov_b32 v0, 0
    v_mov_b32 v1, 0
    v_mov_b32 v2, 0
    v_mov_b32 v3, 0
    v_mov_b32 v4, 0
    v_mov_b32 v5, 0
    v_mov_b32 v6, 0
    v_mov_b32 v7, 0
    v_mov_b32 v8, 0
    v_mov_b32 v9, 0
    v_mov_b32 v10, 0
    v_mov_b32 v11, 0
    v_mov_b32 v12, 0
    v_mov_b32 v13, 0
    v_mov_b32 v14, 0
    v_mov_b32 v15, 0
    v_mov_b32 v16, 0
    v_mov_b32 v17, 0
    v_mov_b32 v18, 0
    v_mov_b32 v19, 0
    v_mov_b32 v20, 0
    v_mov_b32 v21, 0
    v_mov_b32 v22, 0
    v_mov_b32 v23, 0
    v_mov_b32 v24, 0
    v_mov_b32 v25, 0
    v_mov_b32 v26, 0
    v_mov_b32 v27, 0
    v_mov_b32 v28, 0
    v_mov_b32 v29, 0
    v_mov_b32 v30, 0
    v_mov_b32 v31, 0
    s_mov_b32 s20, s54
    s_mov_b32 s21, s55
    s_mov_b32 s22, 2359296
    s_mov_b32 s23, 0x20000
    s_lshl_b32 s30, s28, 3
    v_lshrrev_b32 v60, 3, v255
    v_add_u32 v60, s30, v60
    v_and_b32 v61, 7, v255
    v_lshlrev_b32 v61, 4, v61
    v_mul_u32_u24 v251, 144, v60
    s_mov_b32 s30, 24576
    v_add3_u32 v251, v251, v61, s30
    v_add_u32 v60, s84, v60
    v_mul_u32_u24 v60, 1152, v60
    s_lshl_b32 s30, s85, 7
    v_add3_u32 v252, v60, v61, s30
    s_mov_b32 s73, 73728
    s_lshl_b32 s72, s26, 2
    s_xor_b32 s31, s28, 2
    s_mul_i32 s30, s28, 4096
    s_mul_i32 s31, s31, 4096
    s_add_u32 s30, s30, 123200
    s_add_u32 s31, s31, 123200
    v_add_u32 v247, s30, v248
    v_add_u32 v249, s31, v248
    v_and_b32 v250, 31, v255
    v_mul_u32_u24 v250, 144, v250
    v_lshl_add_u32 v250, v245, 3, v250
    s_and_b32 s30, s28, 1
    s_lshl_b32 s30, s30, 6
    s_add_u32 s30, s30, 24576
    v_add_u32 v250, s30, v250
    s_barrier
L12_P3A_s0:
    ds_read_b64_tr_b16 v[168:169], v246 offset:0
    ds_read_b64_tr_b16 v[170:171], v246 offset:512
    ds_read_b64_tr_b16 v[172:173], v246 offset:2048
    ds_read_b64_tr_b16 v[174:175], v246 offset:2560
    ds_read_b64_tr_b16 v[176:177], v246 offset:4096
    ds_read_b64_tr_b16 v[178:179], v246 offset:4608
    ds_read_b64_tr_b16 v[180:181], v246 offset:6144
    ds_read_b64_tr_b16 v[182:183], v246 offset:6656
    ds_read_b64_tr_b16 v[184:185], v246 offset:8192
    ds_read_b64_tr_b16 v[186:187], v246 offset:8704
    ds_read_b64_tr_b16 v[188:189], v246 offset:19456
    ds_read_b64_tr_b16 v[190:191], v246 offset:19968
    ds_read_b64_tr_b16 v[192:193], v246 offset:21504
    ds_read_b64_tr_b16 v[194:195], v246 offset:22016
    ds_read_b64_tr_b16 v[196:197], v246 offset:23552
    ds_read_b64_tr_b16 v[198:199], v246 offset:24064
    ds_read_b64_tr_b16 v[200:201], v246 offset:25600
    ds_read_b64_tr_b16 v[202:203], v246 offset:26112
    ds_read_b64_tr_b16 v[204:205], v246 offset:36864
    ds_read_b64_tr_b16 v[206:207], v246 offset:37376
    ds_read_b64_tr_b16 v[208:209], v246 offset:38912
    ds_read_b64_tr_b16 v[210:211], v246 offset:39424
    ds_read_b64_tr_b16 v[212:213], v246 offset:40960
    ds_read_b64_tr_b16 v[214:215], v246 offset:41472
    ds_read_b64_tr_b16 v[216:217], v246 offset:43008
    ds_read_b64_tr_b16 v[218:219], v246 offset:43520
    ds_read_b64_tr_b16 v[220:221], v246 offset:45056
    ds_read_b64_tr_b16 v[222:223], v246 offset:45568
    ds_read_b64_tr_b16 v[224:225], v246 offset:56320
    ds_read_b64_tr_b16 v[226:227], v246 offset:56832
    ds_read_b64_tr_b16 v[228:229], v246 offset:58368
    ds_read_b64_tr_b16 v[230:231], v246 offset:58880
    ds_read_b64_tr_b16 v[232:233], v246 offset:60416
    ds_read_b64_tr_b16 v[234:235], v246 offset:60928
    ds_read_b64_tr_b16 v[236:237], v246 offset:62464
    ds_read_b64_tr_b16 v[238:239], v246 offset:62976
    s_waitcnt lgkmcnt(0)
    s_barrier
    s_barrier
    ds_read_b128 v[48:51], v242 offset:24896
    ds_read_b128 v[52:55], v242 offset:29504
    ds_read_b128 v[56:59], v242 offset:24928
    ds_read_b128 v[60:63], v242 offset:29536
    ds_read_b128 v[64:67], v242 offset:24960
    ds_read_b128 v[68:71], v242 offset:29568
    s_waitcnt lgkmcnt(4)
    v_mfma_f32_32x32x16_bf16 v[0:15], v[96:99], v[48:51], v[0:15]
    ds_read_b128 v[72:75], v242 offset:24992
    ds_read_b128 v[76:79], v242 offset:29600
    v_mfma_f32_32x32x16_bf16 v[16:31], v[96:99], v[52:55], v[16:31]
    s_waitcnt lgkmcnt(4)
    v_mfma_f32_32x32x16_bf16 v[0:15], v[100:103], v[56:59], v[0:15]
    ds_read_b128 v[48:51], v242 offset:25024
    ds_read_b128 v[52:55], v242 offset:29632
    v_mfma_f32_32x32x16_bf16 v[16:31], v[100:103], v[60:63], v[16:31]
    s_waitcnt lgkmcnt(4)
    v_mfma_f32_32x32x16_bf16 v[0:15], v[104:107], v[64:67], v[0:15]
    s_barrier
    ds_read_b128 v[56:59], v240 offset:16
    ds_read_b128 v[60:63], v240 offset:4624
    v_mfma_f32_32x32x16_bf16 v[16:31], v[104:107], v[68:71], v[16:31]
    s_waitcnt lgkmcnt(4)
    v_mfma_f32_32x32x16_bf16 v[0:15], v[108:111], v[72:75], v[0:15]
    ds_read_b128 v[64:67], v240 offset:48
    ds_read_b128 v[68:71], v240 offset:4656
    v_mfma_f32_32x32x16_bf16 v[16:31], v[108:111], v[76:79], v[16:31]
    s_waitcnt lgkmcnt(4)
    v_mfma_f32_32x32x16_bf16 v[0:15], v[112:115], v[48:51], v[0:15]
    ds_read_b128 v[72:75], v240 offset:80
    ds_read_b128 v[76:79], v240 offset:4688
    v_mfma_f32_32x32x16_bf16 v[16:31], v[112:115], v[52:55], v[16:31]
    s_waitcnt lgkmcnt(4)
    v_mfma_f32_32x32x16_bf16 v[0:15], v[116:119], v[56:59], v[0:15]
    ds_read_b128 v[48:51], v240 offset:112
    ds_read_b128 v[52:55], v240 offset:4720
    v_mfma_f32_32x32x16_bf16 v[16:31], v[116:119], v[60:63], v[16:31]
    s_waitcnt lgkmcnt(4)
    v_mfma_f32_32x32x16_bf16 v[0:15], v[120:123], v[64:67], v[0:15]
    s_barrier
    ds_read_b128 v[56:59], v240 offset:18432
    ds_read_b128 v[60:63], v240 offset:23040
    v_mfma_f32_32x32x16_bf16 v[16:31], v[120:123], v[68:71], v[16:31]
    s_waitcnt lgkmcnt(4)
    v_mfma_f32_32x32x16_bf16 v[0:15], v[124:127], v[72:75], v[0:15]
    ds_read_b128 v[64:67], v240 offset:18464
    ds_read_b128 v[68:71], v240 offset:23072
    v_mfma_f32_32x32x16_bf16 v[16:31], v[124:127], v[76:79], v[16:31]
    s_waitcnt lgkmcnt(4)
    v_mfma_f32_32x32x16_bf16 v[0:15], v[128:131], v[48:51], v[0:15]
    ds_read_b128 v[72:75], v240 offset:18496
    ds_read_b128 v[76:79], v240 offset:23104
    v_mfma_f32_32x32x16_bf16 v[16:31], v[128:131], v[52:55], v[16:31]
    s_waitcnt lgkmcnt(4)
    v_mfma_f32_32x32x16_bf16 v[0:15], v[132:135], v[56:59], v[0:15]
    ds_read_b128 v[48:51], v240 offset:18528
    ds_read_b128 v[52:55], v240 offset:23136
    v_mfma_f32_32x32x16_bf16 v[16:31], v[132:135], v[60:63], v[16:31]
    s_waitcnt lgkmcnt(4)
    v_mfma_f32_32x32x16_bf16 v[0:15], v[136:139], v[64:67], v[0:15]
    ds_read_b128 v[56:59], v240 offset:18560
    ds_read_b128 v[60:63], v240 offset:23168
    v_mfma_f32_32x32x16_bf16 v[16:31], v[136:139], v[68:71], v[16:31]
    s_waitcnt lgkmcnt(4)
    v_mfma_f32_32x32x16_bf16 v[0:15], v[140:143], v[72:75], v[0:15]
    s_barrier
    ds_read_b128 v[64:67], v242 offset:43344
    ds_read_b128 v[68:71], v242 offset:47952
    v_mfma_f32_32x32x16_bf16 v[16:31], v[140:143], v[76:79], v[16:31]
    s_waitcnt lgkmcnt(4)
    v_mfma_f32_32x32x16_bf16 v[0:15], v[144:147], v[48:51], v[0:15]
    ds_read_b128 v[72:75], v242 offset:43376
    ds_read_b128 v[76:79], v242 offset:47984
    v_mfma_f32_32x32x16_bf16 v[16:31], v[144:147], v[52:55], v[16:31]
    s_waitcnt lgkmcnt(4)
    v_mfma_f32_32x32x16_bf16 v[0:15], v[148:151], v[56:59], v[0:15]
    ds_read_b128 v[48:51], v242 offset:43408
    ds_read_b128 v[52:55], v242 offset:48016
    v_mfma_f32_32x32x16_bf16 v[16:31], v[148:151], v[60:63], v[16:31]
    s_waitcnt lgkmcnt(4)
    v_mfma_f32_32x32x16_bf16 v[0:15], v[152:155], v[64:67], v[0:15]
    ds_read_b128 v[56:59], v242 offset:43440
    ds_read_b128 v[60:63], v242 offset:48048
    v_mfma_f32_32x32x16_bf16 v[16:31], v[152:155], v[68:71], v[16:31]
    s_waitcnt lgkmcnt(4)
    v_mfma_f32_32x32x16_bf16 v[0:15], v[156:159], v[72:75], v[0:15]
    s_barrier
    ds_read_b128 v[64:67], v241 offset:0
    ds_read_b128 v[68:71], v241 offset:4608
    v_mfma_f32_32x32x16_bf16 v[16:31], v[156:159], v[76:79], v[16:31]
    s_waitcnt lgkmcnt(4)
    v_mfma_f32_32x32x16_bf16 v[0:15], v[160:163], v[48:51], v[0:15]
    ds_read_b128 v[72:75], v241 offset:32
    ds_read_b128 v[76:79], v241 offset:4640
    v_mfma_f32_32x32x16_bf16 v[16:31], v[160:163], v[52:55], v[16:31]
    s_waitcnt lgkmcnt(4)
    v_mfma_f32_32x32x16_bf16 v[0:15], v[164:167], v[56:59], v[0:15]
    ds_read_b128 v[48:51], v241 offset:64
    ds_read_b128 v[52:55], v241 offset:4672
    v_mfma_f32_32x32x16_bf16 v[16:31], v[164:167], v[60:63], v[16:31]
    s_waitcnt lgkmcnt(4)
    v_mfma_f32_32x32x16_bf16 v[0:15], v[168:171], v[64:67], v[0:15]
    ds_read_b128 v[56:59], v241 offset:96
    ds_read_b128 v[60:63], v241 offset:4704
    v_mfma_f32_32x32x16_bf16 v[16:31], v[168:171], v[68:71], v[16:31]
    s_waitcnt lgkmcnt(4)
    v_mfma_f32_32x32x16_bf16 v[0:15], v[172:175], v[72:75], v[0:15]
    ds_read_b128 v[64:67], v241 offset:128
    ds_read_b128 v[68:71], v241 offset:4736
    v_mfma_f32_32x32x16_bf16 v[16:31], v[172:175], v[76:79], v[16:31]
    s_waitcnt lgkmcnt(4)
    v_mfma_f32_32x32x16_bf16 v[0:15], v[176:179], v[48:51], v[0:15]
    s_barrier
    ds_read_b128 v[72:75], v241 offset:18448
    ds_read_b128 v[76:79], v241 offset:23056
    v_mfma_f32_32x32x16_bf16 v[16:31], v[176:179], v[52:55], v[16:31]
    s_waitcnt lgkmcnt(4)
    v_mfma_f32_32x32x16_bf16 v[0:15], v[180:183], v[56:59], v[0:15]
    ds_read_b128 v[48:51], v241 offset:18480
    ds_read_b128 v[52:55], v241 offset:23088
    v_mfma_f32_32x32x16_bf16 v[16:31], v[180:183], v[60:63], v[16:31]
    s_waitcnt lgkmcnt(4)
    v_mfma_f32_32x32x16_bf16 v[0:15], v[184:187], v[64:67], v[0:15]
    ds_read_b128 v[56:59], v241 offset:18512
    ds_read_b128 v[60:63], v241 offset:23120
    v_mfma_f32_32x32x16_bf16 v[16:31], v[184:187], v[68:71], v[16:31]
    s_waitcnt lgkmcnt(4)
    v_mfma_f32_32x32x16_bf16 v[0:15], v[188:191], v[72:75], v[0:15]
    ds_read_b128 v[64:67], v241 offset:18544
    ds_read_b128 v[68:71], v241 offset:23152
    v_mfma_f32_32x32x16_bf16 v[16:31], v[188:191], v[76:79], v[16:31]
    s_waitcnt lgkmcnt(4)
    v_mfma_f32_32x32x16_bf16 v[0:15], v[192:195], v[48:51], v[0:15]
    s_barrier
    ds_read_b128 v[72:75], v241 offset:36864
    ds_read_b128 v[76:79], v241 offset:41472
    v_mfma_f32_32x32x16_bf16 v[16:31], v[192:195], v[52:55], v[16:31]
    s_waitcnt lgkmcnt(4)
    v_mfma_f32_32x32x16_bf16 v[0:15], v[196:199], v[56:59], v[0:15]
    ds_read_b128 v[48:51], v241 offset:36896
    ds_read_b128 v[52:55], v241 offset:41504
    v_mfma_f32_32x32x16_bf16 v[16:31], v[196:199], v[60:63], v[16:31]
    s_waitcnt lgkmcnt(4)
    v_mfma_f32_32x32x16_bf16 v[0:15], v[200:203], v[64:67], v[0:15]
    ds_read_b128 v[56:59], v241 offset:36928
    ds_read_b128 v[60:63], v241 offset:41536
    v_mfma_f32_32x32x16_bf16 v[16:31], v[200:203], v[68:71], v[16:31]
    s_waitcnt lgkmcnt(4)
    v_mfma_f32_32x32x16_bf16 v[0:15], v[204:207], v[72:75], v[0:15]
    ds_read_b128 v[64:67], v241 offset:36960
    ds_read_b128 v[68:71], v241 offset:41568
    v_mfma_f32_32x32x16_bf16 v[16:31], v[204:207], v[76:79], v[16:31]
    s_waitcnt lgkmcnt(4)
    v_mfma_f32_32x32x16_bf16 v[0:15], v[208:211], v[48:51], v[0:15]
    ds_read_b128 v[72:75], v241 offset:36992
    ds_read_b128 v[76:79], v241 offset:41600
    v_mfma_f32_32x32x16_bf16 v[16:31], v[208:211], v[52:55], v[16:31]
    s_waitcnt lgkmcnt(4)
    v_mfma_f32_32x32x16_bf16 v[0:15], v[212:215], v[56:59], v[0:15]
    s_barrier
    ds_read_b128 v[48:51], v242 offset:6160
    ds_read_b128 v[52:55], v242 offset:10768
    v_mfma_f32_32x32x16_bf16 v[16:31], v[212:215], v[60:63], v[16:31]
    s_waitcnt lgkmcnt(4)
    v_mfma_f32_32x32x16_bf16 v[0:15], v[216:219], v[64:67], v[0:15]
    ds_read_b128 v[56:59], v242 offset:6192
    ds_read_b128 v[60:63], v242 offset:10800
    v_mfma_f32_32x32x16_bf16 v[16:31], v[216:219], v[68:71], v[16:31]
    s_waitcnt lgkmcnt(4)
    v_mfma_f32_32x32x16_bf16 v[0:15], v[220:223], v[72:75], v[0:15]
    ds_read_b128 v[64:67], v242 offset:6224
    ds_read_b128 v[68:71], v242 offset:10832
    v_mfma_f32_32x32x16_bf16 v[16:31], v[220:223], v[76:79], v[16:31]
    s_waitcnt lgkmcnt(4)
    v_mfma_f32_32x32x16_bf16 v[0:15], v[224:227], v[48:51], v[0:15]
    ds_read_b128 v[72:75], v242 offset:6256
    ds_read_b128 v[76:79], v242 offset:10864
    v_mfma_f32_32x32x16_bf16 v[16:31], v[224:227], v[52:55], v[16:31]
    s_waitcnt lgkmcnt(4)
    v_mfma_f32_32x32x16_bf16 v[0:15], v[228:231], v[56:59], v[0:15]
    v_mfma_f32_32x32x16_bf16 v[16:31], v[228:231], v[60:63], v[16:31]
    s_waitcnt lgkmcnt(2)
    v_mfma_f32_32x32x16_bf16 v[0:15], v[232:235], v[64:67], v[0:15]
    v_mfma_f32_32x32x16_bf16 v[16:31], v[232:235], v[68:71], v[16:31]
    s_waitcnt lgkmcnt(0)
    v_mfma_f32_32x32x16_bf16 v[0:15], v[236:239], v[72:75], v[0:15]
    v_mfma_f32_32x32x16_bf16 v[16:31], v[236:239], v[76:79], v[16:31]
    s_nop 11
    ds_write_b128 v247, v[16:19] offset:0
    ds_write_b128 v247, v[20:23] offset:1024
    ds_write_b128 v247, v[24:27] offset:2048
    ds_write_b128 v247, v[28:31] offset:3072
    s_waitcnt lgkmcnt(0)
    s_barrier
    ds_read_b128 v[48:51], v249 offset:0
    ds_read_b128 v[52:55], v249 offset:1024
    ds_read_b128 v[56:59], v249 offset:2048
    ds_read_b128 v[60:63], v249 offset:3072
    s_waitcnt lgkmcnt(3)
    v_pk_add_f32 v[0:1], v[0:1], v[48:49]
    v_pk_add_f32 v[2:3], v[2:3], v[50:51]
    v_cvt_pk_bf16_f32 v104, v0, v1
    v_cvt_pk_bf16_f32 v105, v2, v3
    ds_write_b64 v250, v[104:105] offset:0
    s_waitcnt lgkmcnt(3)
    v_pk_add_f32 v[4:5], v[4:5], v[52:53]
    v_pk_add_f32 v[6:7], v[6:7], v[54:55]
    v_cvt_pk_bf16_f32 v106, v4, v5
    v_cvt_pk_bf16_f32 v107, v6, v7
    ds_write_b64 v250, v[106:107] offset:16
    s_waitcnt lgkmcnt(3)
    v_pk_add_f32 v[8:9], v[8:9], v[56:57]
    v_pk_add_f32 v[10:11], v[10:11], v[58:59]
    v_cvt_pk_bf16_f32 v108, v8, v9
    v_cvt_pk_bf16_f32 v109, v10, v11
    ds_write_b64 v250, v[108:109] offset:32
    s_waitcnt lgkmcnt(3)
    v_pk_add_f32 v[12:13], v[12:13], v[60:61]
    v_pk_add_f32 v[14:15], v[14:15], v[62:63]
    v_cvt_pk_bf16_f32 v110, v12, v13
    v_cvt_pk_bf16_f32 v111, v14, v15
    ds_write_b64 v250, v[110:111] offset:48
    s_waitcnt lgkmcnt(0)
    s_barrier
    s_branch L12_P3_store
L12_P3A_sp1:
L_dry_PA1:
    s_mov_b32 s30, 9216
    v_mad_i32_i24 v24, v245, s30, v244
    v_add_u32 v24, 152576, v24
    ds_read_b64_tr_b16 v[96:97], v24 offset:0
    ds_read_b64_tr_b16 v[98:99], v24 offset:512
    s_mov_b32 s30, -152064
    v_mad_i32_i24 v25, v245, s30, v244
    v_add_u32 v25, 154624, v25
    ds_read_b64_tr_b16 v[100:101], v25 offset:0
    ds_read_b64_tr_b16 v[102:103], v25 offset:512
    s_mov_b32 s30, -92512
    v_mad_i32_i24 v26, v245, s30, v244
    v_add_u32 v26, 156672, v26
    ds_read_b64_tr_b16 v[104:105], v26 offset:0
    ds_read_b64_tr_b16 v[106:107], v26 offset:512
    s_mov_b32 s30, -155136
    v_mad_i32_i24 v27, v245, s30, v244
    v_add_u32 v27, 158720, v27
    ds_read_b64_tr_b16 v[108:109], v27 offset:0
    ds_read_b64_tr_b16 v[110:111], v27 offset:512
    s_mov_b32 s30, 35936
    v_mad_i32_i24 v28, v245, s30, v244
    v_add_u32 v28, 65184, v28
    ds_read_b64_tr_b16 v[112:113], v28 offset:0
    ds_read_b64_tr_b16 v[114:115], v28 offset:512
    s_mov_b32 s30, 35936
    v_mad_i32_i24 v29, v245, s30, v244
    v_add_u32 v29, 4608, v29
    ds_read_b64_tr_b16 v[116:117], v29 offset:0
    ds_read_b64_tr_b16 v[118:119], v29 offset:512
    s_mov_b32 s30, 35936
    v_mad_i32_i24 v30, v245, s30, v244
    v_add_u32 v30, 66208, v30
    ds_read_b64_tr_b16 v[120:121], v30 offset:0
    ds_read_b64_tr_b16 v[122:123], v30 offset:512
    s_mov_b32 s30, 32848
    v_mad_i32_i24 v31, v245, s30, v244
    v_add_u32 v31, 8720, v31
    ds_read_b64_tr_b16 v[124:125], v31 offset:0
    ds_read_b64_tr_b16 v[126:127], v31 offset:512
    s_mov_b32 s30, 32848
    v_mad_i32_i24 v24, v245, s30, v244
    v_add_u32 v24, 70320, v24
    ds_read_b64_tr_b16 v[128:129], v24 offset:0
    ds_read_b64_tr_b16 v[130:131], v24 offset:512
    s_mov_b32 s30, 32848
    v_mad_i32_i24 v25, v245, s30, v244
    v_add_u32 v25, 45680, v25
    ds_read_b64_tr_b16 v[132:133], v25 offset:0
    ds_read_b64_tr_b16 v[134:135], v25 offset:512
    s_mov_b32 s30, -86240
    v_mad_i32_i24 v26, v245, s30, v244
    v_add_u32 v26, 107280, v26
    ds_read_b64_tr_b16 v[136:137], v26 offset:0
    ds_read_b64_tr_b16 v[138:139], v26 offset:512
    s_mov_b32 s30, 35936
    v_mad_i32_i24 v27, v245, s30, v244
    v_add_u32 v27, 46704, v27
    ds_read_b64_tr_b16 v[140:141], v27 offset:0
    ds_read_b64_tr_b16 v[142:143], v27 offset:512
    s_mov_b32 s30, -86240
    v_mad_i32_i24 v28, v245, s30, v244
    v_add_u32 v28, 108304, v28
    ds_read_b64_tr_b16 v[144:145], v28 offset:0
    ds_read_b64_tr_b16 v[146:147], v28 offset:512
    s_mov_b32 s30, 35936
    v_mad_i32_i24 v29, v245, s30, v244
    v_add_u32 v29, 83664, v29
    ds_read_b64_tr_b16 v[148:149], v29 offset:0
    ds_read_b64_tr_b16 v[150:151], v29 offset:512
    s_mov_b32 s30, 35936
    v_mad_i32_i24 v30, v245, s30, v244
    v_add_u32 v30, 23088, v30
    ds_read_b64_tr_b16 v[152:153], v30 offset:0
    ds_read_b64_tr_b16 v[154:155], v30 offset:512
    s_mov_b32 s30, 35936
    v_mad_i32_i24 v31, v245, s30, v244
    v_add_u32 v31, 84688, v31
    ds_read_b64_tr_b16 v[156:157], v31 offset:0
    ds_read_b64_tr_b16 v[158:159], v31 offset:512
    s_mov_b32 s30, 32848
    v_mad_i32_i24 v24, v245, s30, v244
    v_add_u32 v24, 27200, v24
    ds_read_b64_tr_b16 v[160:161], v24 offset:0
    ds_read_b64_tr_b16 v[162:163], v24 offset:512
    s_mov_b32 s30, 32848
    v_mad_i32_i24 v25, v245, s30, v244
    v_add_u32 v25, 88800, v25
    ds_read_b64_tr_b16 v[164:165], v25 offset:0
    ds_read_b64_tr_b16 v[166:167], v25 offset:512
    s_waitcnt lgkmcnt(0)
    s_cbranch_execz L_dry_ret
    s_barrier
L12_P3A_pb1:
    v_mul_u32_u24 v21, 9216, v245
    s_mov_b32 s30, 49152
    v_add3_u32 v246, v244, v21, s30
    v_mul_u32_u24 v20, 144, v20
    v_mul_u32_u24 v21, 9216, v245
    v_add_u32 v240, v20, v21
    v_add_u32 v241, 49152, v240
    v_add_u32 v242, 98304, v240
    v_mov_b32 v0, 0
    v_mov_b32 v1, 0
    v_mov_b32 v2, 0
    v_mov_b32 v3, 0
    v_mov_b32 v4, 0
    v_mov_b32 v5, 0
    v_mov_b32 v6, 0
    v_mov_b32 v7, 0
    v_mov_b32 v8, 0
    v_mov_b32 v9, 0
    v_mov_b32 v10, 0
    v_mov_b32 v11, 0
    v_mov_b32 v12, 0
    v_mov_b32 v13, 0
    v_mov_b32 v14, 0
    v_mov_b32 v15, 0
    v_mov_b32 v16, 0
    v_mov_b32 v17, 0
    v_mov_b32 v18, 0
    v_mov_b32 v19, 0
    v_mov_b32 v20, 0
    v_mov_b32 v21, 0
    v_mov_b32 v22, 0
    v_mov_b32 v23, 0
    v_mov_b32 v24, 0
    v_mov_b32 v25, 0
    v_mov_b32 v26, 0
    v_mov_b32 v27, 0
    v_mov_b32 v28, 0
    v_mov_b32 v29, 0
    v_mov_b32 v30, 0
    v_mov_b32 v31, 0
    s_mov_b32 s20, s54
    s_mov_b32 s21, s55
    s_mov_b32 s22, 2359296
    s_mov_b32 s23, 0x20000
    s_lshl_b32 s30, s28, 3
    v_lshrrev_b32 v60, 3, v255
    v_add_u32 v60, s30, v60
    v_and_b32 v61, 7, v255
    v_lshlrev_b32 v61, 4, v61
    v_mul_u32_u24 v251, 144, v60
    s_mov_b32 s30, 24576
    v_add3_u32 v251, v251, v61, s30
    v_add_u32 v60, s84, v60
    v_mul_u32_u24 v60, 1152, v60
    s_lshl_b32 s30, s85, 7
    v_add3_u32 v252, v60, v61, s30
    s_mov_b32 s73, 73728
    s_lshl_b32 s72, s26, 2
    s_xor_b32 s31, s28, 2
    s_mul_i32 s30, s28, 4096
    s_mul_i32 s31, s31, 4096
    s_add_u32 s30, s30, 123200
    s_add_u32 s31, s31, 123200
    v_add_u32 v247, s30, v248
    v_add_u32 v249, s31, v248
    v_and_b32 v250, 31, v255
    v_mul_u32_u24 v250, 144, v250
    v_lshl_add_u32 v250, v245, 3, v250
    s_and_b32 s30, s28, 1
    s_lshl_b32 s30, s30, 6
    s_add_u32 s30, s30, 24576
    v_add_u32 v250, s30, v250
    s_barrier
L12_P3A_s1:
    ds_read_b64_tr_b16 v[168:169], v246 offset:1024
    ds_read_b64_tr_b16 v[170:171], v246 offset:1536
    ds_read_b64_tr_b16 v[172:173], v246 offset:3072
    ds_read_b64_tr_b16 v[174:175], v246 offset:3584
    ds_read_b64_tr_b16 v[176:177], v246 offset:5120
    ds_read_b64_tr_b16 v[178:179], v246 offset:5632
    ds_read_b64_tr_b16 v[180:181], v246 offset:7168
    ds_read_b64_tr_b16 v[182:183], v246 offset:7680
    ds_read_b64_tr_b16 v[184:185], v246 offset:18432
    ds_read_b64_tr_b16 v[186:187], v246 offset:18944
    ds_read_b64_tr_b16 v[188:189], v246 offset:20480
    ds_read_b64_tr_b16 v[190:191], v246 offset:20992
    ds_read_b64_tr_b16 v[192:193], v246 offset:22528
    ds_read_b64_tr_b16 v[194:195], v246 offset:23040
    ds_read_b64_tr_b16 v[196:197], v246 offset:24576
    ds_read_b64_tr_b16 v[198:199], v246 offset:25088
    ds_read_b64_tr_b16 v[200:201], v246 offset:26624
    ds_read_b64_tr_b16 v[202:203], v246 offset:27136
    ds_read_b64_tr_b16 v[204:205], v246 offset:37888
    ds_read_b64_tr_b16 v[206:207], v246 offset:38400
    ds_read_b64_tr_b16 v[208:209], v246 offset:39936
    ds_read_b64_tr_b16 v[210:211], v246 offset:40448
    ds_read_b64_tr_b16 v[212:213], v246 offset:41984
    ds_read_b64_tr_b16 v[214:215], v246 offset:42496
    ds_read_b64_tr_b16 v[216:217], v246 offset:44032
    ds_read_b64_tr_b16 v[218:219], v246 offset:44544
    ds_read_b64_tr_b16 v[220:221], v246 offset:55296
    ds_read_b64_tr_b16 v[222:223], v246 offset:55808
    ds_read_b64_tr_b16 v[224:225], v246 offset:57344
    ds_read_b64_tr_b16 v[226:227], v246 offset:57856
    ds_read_b64_tr_b16 v[228:229], v246 offset:59392
    ds_read_b64_tr_b16 v[230:231], v246 offset:59904
    ds_read_b64_tr_b16 v[232:233], v246 offset:61440
    ds_read_b64_tr_b16 v[234:235], v246 offset:61952
    ds_read_b64_tr_b16 v[236:237], v246 offset:63488
    ds_read_b64_tr_b16 v[238:239], v246 offset:64000
    s_waitcnt lgkmcnt(0)
    s_barrier
    s_barrier
    ds_read_b128 v[48:51], v242 offset:24912
    ds_read_b128 v[52:55], v242 offset:29520
    ds_read_b128 v[56:59], v242 offset:24944
    ds_read_b128 v[60:63], v242 offset:29552
    ds_read_b128 v[64:67], v242 offset:24976
    ds_read_b128 v[68:71], v242 offset:29584
    s_waitcnt lgkmcnt(4)
    v_mfma_f32_32x32x16_bf16 v[0:15], v[96:99], v[48:51], v[0:15]
    ds_read_b128 v[72:75], v242 offset:25008
    ds_read_b128 v[76:79], v242 offset:29616
    v_mfma_f32_32x32x16_bf16 v[16:31], v[96:99], v[52:55], v[16:31]
    s_waitcnt lgkmcnt(4)
    v_mfma_f32_32x32x16_bf16 v[0:15], v[100:103], v[56:59], v[0:15]
    v_mfma_f32_32x32x16_bf16 v[16:31], v[100:103], v[60:63], v[16:31]
    s_waitcnt lgkmcnt(2)
    v_mfma_f32_32x32x16_bf16 v[0:15], v[104:107], v[64:67], v[0:15]
    s_barrier
    ds_read_b128 v[48:51], v240 offset:0
    ds_read_b128 v[52:55], v240 offset:4608
    ds_read_b128 v[56:59], v240 offset:32
    ds_read_b128 v[60:63], v240 offset:4640
    v_mfma_f32_32x32x16_bf16 v[16:31], v[104:107], v[68:71], v[16:31]
    s_waitcnt lgkmcnt(4)
    v_mfma_f32_32x32x16_bf16 v[0:15], v[108:111], v[72:75], v[0:15]
    ds_read_b128 v[64:67], v240 offset:64
    ds_read_b128 v[68:71], v240 offset:4672
    v_mfma_f32_32x32x16_bf16 v[16:31], v[108:111], v[76:79], v[16:31]
    s_waitcnt lgkmcnt(4)
    v_mfma_f32_32x32x16_bf16 v[0:15], v[112:115], v[48:51], v[0:15]
    ds_read_b128 v[72:75], v240 offset:96
    ds_read_b128 v[76:79], v240 offset:4704
    v_mfma_f32_32x32x16_bf16 v[16:31], v[112:115], v[52:55], v[16:31]
    s_waitcnt lgkmcnt(4)
    v_mfma_f32_32x32x16_bf16 v[0:15], v[116:119], v[56:59], v[0:15]
    ds_read_b128 v[48:51], v240 offset:128
    ds_read_b128 v[52:55], v240 offset:4736
    v_mfma_f32_32x32x16_bf16 v[16:31], v[116:119], v[60:63], v[16:31]
    s_waitcnt lgkmcnt(4)
    v_mfma_f32_32x32x16_bf16 v[0:15], v[120:123], v[64:67], v[0:15]
    s_barrier
    ds_read_b128 v[56:59], v240 offset:18448
    ds_read_b128 v[60:63], v240 offset:23056
    v_mfma_f32_32x32x16_bf16 v[16:31], v[120:123], v[68:71], v[16:31]
    s_waitcnt lgkmcnt(4)
    v_mfma_f32_32x32x16_bf16 v[0:15], v[124:127], v[72:75], v[0:15]
    ds_read_b128 v[64:67], v240 offset:18480
    ds_read_b128 v[68:71], v240 offset:23088
    v_mfma_f32_32x32x16_bf16 v[16:31], v[124:127], v[76:79], v[16:31]
    s_waitcnt lgkmcnt(4)
    v_mfma_f32_32x32x16_bf16 v[0:15], v[128:131], v[48:51], v[0:15]
    ds_read_b128 v[72:75], v240 offset:18512
    ds_read_b128 v[76:79], v240 offset:23120
    v_mfma_f32_32x32x16_bf16 v[16:31], v[128:131], v[52:55], v[16:31]
    s_waitcnt lgkmcnt(4)
    v_mfma_f32_32x32x16_bf16 v[0:15], v[132:135], v[56:59], v[0:15]
    ds_read_b128 v[48:51], v240 offset:18544
    ds_read_b128 v[52:55], v240 offset:23152
    v_mfma_f32_32x32x16_bf16 v[16:31], v[132:135], v[60:63], v[16:31]
    s_waitcnt lgkmcnt(4)
    v_mfma_f32_32x32x16_bf16 v[0:15], v[136:139], v[64:67], v[0:15]
    v_mfma_f32_32x32x16_bf16 v[16:31], v[136:139], v[68:71], v[16:31]
    s_waitcnt lgkmcnt(2)
    v_mfma_f32_32x32x16_bf16 v[0:15], v[140:143], v[72:75], v[0:15]
    s_barrier
    ds_read_b128 v[56:59], v242 offset:43328
    ds_read_b128 v[60:63], v242 offset:47936
    ds_read_b128 v[64:67], v242 offset:43360
    ds_read_b128 v[68:71], v242 offset:47968
    v_mfma_f32_32x32x16_bf16 v[16:31], v[140:143], v[76:79], v[16:31]
    s_waitcnt lgkmcnt(4)
    v_mfma_f32_32x32x16_bf16 v[0:15], v[144:147], v[48:51], v[0:15]
    ds_read_b128 v[72:75], v242 offset:43392
    ds_read_b128 v[76:79], v242 offset:48000
    v_mfma_f32_32x32x16_bf16 v[16:31], v[144:147], v[52:55], v[16:31]
    s_waitcnt lgkmcnt(4)
    v_mfma_f32_32x32x16_bf16 v[0:15], v[148:151], v[56:59], v[0:15]
    ds_read_b128 v[48:51], v242 offset:43424
    ds_read_b128 v[52:55], v242 offset:48032
    v_mfma_f32_32x32x16_bf16 v[16:31], v[148:151], v[60:63], v[16:31]
    s_waitcnt lgkmcnt(4)
    v_mfma_f32_32x32x16_bf16 v[0:15], v[152:155], v[64:67], v[0:15]
    ds_read_b128 v[56:59], v242 offset:43456
    ds_read_b128 v[60:63], v242 offset:48064
    v_mfma_f32_32x32x16_bf16 v[16:31], v[152:155], v[68:71], v[16:31]
    s_waitcnt lgkmcnt(4)
    v_mfma_f32_32x32x16_bf16 v[0:15], v[156:159], v[72:75], v[0:15]
    s_barrier
    ds_read_b128 v[64:67], v241 offset:16
    ds_read_b128 v[68:71], v241 offset:4624
    v_mfma_f32_32x32x16_bf16 v[16:31], v[156:159], v[76:79], v[16:31]
    s_waitcnt lgkmcnt(4)
    v_mfma_f32_32x32x16_bf16 v[0:15], v[160:163], v[48:51], v[0:15]
    ds_read_b128 v[72:75], v241 offset:48
    ds_read_b128 v[76:79], v241 offset:4656
    v_mfma_f32_32x32x16_bf16 v[16:31], v[160:163], v[52:55], v[16:31]
    s_waitcnt lgkmcnt(4)
    v_mfma_f32_32x32x16_bf16 v[0:15], v[164:167], v[56:59], v[0:15]
    ds_read_b128 v[48:51], v241 offset:80
    ds_read_b128 v[52:55], v241 offset:4688
    v_mfma_f32_32x32x16_bf16 v[16:31], v[164:167], v[60:63], v[16:31]
    s_waitcnt lgkmcnt(4)
    v_mfma_f32_32x32x16_bf16 v[0:15], v[168:171], v[64:67], v[0:15]
    ds_read_b128 v[56:59], v241 offset:112
    ds_read_b128 v[60:63], v241 offset:4720
    v_mfma_f32_32x32x16_bf16 v[16:31], v[168:171], v[68:71], v[16:31]
    s_waitcnt lgkmcnt(4)
    v_mfma_f32_32x32x16_bf16 v[0:15], v[172:175], v[72:75], v[0:15]
    v_mfma_f32_32x32x16_bf16 v[16:31], v[172:175], v[76:79], v[16:31]
    s_waitcnt lgkmcnt(2)
    v_mfma_f32_32x32x16_bf16 v[0:15], v[176:179], v[48:51], v[0:15]
    s_barrier
    ds_read_b128 v[64:67], v241 offset:18432
    ds_read_b128 v[68:71], v241 offset:23040
    ds_read_b128 v[72:75], v241 offset:18464
    ds_read_b128 v[76:79], v241 offset:23072
    v_mfma_f32_32x32x16_bf16 v[16:31], v[176:179], v[52:55], v[16:31]
    s_waitcnt lgkmcnt(4)
    v_mfma_f32_32x32x16_bf16 v[0:15], v[180:183], v[56:59], v[0:15]
    ds_read_b128 v[48:51], v241 offset:18496
    ds_read_b128 v[52:55], v241 offset:23104
    v_mfma_f32_32x32x16_bf16 v[16:31], v[180:183], v[60:63], v[16:31]
    s_waitcnt lgkmcnt(4)
    v_mfma_f32_32x32x16_bf16 v[0:15], v[184:187], v[64:67], v[0:15]
    ds_read_b128 v[56:59], v241 offset:18528
    ds_read_b128 v[60:63], v241 offset:23136
    v_mfma_f32_32x32x16_bf16 v[16:31], v[184:187], v[68:71], v[16:31]
    s_waitcnt lgkmcnt(4)
    v_mfma_f32_32x32x16_bf16 v[0:15], v[188:191], v[72:75], v[0:15]
    ds_read_b128 v[64:67], v241 offset:18560
    ds_read_b128 v[68:71], v241 offset:23168
    v_mfma_f32_32x32x16_bf16 v[16:31], v[188:191], v[76:79], v[16:31]
    s_waitcnt lgkmcnt(4)
    v_mfma_f32_32x32x16_bf16 v[0:15], v[192:195], v[48:51], v[0:15]
    s_barrier
    ds_read_b128 v[72:75], v241 offset:36880
    ds_read_b128 v[76:79], v241 offset:41488
    v_mfma_f32_32x32x16_bf16 v[16:31], v[192:195], v[52:55], v[16:31]
    s_waitcnt lgkmcnt(4)
    v_mfma_f32_32x32x16_bf16 v[0:15], v[196:199], v[56:59], v[0:15]
    ds_read_b128 v[48:51], v241 offset:36912
    ds_read_b128 v[52:55], v241 offset:41520
    v_mfma_f32_32x32x16_bf16 v[16:31], v[196:199], v[60:63], v[16:31]
    s_waitcnt lgkmcnt(4)
    v_mfma_f32_32x32x16_bf16 v[0:15], v[200:203], v[64:67], v[0:15]
    ds_read_b128 v[56:59], v241 offset:36944
    ds_read_b128 v[60:63], v241 offset:41552
    v_mfma_f32_32x32x16_bf16 v[16:31], v[200:203], v[68:71], v[16:31]
    s_waitcnt lgkmcnt(4)
    v_mfma_f32_32x32x16_bf16 v[0:15], v[204:207], v[72:75], v[0:15]
    ds_read_b128 v[64:67], v241 offset:36976
    ds_read_b128 v[68:71], v241 offset:41584
    v_mfma_f32_32x32x16_bf16 v[16:31], v[204:207], v[76:79], v[16:31]
    s_waitcnt lgkmcnt(4)
    v_mfma_f32_32x32x16_bf16 v[0:15], v[208:211], v[48:51], v[0:15]
    v_mfma_f32_32x32x16_bf16 v[16:31], v[208:211], v[52:55], v[16:31]
    s_waitcnt lgkmcnt(2)
    v_mfma_f32_32x32x16_bf16 v[0:15], v[212:215], v[56:59], v[0:15]
    s_barrier
    ds_read_b128 v[72:75], v242 offset:6144
    ds_read_b128 v[76:79], v242 offset:10752
    ds_read_b128 v[48:51], v242 offset:6176
    ds_read_b128 v[52:55], v242 offset:10784
    v_mfma_f32_32x32x16_bf16 v[16:31], v[212:215], v[60:63], v[16:31]
    s_waitcnt lgkmcnt(4)
    v_mfma_f32_32x32x16_bf16 v[0:15], v[216:219], v[64:67], v[0:15]
    ds_read_b128 v[56:59], v242 offset:6208
    ds_read_b128 v[60:63], v242 offset:10816
    v_mfma_f32_32x32x16_bf16 v[16:31], v[216:219], v[68:71], v[16:31]
    s_waitcnt lgkmcnt(4)
    v_mfma_f32_32x32x16_bf16 v[0:15], v[220:223], v[72:75], v[0:15]
    ds_read_b128 v[64:67], v242 offset:6240
    ds_read_b128 v[68:71], v242 offset:10848
    v_mfma_f32_32x32x16_bf16 v[16:31], v[220:223], v[76:79], v[16:31]
    s_waitcnt lgkmcnt(4)
    v_mfma_f32_32x32x16_bf16 v[0:15], v[224:227], v[48:51], v[0:15]
    ds_read_b128 v[72:75], v242 offset:6272
    ds_read_b128 v[76:79], v242 offset:10880
    v_mfma_f32_32x32x16_bf16 v[16:31], v[224:227], v[52:55], v[16:31]
    s_waitcnt lgkmcnt(4)
    v_mfma_f32_32x32x16_bf16 v[0:15], v[228:231], v[56:59], v[0:15]
    v_mfma_f32_32x32x16_bf16 v[16:31], v[228:231], v[60:63], v[16:31]
    s_waitcnt lgkmcnt(2)
    v_mfma_f32_32x32x16_bf16 v[0:15], v[232:235], v[64:67], v[0:15]
    v_mfma_f32_32x32x16_bf16 v[16:31], v[232:235], v[68:71], v[16:31]
    s_waitcnt lgkmcnt(0)
    v_mfma_f32_32x32x16_bf16 v[0:15], v[236:239], v[72:75], v[0:15]
    v_mfma_f32_32x32x16_bf16 v[16:31], v[236:239], v[76:79], v[16:31]
    s_nop 10
    ds_write_b128 v247, v[0:3] offset:0
    ds_write_b128 v247, v[4:7] offset:1024
    ds_write_b128 v247, v[8:11] offset:2048
    ds_write_b128 v247, v[12:15] offset:3072
    s_waitcnt lgkmcnt(0)
    s_barrier
    ds_read_b128 v[48:51], v249 offset:0
    ds_read_b128 v[52:55], v249 offset:1024
    ds_read_b128 v[56:59], v249 offset:2048
    ds_read_b128 v[60:63], v249 offset:3072
    s_waitcnt lgkmcnt(3)
    v_pk_add_f32 v[16:17], v[16:17], v[48:49]
    v_pk_add_f32 v[18:19], v[18:19], v[50:51]
    v_cvt_pk_bf16_f32 v104, v16, v17
    v_cvt_pk_bf16_f32 v105, v18, v19
    ds_write_b64 v250, v[104:105] offset:4608
    s_waitcnt lgkmcnt(3)
    v_pk_add_f32 v[20:21], v[20:21], v[52:53]
    v_pk_add_f32 v[22:23], v[22:23], v[54:55]
    v_cvt_pk_bf16_f32 v106, v20, v21
    v_cvt_pk_bf16_f32 v107, v22, v23
    ds_write_b64 v250, v[106:107] offset:4624
    s_waitcnt lgkmcnt(3)
    v_pk_add_f32 v[24:25], v[24:25], v[56:57]
    v_pk_add_f32 v[26:27], v[26:27], v[58:59]
    v_cvt_pk_bf16_f32 v108, v24, v25
    v_cvt_pk_bf16_f32 v109, v26, v27
    ds_write_b64 v250, v[108:109] offset:4640
    s_waitcnt lgkmcnt(3)
    v_pk_add_f32 v[28:29], v[28:29], v[60:61]
    v_pk_add_f32 v[30:31], v[30:31], v[62:63]
    v_cvt_pk_bf16_f32 v110, v28, v29
    v_cvt_pk_bf16_f32 v111, v30, v31
    ds_write_b64 v250, v[110:111] offset:4656
    s_waitcnt lgkmcnt(0)
    s_barrier
    s_branch L12_P3_store
L12_P3A_loader:
    ds_read_b128 v[20:23], v253 offset:0
    ds_read_b128 v[24:27], v253 offset:1024
    ds_read_b128 v[28:31], v253 offset:2048
    ds_read_b128 v[32:35], v253 offset:3072
    ds_read_b128 v[36:39], v253 offset:4096
    s_mov_b32 s8, s4
    s_mov_b32 s9, s5
    s_mov_b32 s10, 663552
    s_mov_b32 s11, 0x20000
    s_mov_b32 s30, 4096
    v_mov_b32 v16, s42
    s_waitcnt lgkmcnt(4)
    buffer_store_dwordx4 v[20:23], v248, s[44:47], 0 offen offset:0 sc1
    s_waitcnt lgkmcnt(3)
    buffer_store_dwordx4 v[24:27], v248, s[44:47], 0 offen offset:1024 sc1
    s_waitcnt lgkmcnt(2)
    buffer_store_dwordx4 v[28:31], v248, s[44:47], 0 offen offset:2048 sc1
    s_waitcnt lgkmcnt(1)
    buffer_store_dwordx4 v[32:35], v248, s[44:47], 0 offen offset:3072 sc1
    s_waitcnt lgkmcnt(0)
    buffer_store_dwordx4 v[36:39], v248, s[44:47], s30 offen offset:0 sc1
    s_cmp_lg_u32 s43, 0
    s_cbranch_scc1 L12_P3A_tile
    s_waitcnt vmcnt(0)
    s_mov_b64 exec, 1
    buffer_store_dword v16, v252, s[16:19], 0 offen sc1
    s_mov_b64 exec, -1
    s_branch L12_P3_fin
L12_P3A_tile:
    s_mov_b64 exec, s[64:65]
    buffer_load_dword v17, v250, s[16:19], 0 offen sc1
    s_mov_b64 exec, -1
    s_barrier
    s_mov_b32 s75, 0
    s_add_u32 m0, s77, 49152
    s_nop 0
    buffer_load_dwordx4 v241, s[8:11], s75 offen lds
    s_mov_b32 s75, 36864
    s_add_u32 m0, s77, 53248
    s_nop 0
    buffer_load_dwordx4 v241, s[8:11], s75 offen lds
    s_mov_b32 s75, 73728
    s_add_u32 m0, s77, 57344
    s_nop 0
    buffer_load_dwordx4 v241, s[8:11], s75 offen lds
    s_mov_b32 s75, 110592
    s_add_u32 m0, s77, 61440
    s_nop 0
    buffer_load_dwordx4 v241, s[8:11], s75 offen lds
    s_mov_b32 s75, 147456
    s_add_u32 m0, s77, 65536
    s_nop 0
    buffer_load_dwordx4 v241, s[8:11], s75 offen lds
    s_waitcnt vmcnt(5)
    s_mov_b64 exec, 1
    buffer_store_dword v16, v252, s[16:19], 0 offen sc1
    s_mov_b64 exec, -1
    s_mov_b32 s75, 184320
    s_add_u32 m0, s77, 69632
    s_nop 0
    buffer_load_dwordx4 v241, s[8:11], s75 offen lds
    s_mov_b32 s75, 221184
    s_add_u32 m0, s77, 73728
    s_nop 0
    buffer_load_dwordx4 v241, s[8:11], s75 offen lds
    s_mov_b32 s75, 258048
    s_add_u32 m0, s77, 77824
    s_nop 0
    buffer_load_dwordx4 v241, s[8:11], s75 offen lds
    s_mov_b32 s75, 294912
    s_add_u32 m0, s77, 81920
    s_nop 0
    buffer_load_dwordx4 v241, s[8:11], s75 offen lds
    s_mov_b32 s75, 331776
    s_add_u32 m0, s77, 86016
    s_nop 0
    buffer_load_dwordx4 v241, s[8:11], s75 offen lds
    s_mov_b32 s75, 368640
    s_add_u32 m0, s77, 90112
    s_nop 0
    buffer_load_dwordx4 v241, s[8:11], s75 offen lds
    s_mov_b32 s75, 405504
    s_add_u32 m0, s77, 94208
    s_nop 0
    buffer_load_dwordx4 v241, s[8:11], s75 offen lds
    s_mov_b32 s75, 442368
    s_add_u32 m0, s77, 98304
    s_nop 0
    buffer_load_dwordx4 v241, s[8:11], s75 offen lds
    s_mov_b32 s75, 479232
    s_add_u32 m0, s77, 102400
    s_nop 0
    buffer_load_dwordx4 v241, s[8:11], s75 offen lds
    s_mov_b32 s75, 516096
    s_add_u32 m0, s77, 106496
    s_nop 0
    buffer_load_dwordx4 v241, s[8:11], s75 offen lds
    s_mov_b32 s75, 552960
    s_add_u32 m0, s77, 110592
    s_nop 0
    buffer_load_dwordx4 v241, s[8:11], s75 offen lds
    s_mov_b32 s75, 589824
    s_add_u32 m0, s77, 114688
    s_nop 0
    buffer_load_dwordx4 v241, s[8:11], s75 offen lds
    s_mov_b32 s75, 626688
    s_add_u32 m0, s77, 118784
    s_nop 0
    buffer_load_dwordx4 v241, s[8:11], s75 offen lds
    s_mov_b64 exec, s[64:65]
    v_cmp_ne_u32 vcc, s42, v17
    s_cbranch_vccz L12_P3A_bready
    s_waitcnt vmcnt(0)
    s_barrier
    s_mov_b32 s30, 20000
L_poll_OA1:
    buffer_load_dword v17, v250, s[16:19], 0 offen sc1
    s_waitcnt vmcnt(0)
    v_cmp_ne_u32 vcc, s42, v17
    s_cbranch_vccz L_polled_OA1
    s_sleep 1
    s_sub_u32 s30, s30, 1
    s_cmp_lg_u32 s30, 0
    s_cbranch_scc1 L_poll_OA1
L_polled_OA1:
    s_mov_b64 exec, -1
    s_mov_b32 s75, 2359296
    s_add_u32 m0, s77, 123200
    s_nop 0
    buffer_load_dwordx4 v242, s[16:19], s75 offen sc1 lds
    s_add_u32 m0, s77, 127296
    s_nop 0
    buffer_load_dwordx4 v243, s[16:19], s75 offen sc1 lds
    s_add_u32 m0, s77, 131392
    s_nop 0
    buffer_load_dwordx4 v244, s[16:19], s75 offen sc1 lds
    s_add_u32 m0, s77, 135488
    s_nop 0
    buffer_load_dwordx4 v245, s[16:19], s75 offen sc1 lds
    s_add_u32 m0, s70, 139584
    s_mov_b64 exec, s[68:69]
    buffer_load_dwordx4 v246, s[16:19], s75 offen sc1 lds
    s_mov_b64 exec, -1
    s_branch L12_P3A_join
L12_P3A_bready:
    s_mov_b64 exec, -1
    s_waitcnt vmcnt(0)
    s_barrier
    s_mov_b32 s75, 2359296
    s_add_u32 m0, s77, 123200
    s_nop 0
    buffer_load_dwordx4 v242, s[16:19], s75 offen sc1 lds
    s_add_u32 m0, s77, 127296
    s_nop 0
    buffer_load_dwordx4 v243, s[16:19], s75 offen sc1 lds
    s_add_u32 m0, s77, 131392
    s_nop 0
    buffer_load_dwordx4 v244, s[16:19], s75 offen sc1 lds
    s_add_u32 m0, s77, 135488
    s_nop 0
    buffer_load_dwordx4 v245, s[16:19], s75 offen sc1 lds
    s_add_u32 m0, s70, 139584
    s_mov_b64 exec, s[68:69]
    buffer_load_dwordx4 v246, s[16:19], s75 offen sc1 lds
    s_mov_b64 exec, -1
L12_P3A_join:
    s_mov_b32 s75, 2949120
    s_add_u32 m0, s77, 0
    s_nop 0
    buffer_load_dwordx4 v242, s[16:19], s75 offen sc1 lds
    s_add_u32 m0, s77, 4096
    s_nop 0
    buffer_load_dwordx4 v243, s[16:19], s75 offen sc1 lds
    s_add_u32 m0, s77, 8192
    s_nop 0
    buffer_load_dwordx4 v244, s[16:19], s75 offen sc1 lds
    s_add_u32 m0, s77, 12288
    s_nop 0
    buffer_load_dwordx4 v245, s[16:19], s75 offen sc1 lds
    s_add_u32 m0, s70, 16384
    s_mov_b64 exec, s[68:69]
    buffer_load_dwordx4 v246, s[16:19], s75 offen sc1 lds
    s_mov_b64 exec, -1
    s_mov_b64 exec, s[66:67]
    buffer_load_dword v17, v250, s[16:19], 0 offen sc1
    s_mov_b64 exec, -1
    s_barrier
    s_mov_b32 s75, 3538944
    s_add_u32 m0, s77, 18432
    s_nop 0
    buffer_load_dwordx4 v242, s[16:19], s75 offen sc1 lds
    s_add_u32 m0, s77, 22528
    s_nop 0
    buffer_load_dwordx4 v243, s[16:19], s75 offen sc1 lds
    s_add_u32 m0, s77, 26624
    s_nop 0
    buffer_load_dwordx4 v244, s[16:19], s75 offen sc1 lds
    s_add_u32 m0, s77, 30720
    s_nop 0
    buffer_load_dwordx4 v245, s[16:19], s75 offen sc1 lds
    s_add_u32 m0, s70, 34816
    s_mov_b64 exec, s[68:69]
    buffer_load_dwordx4 v246, s[16:19], s75 offen sc1 lds
    s_mov_b64 exec, -1
    s_waitcnt vmcnt(11)
    s_barrier
    s_mov_b32 s75, 4128768
    s_add_u32 m0, s77, 141632
    s_nop 0
    buffer_load_dwordx4 v242, s[16:19], s75 offen sc1 lds
    s_add_u32 m0, s77, 145728
    s_nop 0
    buffer_load_dwordx4 v243, s[16:19], s75 offen sc1 lds
    s_add_u32 m0, s77, 149824
    s_nop 0
    buffer_load_dwordx4 v244, s[16:19], s75 offen sc1 lds
    s_add_u32 m0, s77, 153920
    s_nop 0
    buffer_load_dwordx4 v245, s[16:19], s75 offen sc1 lds
    s_add_u32 m0, s70, 158016
    s_mov_b64 exec, s[68:69]
    buffer_load_dwordx4 v246, s[16:19], s75 offen sc1 lds
    s_mov_b64 exec, -1
    s_waitcnt vmcnt(10)
    s_barrier
    s_mov_b64 exec, s[66:67]
    v_cmp_ne_u32 vcc, s42, v17
    s_cbranch_vccz L12_P3A_aready
    s_waitcnt vmcnt(5)
    s_barrier
    s_mov_b32 s30, 20000
L_poll_OA2:
    buffer_load_dword v17, v250, s[16:19], 0 offen sc1
    s_waitcnt vmcnt(0)
    v_cmp_ne_u32 vcc, s42, v17
    s_cbranch_vccz L_polled_OA2
    s_sleep 1
    s_sub_u32 s30, s30, 1
    s_cmp_lg_u32 s30, 0
    s_cbranch_scc1 L_poll_OA2
L_polled_OA2:
    s_mov_b64 exec, -1
    s_mov_b32 s75, 0
    s_add_u32 m0, s77, 49152
    s_nop 0
    buffer_load_dwordx4 v242, s[16:19], s75 offen sc1 lds
    s_add_u32 m0, s77, 53248
    s_nop 0
    buffer_load_dwordx4 v243, s[16:19], s75 offen sc1 lds
    s_add_u32 m0, s77, 57344
    s_nop 0
    buffer_load_dwordx4 v244, s[16:19], s75 offen sc1 lds
    s_add_u32 m0, s77, 61440
    s_nop 0
    buffer_load_dwordx4 v245, s[16:19], s75 offen sc1 lds
    s_add_u32 m0, s70, 65536
    s_mov_b64 exec, s[68:69]
    buffer_load_dwordx4 v246, s[16:19], s75 offen sc1 lds
    s_mov_b64 exec, -1
    s_barrier
    s_mov_b32 s75, 589824
    s_add_u32 m0, s77, 67584
    s_nop 0
    buffer_load_dwordx4 v242, s[16:19], s75 offen sc1 lds
    s_add_u32 m0, s77, 71680
    s_nop 0
    buffer_load_dwordx4 v243, s[16:19], s75 offen sc1 lds
    s_add_u32 m0, s77, 75776
    s_nop 0
    buffer_load_dwordx4 v244, s[16:19], s75 offen sc1 lds
    s_add_u32 m0, s77, 79872
    s_nop 0
    buffer_load_dwordx4 v245, s[16:19], s75 offen sc1 lds
    s_add_u32 m0, s70, 83968
    s_mov_b64 exec, s[68:69]
    buffer_load_dwordx4 v246, s[16:19], s75 offen sc1 lds
    s_mov_b64 exec, -1
    s_branch L12_P3A_join2
L12_P3A_aready:
    s_mov_b64 exec, -1
    s_mov_b32 s75, 0
    s_add_u32 m0, s77, 49152
    s_nop 0
    buffer_load_dwordx4 v242, s[16:19], s75 offen sc1 lds
    s_add_u32 m0, s77, 53248
    s_nop 0
    buffer_load_dwordx4 v243, s[16:19], s75 offen sc1 lds
    s_add_u32 m0, s77, 57344
    s_nop 0
    buffer_load_dwordx4 v244, s[16:19], s75 offen sc1 lds
    s_add_u32 m0, s77, 61440
    s_nop 0
    buffer_load_dwordx4 v245, s[16:19], s75 offen sc1 lds
    s_add_u32 m0, s70, 65536
    s_mov_b64 exec, s[68:69]
    buffer_load_dwordx4 v246, s[16:19], s75 offen sc1 lds
    s_mov_b64 exec, -1
    s_waitcnt vmcnt(10)
    s_barrier
    s_mov_b32 s75, 589824
    s_add_u32 m0, s77, 67584
    s_nop 0
    buffer_load_dwordx4 v242, s[16:19], s75 offen sc1 lds
    s_add_u32 m0, s77, 71680
    s_nop 0
    buffer_load_dwordx4 v243, s[16:19], s75 offen sc1 lds
    s_add_u32 m0, s77, 75776
    s_nop 0
    buffer_load_dwordx4 v244, s[16:19], s75 offen sc1 lds
    s_add_u32 m0, s77, 79872
    s_nop 0
    buffer_load_dwordx4 v245, s[16:19], s75 offen sc1 lds
    s_add_u32 m0, s70, 83968
    s_mov_b64 exec, s[68:69]
    buffer_load_dwordx4 v246, s[16:19], s75 offen sc1 lds
    s_mov_b64 exec, -1
    s_waitcnt vmcnt(10)
    s_barrier
L12_P3A_join2:
    s_mov_b32 s75, 1179648
    s_add_u32 m0, s77, 86016
    s_nop 0
    buffer_load_dwordx4 v242, s[16:19], s75 offen sc1 lds
    s_add_u32 m0, s77, 90112
    s_nop 0
    buffer_load_dwordx4 v243, s[16:19], s75 offen sc1 lds
    s_add_u32 m0, s77, 94208
    s_nop 0
    buffer_load_dwordx4 v244, s[16:19], s75 offen sc1 lds
    s_add_u32 m0, s77, 98304
    s_nop 0
    buffer_load_dwordx4 v245, s[16:19], s75 offen sc1 lds
    s_add_u32 m0, s70, 102400
    s_mov_b64 exec, s[68:69]
    buffer_load_dwordx4 v246, s[16:19], s75 offen sc1 lds
    s_mov_b64 exec, -1
    s_waitcnt vmcnt(10)
    s_barrier
    s_mov_b32 s75, 1769472
    s_add_u32 m0, s77, 104448
    s_nop 0
    buffer_load_dwordx4 v242, s[16:19], s75 offen sc1 lds
    s_add_u32 m0, s77, 108544
    s_nop 0
    buffer_load_dwordx4 v243, s[16:19], s75 offen sc1 lds
    s_add_u32 m0, s77, 112640
    s_nop 0
    buffer_load_dwordx4 v244, s[16:19], s75 offen sc1 lds
    s_add_u32 m0, s77, 116736
    s_nop 0
    buffer_load_dwordx4 v245, s[16:19], s75 offen sc1 lds
    s_add_u32 m0, s70, 120832
    s_mov_b64 exec, s[68:69]
    buffer_load_dwordx4 v246, s[16:19], s75 offen sc1 lds
    s_mov_b64 exec, -1
    s_waitcnt vmcnt(10)
    s_barrier
    s_waitcnt vmcnt(5)
    s_barrier
    s_waitcnt vmcnt(0)
    s_barrier
    s_mov_b32 s20, s54
    s_mov_b32 s21, s55
    s_mov_b32 s22, 2359296
    s_mov_b32 s23, 0x20000
    s_lshl_b32 s30, s28, 3
    v_lshrrev_b32 v2, 3, v255
    v_add_u32 v2, s30, v2
    v_and_b32 v3, 7, v255
    v_lshlrev_b32 v3, 4, v3
    v_mul_u32_u24 v251, 144, v2
    s_mov_b32 s30, 24576
    v_add3_u32 v251, v251, v3, s30
    v_add_u32 v2, s84, v2
    v_mul_u32_u24 v2, 1152, v2
    s_lshl_b32 s30, s85, 7
    v_add3_u32 v252, v2, v3, s30
    s_mov_b32 s73, 73728
    s_lshl_b32 s72, s26, 2
    s_barrier
    s_barrier
    s_branch L12_P3_store
L12_recover:
    s_mov_b32 s20, s58
    s_mov_b32 s21, s59
    s_mov_b32 s23, 0x20000
    s_lshl_b32 s35, s27, 2
    s_add_u32 s35, s35, s36
    s_mul_i32 s35, s35, 163840
    s_mul_i32 s33, s36, 30800
    s_lshr_b32 s34, s28, 2
    s_lshl_b32 s34, s34, 10
    s_add_u32 s35, s35, s34
    s_add_u32 s33, s33, s34
    s_cmp_ge_u32 s24, 0
    s_cselect_b32 s22, 268435456, 0
    s_cselect_b32 s32, s24, 0
    s_sub_u32 s32, s32, 0
    s_mul_i32 s32, s32, 10240
    s_add_u32 s32, s32, s35
    s_add_u32 m0, s33, 4096
    s_nop 0
    buffer_load_dwordx4 v239, s[20:23], s32 offen sc1 lds
    s_add_u32 s32, s32, 2048
    s_add_u32 m0, s33, 10256
    s_nop 0
    buffer_load_dwordx4 v239, s[20:23], s32 offen sc1 lds
    s_add_u32 s32, s32, 2048
    s_add_u32 m0, s33, 16416
    s_nop 0
    buffer_load_dwordx4 v239, s[20:23], s32 offen sc1 lds
    s_add_u32 s32, s32, 2048
    s_add_u32 m0, s33, 22576
    s_nop 0
    buffer_load_dwordx4 v239, s[20:23], s32 offen sc1 lds
    s_add_u32 s32, s32, 2048
    s_add_u32 m0, s33, 28736
    s_nop 0
    buffer_load_dwordx4 v239, s[20:23], s32 offen sc1 lds
    s_cmp_ge_u32 s24, 1
    s_cselect_b32 s22, 268435456, 0
    s_cselect_b32 s32, s24, 1
    s_sub_u32 s32, s32, 1
    s_mul_i32 s32, s32, 10240
    s_add_u32 s32, s32, s35
    s_add_u32 m0, s33, 2048
    s_nop 0
    buffer_load_dwordx4 v239, s[20:23], s32 offen sc1 lds
    s_add_u32 s32, s32, 2048
    s_add_u32 m0, s33, 8208
    s_nop 0
    buffer_load_dwordx4 v239, s[20:23], s32 offen sc1 lds
    s_add_u32 s32, s32, 2048
    s_add_u32 m0, s33, 14368
    s_nop 0
    buffer_load_dwordx4 v239, s[20:23], s32 offen sc1 lds
    s_add_u32 s32, s32, 2048
    s_add_u32 m0, s33, 20528
    s_nop 0
    buffer_load_dwordx4 v239, s[20:23], s32 offen sc1 lds
    s_add_u32 s32, s32, 2048
    s_add_u32 m0, s33, 26688
    s_nop 0
    buffer_load_dwordx4 v239, s[20:23], s32 offen sc1 lds
    s_cmp_ge_u32 s24, 2
    s_cselect_b32 s22, 268435456, 0
    s_cselect_b32 s32, s24, 2
    s_sub_u32 s32, s32, 2
    s_mul_i32 s32, s32, 10240
    s_add_u32 s32, s32, s35
    s_add_u32 m0, s33, 0
    s_nop 0
    buffer_load_dwordx4 v239, s[20:23], s32 offen sc1 lds
    s_add_u32 s32, s32, 2048
    s_add_u32 m0, s33, 6160
    s_nop 0
    buffer_load_dwordx4 v239, s[20:23], s32 offen sc1 lds
    s_add_u32 s32, s32, 2048
    s_add_u32 m0, s33, 12320
    s_nop 0
    buffer_load_dwordx4 v239, s[20:23], s32 offen sc1 lds
    s_add_u32 s32, s32, 2048
    s_add_u32 m0, s33, 18480
    s_nop 0
    buffer_load_dwordx4 v239, s[20:23], s32 offen sc1 lds
    s_add_u32 s32, s32, 2048
    s_add_u32 m0, s33, 24640
    s_nop 0
    buffer_load_dwordx4 v239, s[20:23], s32 offen sc1 lds
    s_waitcnt vmcnt(0)
    s_barrier
    s_lshl_b32 s35, s24, 2
    s_add_u32 s35, s35, s37
    s_sub_u32 s35, 8, s35
    s_max_i32 s35, s35, 0
    v_mov_b32 v150, 0xf149f2ca
    s_mov_b32 s34, s35
    s_add_u32 s32, s35, 0
    s_lshl_b32 s32, s32, 9
    v_add_u32 v147, s32, v222
    v_add_u32 v148, s32, v223
    v_add_u32 v149, s32, v224
L12_slow00:
    ds_read_b128 v[72:75], v147
    ds_read_b128 v[76:79], v148
    s_waitcnt lgkmcnt(0)
    s_cmp_eq_u32 s34, 0
    s_cbranch_scc1 L12_slow00_far
    s_cmp_eq_u32 s34, 8
    s_cbranch_scc1 L12_slow00_diag
    v_mfma_f32_32x32x16_bf16 v[0:15], v[72:75], v[104:107], 0
    s_branch L12_slow00_j
L12_slow00_far:
    v_mfma_f32_32x32x16_bf16 v[0:15], v[72:75], v[104:107], v[206:221]
    s_branch L12_slow00_j
L12_slow00_diag:
    v_mfma_f32_32x32x16_bf16 v[0:15], v[72:75], v[104:107], v[190:205]
L12_slow00_j:
    v_mfma_f32_32x32x16_bf16 v[0:15], v[76:79], v[108:111], v[0:15]
    s_nop 11
    v_max3_f32 v150, v150, v0, v1
    v_max3_f32 v150, v150, v2, v3
    v_max3_f32 v150, v150, v4, v5
    v_max3_f32 v150, v150, v6, v7
    v_max3_f32 v150, v150, v8, v9
    v_max3_f32 v150, v150, v10, v11
    v_max3_f32 v150, v150, v12, v13
    v_max3_f32 v150, v150, v14, v15
    v_add_u32 v147, 512, v147
    v_add_u32 v148, 512, v148
    v_add_u32 v149, 512, v149
    s_nop 11
    s_add_u32 s34, s34, 1
    s_cmp_le_u32 s34, 8
    s_cbranch_scc1 L12_slow00
    v_mov_b32 v151, v150
    s_nop 1
    v_permlane32_swap_b32 v150, v151
    s_nop 1
    v_max_f32 v150, v150, v151
    s_mov_b32 s34, s35
    s_add_u32 s32, s35, 0
    s_lshl_b32 s32, s32, 9
    v_add_u32 v147, s32, v222
    v_add_u32 v148, s32, v223
    v_add_u32 v149, s32, v224
    v_mov_b32 v32, 0
    v_mov_b32 v33, 0
    v_mov_b32 v34, 0
    v_mov_b32 v35, 0
    v_mov_b32 v36, 0
    v_mov_b32 v37, 0
    v_mov_b32 v38, 0
    v_mov_b32 v39, 0
    v_mov_b32 v40, 0
    v_mov_b32 v41, 0
    v_mov_b32 v42, 0
    v_mov_b32 v43, 0
    v_mov_b32 v44, 0
    v_mov_b32 v45, 0
    v_mov_b32 v46, 0
    v_mov_b32 v47, 0
L12_slow01:
    ds_read_b128 v[72:75], v147
    ds_read_b128 v[76:79], v148
    ds_read_b64_tr_b16 v[88:89], v149 offset:0
    ds_read_b64_tr_b16 v[90:91], v149 offset:32
    ds_read_b64_tr_b16 v[92:93], v149 offset:256
    ds_read_b64_tr_b16 v[94:95], v149 offset:288
    s_waitcnt lgkmcnt(0)
    s_cmp_eq_u32 s34, 0
    s_cbranch_scc1 L12_slow01_far
    s_cmp_eq_u32 s34, 8
    s_cbranch_scc1 L12_slow01_diag
    v_mfma_f32_32x32x16_bf16 v[0:15], v[72:75], v[104:107], 0
    s_branch L12_slow01_j
L12_slow01_far:
    v_mfma_f32_32x32x16_bf16 v[0:15], v[72:75], v[104:107], v[206:221]
    s_branch L12_slow01_j
L12_slow01_diag:
    v_mfma_f32_32x32x16_bf16 v[0:15], v[72:75], v[104:107], v[190:205]
L12_slow01_j:
    v_mfma_f32_32x32x16_bf16 v[0:15], v[76:79], v[108:111], v[0:15]
    s_nop 11
    v_sub_f32 v0, v0, v150
    v_sub_f32 v1, v1, v150
    v_sub_f32 v2, v2, v150
    v_sub_f32 v3, v3, v150
    v_sub_f32 v4, v4, v150
    v_sub_f32 v5, v5, v150
    v_sub_f32 v6, v6, v150
    v_sub_f32 v7, v7, v150
    v_sub_f32 v8, v8, v150
    v_sub_f32 v9, v9, v150
    v_sub_f32 v10, v10, v150
    v_sub_f32 v11, v11, v150
    v_sub_f32 v12, v12, v150
    v_sub_f32 v13, v13, v150
    v_sub_f32 v14, v14, v150
    v_sub_f32 v15, v15, v150
    v_exp_f32 v0, v0
    v_exp_f32 v1, v1
    v_exp_f32 v2, v2
    v_exp_f32 v3, v3
    v_exp_f32 v4, v4
    v_exp_f32 v5, v5
    v_exp_f32 v6, v6
    v_exp_f32 v7, v7
    v_exp_f32 v8, v8
    v_exp_f32 v9, v9
    v_exp_f32 v10, v10
    v_exp_f32 v11, v11
    v_exp_f32 v12, v12
    v_exp_f32 v13, v13
    v_exp_f32 v14, v14
    v_exp_f32 v15, v15
    v_cvt_pk_bf16_f32 v64, v0, v1
    v_cvt_pk_bf16_f32 v65, v2, v3
    v_cvt_pk_bf16_f32 v66, v4, v5
    v_cvt_pk_bf16_f32 v67, v6, v7
    v_cvt_pk_bf16_f32 v68, v8, v9
    v_cvt_pk_bf16_f32 v69, v10, v11
    v_cvt_pk_bf16_f32 v70, v12, v13
    v_cvt_pk_bf16_f32 v71, v14, v15
    v_mfma_f32_32x32x16_bf16 v[32:47], v[88:91], v[64:67], v[32:47]
    s_nop 0
    v_mfma_f32_32x32x16_bf16 v[32:47], v[92:95], v[68:71], v[32:47]
    v_add_u32 v147, 512, v147
    v_add_u32 v148, 512, v148
    v_add_u32 v149, 512, v149
    s_nop 11
    s_add_u32 s34, s34, 1
    s_cmp_le_u32 s34, 8
    s_cbranch_scc1 L12_slow01
    v_rcp_f32 v126, v42
    s_nop 0
    v_mul_f32 v126, v126, v120
    v_pk_mul_f32 v[32:33], v[32:33], v[126:127] op_sel_hi:[1,0]
    v_pk_mul_f32 v[34:35], v[34:35], v[126:127] op_sel_hi:[1,0]
    v_pk_mul_f32 v[36:37], v[36:37], v[126:127] op_sel_hi:[1,0]
    v_pk_mul_f32 v[38:39], v[38:39], v[126:127] op_sel_hi:[1,0]
    v_pk_mul_f32 v[40:41], v[40:41], v[126:127] op_sel_hi:[1,0]
    v_cvt_pk_bf16_f32 v64, v32, v33
    v_cvt_pk_bf16_f32 v65, v34, v35
    v_cvt_pk_bf16_f32 v66, v36, v37
    v_cvt_pk_bf16_f32 v67, v38, v39
    v_cvt_pk_bf16_f32 v68, v40, v41
    ds_write2_b32 v225, v64, v65 offset0:0 offset1:1
    ds_write2_b32 v225, v66, v67 offset0:4 offset1:5
    ds_write_b32 v226, v68 offset:32
    s_lshl_b32 s35, s24, 2
    s_add_u32 s35, s35, s38
    s_sub_u32 s35, 8, s35
    s_max_i32 s35, s35, 0
    v_mov_b32 v150, 0xf149f2ca
    s_mov_b32 s34, s35
    s_add_u32 s32, s35, 1
    s_lshl_b32 s32, s32, 9
    v_add_u32 v147, s32, v222
    v_add_u32 v148, s32, v223
    v_add_u32 v149, s32, v224
L12_slow10:
    ds_read_b128 v[72:75], v147
    ds_read_b128 v[76:79], v148
    s_waitcnt lgkmcnt(0)
    s_cmp_eq_u32 s34, 0
    s_cbranch_scc1 L12_slow10_far
    s_cmp_eq_u32 s34, 8
    s_cbranch_scc1 L12_slow10_diag
    v_mfma_f32_32x32x16_bf16 v[0:15], v[72:75], v[112:115], 0
    s_branch L12_slow10_j
L12_slow10_far:
    v_mfma_f32_32x32x16_bf16 v[0:15], v[72:75], v[112:115], v[206:221]
    s_branch L12_slow10_j
L12_slow10_diag:
    v_mfma_f32_32x32x16_bf16 v[0:15], v[72:75], v[112:115], v[190:205]
L12_slow10_j:
    v_mfma_f32_32x32x16_bf16 v[0:15], v[76:79], v[116:119], v[0:15]
    s_nop 11
    v_max3_f32 v150, v150, v0, v1
    v_max3_f32 v150, v150, v2, v3
    v_max3_f32 v150, v150, v4, v5
    v_max3_f32 v150, v150, v6, v7
    v_max3_f32 v150, v150, v8, v9
    v_max3_f32 v150, v150, v10, v11
    v_max3_f32 v150, v150, v12, v13
    v_max3_f32 v150, v150, v14, v15
    v_add_u32 v147, 512, v147
    v_add_u32 v148, 512, v148
    v_add_u32 v149, 512, v149
    s_nop 11
    s_add_u32 s34, s34, 1
    s_cmp_le_u32 s34, 8
    s_cbranch_scc1 L12_slow10
    v_mov_b32 v151, v150
    s_nop 1
    v_permlane32_swap_b32 v150, v151
    s_nop 1
    v_max_f32 v150, v150, v151
    s_mov_b32 s34, s35
    s_add_u32 s32, s35, 1
    s_lshl_b32 s32, s32, 9
    v_add_u32 v147, s32, v222
    v_add_u32 v148, s32, v223
    v_add_u32 v149, s32, v224
    v_mov_b32 v48, 0
    v_mov_b32 v49, 0
    v_mov_b32 v50, 0
    v_mov_b32 v51, 0
    v_mov_b32 v52, 0
    v_mov_b32 v53, 0
    v_mov_b32 v54, 0
    v_mov_b32 v55, 0
    v_mov_b32 v56, 0
    v_mov_b32 v57, 0
    v_mov_b32 v58, 0
    v_mov_b32 v59, 0
    v_mov_b32 v60, 0
    v_mov_b32 v61, 0
    v_mov_b32 v62, 0
    v_mov_b32 v63, 0
L12_slow11:
    ds_read_b128 v[72:75], v147
    ds_read_b128 v[76:79], v148
    ds_read_b64_tr_b16 v[88:89], v149 offset:0
    ds_read_b64_tr_b16 v[90:91], v149 offset:32
    ds_read_b64_tr_b16 v[92:93], v149 offset:256
    ds_read_b64_tr_b16 v[94:95], v149 offset:288
    s_waitcnt lgkmcnt(0)
    s_cmp_eq_u32 s34, 0
    s_cbranch_scc1 L12_slow11_far
    s_cmp_eq_u32 s34, 8
    s_cbranch_scc1 L12_slow11_diag
    v_mfma_f32_32x32x16_bf16 v[0:15], v[72:75], v[112:115], 0
    s_branch L12_slow11_j
L12_slow11_far:
    v_mfma_f32_32x32x16_bf16 v[0:15], v[72:75], v[112:115], v[206:221]
    s_branch L12_slow11_j
L12_slow11_diag:
    v_mfma_f32_32x32x16_bf16 v[0:15], v[72:75], v[112:115], v[190:205]
L12_slow11_j:
    v_mfma_f32_32x32x16_bf16 v[0:15], v[76:79], v[116:119], v[0:15]
    s_nop 11
    v_sub_f32 v0, v0, v150
    v_sub_f32 v1, v1, v150
    v_sub_f32 v2, v2, v150
    v_sub_f32 v3, v3, v150
    v_sub_f32 v4, v4, v150
    v_sub_f32 v5, v5, v150
    v_sub_f32 v6, v6, v150
    v_sub_f32 v7, v7, v150
    v_sub_f32 v8, v8, v150
    v_sub_f32 v9, v9, v150
    v_sub_f32 v10, v10, v150
    v_sub_f32 v11, v11, v150
    v_sub_f32 v12, v12, v150
    v_sub_f32 v13, v13, v150
    v_sub_f32 v14, v14, v150
    v_sub_f32 v15, v15, v150
    v_exp_f32 v0, v0
    v_exp_f32 v1, v1
    v_exp_f32 v2, v2
    v_exp_f32 v3, v3
    v_exp_f32 v4, v4
    v_exp_f32 v5, v5
    v_exp_f32 v6, v6
    v_exp_f32 v7, v7
    v_exp_f32 v8, v8
    v_exp_f32 v9, v9
    v_exp_f32 v10, v10
    v_exp_f32 v11, v11
    v_exp_f32 v12, v12
    v_exp_f32 v13, v13
    v_exp_f32 v14, v14
    v_exp_f32 v15, v15
    v_cvt_pk_bf16_f32 v64, v0, v1
    v_cvt_pk_bf16_f32 v65, v2, v3
    v_cvt_pk_bf16_f32 v66, v4, v5
    v_cvt_pk_bf16_f32 v67, v6, v7
    v_cvt_pk_bf16_f32 v68, v8, v9
    v_cvt_pk_bf16_f32 v69, v10, v11
    v_cvt_pk_bf16_f32 v70, v12, v13
    v_cvt_pk_bf16_f32 v71, v14, v15
    v_mfma_f32_32x32x16_bf16 v[48:63], v[88:91], v[64:67], v[48:63]
    s_nop 0
    v_mfma_f32_32x32x16_bf16 v[48:63], v[92:95], v[68:71], v[48:63]
    v_add_u32 v147, 512, v147
    v_add_u32 v148, 512, v148
    v_add_u32 v149, 512, v149
    s_nop 11
    s_add_u32 s34, s34, 1
    s_cmp_le_u32 s34, 8
    s_cbranch_scc1 L12_slow11
    v_rcp_f32 v126, v58
    s_nop 0
    v_mul_f32 v126, v126, v121
    v_pk_mul_f32 v[48:49], v[48:49], v[126:127] op_sel_hi:[1,0]
    v_pk_mul_f32 v[50:51], v[50:51], v[126:127] op_sel_hi:[1,0]
    v_pk_mul_f32 v[52:53], v[52:53], v[126:127] op_sel_hi:[1,0]
    v_pk_mul_f32 v[54:55], v[54:55], v[126:127] op_sel_hi:[1,0]
    v_pk_mul_f32 v[56:57], v[56:57], v[126:127] op_sel_hi:[1,0]
    v_cvt_pk_bf16_f32 v64, v48, v49
    v_cvt_pk_bf16_f32 v65, v50, v51
    v_cvt_pk_bf16_f32 v66, v52, v53
    v_cvt_pk_bf16_f32 v67, v54, v55
    v_cvt_pk_bf16_f32 v68, v56, v57
    ds_write2_b32 v232, v64, v65 offset0:0 offset1:1
    ds_write2_b32 v232, v66, v67 offset0:4 offset1:5
    ds_write_b32 v233, v68 offset:32
    s_waitcnt lgkmcnt(0)
    s_barrier
    s_cmp_ge_u32 s28, 4
    s_cbranch_scc1 L12_rec_noslab
    s_mov_b32 s75, 0
    s_add_u32 m0, s77, 151552
    s_nop 0
    buffer_load_dwordx4 v241, s[8:11], s75 offen lds
    s_mov_b32 s75, 36864
    s_add_u32 m0, s77, 155648
    s_nop 0
    buffer_load_dwordx4 v241, s[8:11], s75 offen lds
    s_mov_b32 s75, 73728
    s_add_u32 m0, s77, 159744
    s_nop 0
    buffer_load_dwordx4 v241, s[8:11], s75 offen lds
    s_mov_b32 s75, 110592
    s_add_u32 m0, s71, 2560
    s_nop 0
    buffer_load_dwordx4 v241, s[8:11], s75 offen lds
    s_mov_b32 s75, 147456
    s_add_u32 m0, s71, 3584
    s_nop 0
    buffer_load_dwordx4 v241, s[8:11], s75 offen lds
    s_mov_b32 s75, 184320
    s_add_u32 m0, s71, 4608
    s_nop 0
    buffer_load_dwordx4 v241, s[8:11], s75 offen lds
    s_mov_b32 s75, 221184
    s_add_u32 m0, s71, 8720
    s_nop 0
    buffer_load_dwordx4 v241, s[8:11], s75 offen lds
    s_mov_b32 s75, 258048
    s_add_u32 m0, s71, 9744
    s_nop 0
    buffer_load_dwordx4 v241, s[8:11], s75 offen lds
    s_mov_b32 s75, 294912
    s_add_u32 m0, s71, 10768
    s_nop 0
    buffer_load_dwordx4 v241, s[8:11], s75 offen lds
    s_mov_b32 s75, 331776
    s_add_u32 m0, s71, 14880
    s_nop 0
    buffer_load_dwordx4 v241, s[8:11], s75 offen lds
    s_mov_b32 s75, 368640
    s_add_u32 m0, s71, 15904
    s_nop 0
    buffer_load_dwordx4 v241, s[8:11], s75 offen lds
    s_mov_b32 s75, 405504
    s_add_u32 m0, s71, 16928
    s_nop 0
    buffer_load_dwordx4 v241, s[8:11], s75 offen lds
    s_mov_b32 s75, 442368
    s_add_u32 m0, s71, 21040
    s_nop 0
    buffer_load_dwordx4 v241, s[8:11], s75 offen lds
    s_mov_b32 s75, 479232
    s_add_u32 m0, s71, 22064
    s_nop 0
    buffer_load_dwordx4 v241, s[8:11], s75 offen lds
    s_mov_b32 s75, 516096
    s_add_u32 m0, s71, 23088
    s_nop 0
    buffer_load_dwordx4 v241, s[8:11], s75 offen lds
    s_mov_b32 s75, 552960
    s_add_u32 m0, s71, 27200
    s_nop 0
    buffer_load_dwordx4 v241, s[8:11], s75 offen lds
    s_mov_b32 s75, 589824
    s_add_u32 m0, s71, 28224
    s_nop 0
    buffer_load_dwordx4 v241, s[8:11], s75 offen lds
    s_mov_b32 s75, 626688
    s_add_u32 m0, s71, 29248
    s_nop 0
    buffer_load_dwordx4 v241, s[8:11], s75 offen lds
    s_waitcnt vmcnt(0)
L12_rec_noslab:
    s_barrier
    s_branch L12_A_done
L12_B_compute:
L_dry_Bk:
    v_cvt_pk_bf16_f32 v112, v32, v33
    v_cvt_pk_bf16_f32 v113, v34, v35
    v_cvt_pk_bf16_f32 v114, v36, v37
    v_cvt_pk_bf16_f32 v115, v38, v39
    v_cvt_pk_bf16_f32 v116, v40, v41
    v_cvt_pk_bf16_f32 v117, v42, v43
    v_cvt_pk_bf16_f32 v118, v44, v45
    v_cvt_pk_bf16_f32 v119, v46, v47
    v_cvt_pk_bf16_f32 v125, v48, v49
    v_cvt_pk_bf16_f32 v126, v50, v51
    v_cvt_pk_bf16_f32 v127, v52, v53
    v_cvt_pk_bf16_f32 v128, v54, v55
    v_cvt_pk_bf16_f32 v129, v56, v57
    v_cvt_pk_bf16_f32 v130, v58, v59
    v_cvt_pk_bf16_f32 v131, v60, v61
    v_cvt_pk_bf16_f32 v132, v62, v63
    v_cvt_pk_bf16_f32 v182, v96, v97
    v_cvt_pk_bf16_f32 v183, v98, v99
    v_cvt_pk_bf16_f32 v120, v100, v101
    v_cvt_pk_bf16_f32 v124, v102, v103
    v_cvt_pk_bf16_f32 v144, v104, v105
    v_cvt_pk_bf16_f32 v148, v106, v107
    v_cvt_pk_bf16_f32 v176, v108, v109
    v_cvt_pk_bf16_f32 v177, v110, v111
    v_permlane32_swap_b32 v112, v116
    v_permlane32_swap_b32 v113, v117
    v_permlane32_swap_b32 v114, v118
    v_permlane32_swap_b32 v115, v119
    s_nop 0
    v_permlane16_swap_b32 v112, v114
    v_permlane16_swap_b32 v113, v115
    v_permlane16_swap_b32 v116, v118
    v_permlane16_swap_b32 v117, v119
    v_permlane32_swap_b32 v182, v144
    v_permlane32_swap_b32 v183, v148
    v_permlane32_swap_b32 v120, v176
    v_permlane32_swap_b32 v124, v177
    s_nop 0
    v_permlane16_swap_b32 v182, v120
    v_permlane16_swap_b32 v183, v124
    v_permlane16_swap_b32 v144, v176
    v_permlane16_swap_b32 v148, v177
    v_permlane32_swap_b32 v125, v129
    v_permlane32_swap_b32 v126, v130
    v_permlane32_swap_b32 v127, v131
    v_permlane32_swap_b32 v128, v132
    s_nop 0
    v_permlane16_swap_b32 v125, v127
    v_permlane16_swap_b32 v126, v128
    v_permlane16_swap_b32 v129, v131
    v_permlane16_swap_b32 v130, v132
    v_cvt_pk_bf16_f32 v136, v64, v65
    v_cvt_pk_bf16_f32 v137, v66, v67
    v_cvt_pk_bf16_f32 v138, v68, v69
    v_cvt_pk_bf16_f32 v139, v70, v71
    v_mfma_f32_32x32x16_bf16 v[32:47], v[186:189], v[112:115], 0
    v_cvt_pk_bf16_f32 v140, v72, v73
    v_cvt_pk_bf16_f32 v141, v74, v75
    v_cvt_pk_bf16_f32 v142, v76, v77
    v_cvt_pk_bf16_f32 v143, v78, v79
    v_mfma_f32_32x32x16_bf16 v[32:47], v[190:193], v[116:119], v[32:47]
    v_cvt_pk_bf16_f32 v149, v80, v81
    v_cvt_pk_bf16_f32 v150, v82, v83
    v_cvt_pk_bf16_f32 v151, v84, v85
    v_cvt_pk_bf16_f32 v152, v86, v87
    v_mfma_f32_32x32x16_bf16 v[32:47], v[194:197], v[120:123], v[32:47]
    v_cvt_pk_bf16_f32 v153, v88, v89
    v_cvt_pk_bf16_f32 v154, v90, v91
    v_cvt_pk_bf16_f32 v155, v92, v93
    v_cvt_pk_bf16_f32 v156, v94, v95
    v_mfma_f32_32x32x16_bf16 v[160:175], v[210:213], v[112:115], 0
    v_permlane32_swap_b32 v136, v140
    v_permlane32_swap_b32 v137, v141
    v_permlane32_swap_b32 v138, v142
    v_permlane32_swap_b32 v139, v143
    v_mfma_f32_32x32x16_bf16 v[160:175], v[214:217], v[116:119], v[160:175]
    v_permlane16_swap_b32 v136, v138
    v_permlane16_swap_b32 v137, v139
    v_permlane16_swap_b32 v140, v142
    v_permlane16_swap_b32 v141, v143
    v_mfma_f32_32x32x16_bf16 v[160:175], v[218:221], v[120:123], v[160:175]
    v_permlane32_swap_b32 v149, v153
    v_permlane32_swap_b32 v150, v154
    v_permlane32_swap_b32 v151, v155
    v_permlane32_swap_b32 v152, v156
    v_mfma_f32_32x32x16_bf16 v[160:175], v[222:225], v[124:127], v[160:175]
    v_permlane16_swap_b32 v149, v151
    v_permlane16_swap_b32 v150, v152
    v_permlane16_swap_b32 v153, v155
    v_permlane16_swap_b32 v154, v156
    v_mfma_f32_32x32x16_bf16 v[160:175], v[226:229], v[128:131], v[160:175]
    v_permlane32_swap_b32 v96, v104
    v_permlane32_swap_b32 v100, v108
    s_nop 1
    v_permlane16_swap_b32 v104, v108
    ds_write_b128 v245, v[136:139] offset:0
    v_mfma_f32_32x32x16_bf16 v[160:175], v[230:233], v[132:135], v[160:175]
    ds_write_b128 v245, v[140:143] offset:16
    ds_write_b128 v245, v[148:151] offset:14336
    ds_write_b128 v245, v[152:155] offset:14352
    v_mul_f32 v253, 0x3fb8aa3b, v108
    v_mfma_f32_32x32x16_bf16 v[48:63], v[198:201], v[124:127], 0
    v_exp_f32 v253, v253
    s_nop 0
    v_add_f32 v253, 1.0, v253
    v_rcp_f32 v253, v253
    v_mfma_f32_32x32x16_bf16 v[48:63], v[202:205], v[128:131], v[48:63]
    v_mfma_f32_32x32x16_bf16 v[48:63], v[206:209], v[132:135], v[48:63]
    v_max3_f32 v84, v32, v33, v34
    v_min3_f32 v86, v32, v33, v34
    v_max3_f32 v84, v84, v35, v36
    v_min3_f32 v86, v86, v35, v36
    v_max3_f32 v84, v84, v37, v38
    v_min3_f32 v86, v86, v37, v38
    v_max3_f32 v84, v84, v39, v40
    v_min3_f32 v86, v86, v39, v40
    v_max3_f32 v84, v84, v41, v42
    v_min3_f32 v86, v86, v41, v42
    v_max3_f32 v84, v84, v43, v44
    v_min3_f32 v86, v86, v43, v44
    v_max3_f32 v84, v84, v45, v46
    v_min3_f32 v86, v86, v45, v46
    v_max3_f32 v84, v84, v47, v160
    v_min3_f32 v86, v86, v47, v160
    v_max_f32 v84, v84, v161
    v_min_f32 v86, v86, v161
    v_mul_f32 v84, s82, v84
    v_mul_f32 v86, s80, v86
    v_pk_fma_f32 v[64:65], v[32:33], s[80:81], v[84:85] op_sel_hi:[1,1,0]
    v_pk_fma_f32 v[32:33], v[32:33], s[82:83], v[86:87] op_sel_hi:[1,1,0]
    v_pk_fma_f32 v[66:67], v[34:35], s[80:81], v[84:85] op_sel_hi:[1,1,0]
    v_pk_fma_f32 v[34:35], v[34:35], s[82:83], v[86:87] op_sel_hi:[1,1,0]
    v_pk_fma_f32 v[68:69], v[36:37], s[80:81], v[84:85] op_sel_hi:[1,1,0]
    v_pk_fma_f32 v[36:37], v[36:37], s[82:83], v[86:87] op_sel_hi:[1,1,0]
    v_pk_fma_f32 v[70:71], v[38:39], s[80:81], v[84:85] op_sel_hi:[1,1,0]
    v_pk_fma_f32 v[38:39], v[38:39], s[82:83], v[86:87] op_sel_hi:[1,1,0]
    v_pk_fma_f32 v[72:73], v[40:41], s[80:81], v[84:85] op_sel_hi:[1,1,0]
    v_pk_fma_f32 v[40:41], v[40:41], s[82:83], v[86:87] op_sel_hi:[1,1,0]
    v_pk_fma_f32 v[74:75], v[42:43], s[80:81], v[84:85] op_sel_hi:[1,1,0]
    v_pk_fma_f32 v[42:43], v[42:43], s[82:83], v[86:87] op_sel_hi:[1,1,0]
    v_pk_fma_f32 v[76:77], v[44:45], s[80:81], v[84:85] op_sel_hi:[1,1,0]
    v_pk_fma_f32 v[44:45], v[44:45], s[82:83], v[86:87] op_sel_hi:[1,1,0]
    v_pk_fma_f32 v[78:79], v[46:47], s[80:81], v[84:85] op_sel_hi:[1,1,0]
    v_pk_fma_f32 v[46:47], v[46:47], s[82:83], v[86:87] op_sel_hi:[1,1,0]
    v_pk_fma_f32 v[80:81], v[160:161], s[80:81], v[84:85] op_sel_hi:[1,1,0]
    v_pk_fma_f32 v[160:161], v[160:161], s[82:83], v[86:87] op_sel_hi:[1,1,0]
    v_exp_f32 v64, v64
    v_exp_f32 v65, v65
    v_exp_f32 v66, v66
    v_exp_f32 v67, v67
    v_exp_f32 v68, v68
    v_exp_f32 v69, v69
    v_exp_f32 v70, v70
    v_exp_f32 v71, v71
    v_exp_f32 v72, v72
    v_exp_f32 v73, v73
    v_exp_f32 v74, v74
    v_exp_f32 v75, v75
    v_exp_f32 v76, v76
    v_exp_f32 v77, v77
    v_exp_f32 v78, v78
    v_exp_f32 v79, v79
    v_exp_f32 v80, v80
    v_exp_f32 v81, v81
    v_exp_f32 v32, v32
    v_exp_f32 v33, v33
    v_exp_f32 v34, v34
    v_exp_f32 v35, v35
    v_exp_f32 v36, v36
    v_exp_f32 v37, v37
    v_exp_f32 v38, v38
    v_exp_f32 v39, v39
    v_exp_f32 v40, v40
    v_exp_f32 v41, v41
    v_exp_f32 v42, v42
    v_exp_f32 v43, v43
    v_exp_f32 v44, v44
    v_exp_f32 v45, v45
    v_exp_f32 v46, v46
    v_exp_f32 v47, v47
    v_exp_f32 v160, v160
    v_exp_f32 v161, v161
    v_pk_add_f32 v[88:89], v[64:65], v[66:67]
    v_pk_add_f32 v[90:91], v[32:33], v[34:35]
    v_pk_add_f32 v[88:89], v[88:89], v[68:69]
    v_pk_add_f32 v[90:91], v[90:91], v[36:37]
    v_pk_add_f32 v[88:89], v[88:89], v[70:71]
    v_pk_add_f32 v[90:91], v[90:91], v[38:39]
    v_pk_add_f32 v[88:89], v[88:89], v[72:73]
    v_pk_add_f32 v[90:91], v[90:91], v[40:41]
    v_pk_add_f32 v[88:89], v[88:89], v[74:75]
    v_pk_add_f32 v[90:91], v[90:91], v[42:43]
    v_pk_add_f32 v[88:89], v[88:89], v[76:77]
    v_pk_add_f32 v[90:91], v[90:91], v[44:45]
    v_pk_add_f32 v[88:89], v[88:89], v[78:79]
    v_pk_add_f32 v[90:91], v[90:91], v[46:47]
    v_pk_add_f32 v[88:89], v[88:89], v[80:81]
    v_pk_add_f32 v[90:91], v[90:91], v[160:161]
    v_add_f32 v88, v88, v89
    v_add_f32 v90, v90, v91
    v_rcp_f32 v88, v88
    v_rcp_f32 v90, v90
    v_mov_b32 v204, v144
    v_mov_b32 v205, 0x3f80
    v_pk_mul_f32 v[64:65], v[64:65], v[88:89] op_sel_hi:[1,0]
    v_pk_mul_f32 v[66:67], v[66:67], v[88:89] op_sel_hi:[1,0]
    v_pk_mul_f32 v[68:69], v[68:69], v[88:89] op_sel_hi:[1,0]
    v_pk_mul_f32 v[70:71], v[70:71], v[88:89] op_sel_hi:[1,0]
    v_pk_mul_f32 v[72:73], v[72:73], v[88:89] op_sel_hi:[1,0]
    v_pk_mul_f32 v[74:75], v[74:75], v[88:89] op_sel_hi:[1,0]
    v_pk_mul_f32 v[76:77], v[76:77], v[88:89] op_sel_hi:[1,0]
    v_pk_mul_f32 v[78:79], v[78:79], v[88:89] op_sel_hi:[1,0]
    v_pk_mul_f32 v[80:81], v[80:81], v[88:89] op_sel_hi:[1,0]
    v_cvt_pk_bf16_f32 v186, v64, v65
    v_cvt_pk_bf16_f32 v187, v66, v67
    v_cvt_pk_bf16_f32 v188, v68, v69
    v_cvt_pk_bf16_f32 v189, v70, v71
    ds_write_b128 v245, v[186:189] offset:32
    v_cvt_pk_bf16_f32 v190, v72, v73
    v_cvt_pk_bf16_f32 v191, v74, v75
    v_cvt_pk_bf16_f32 v192, v76, v77
    v_cvt_pk_bf16_f32 v193, v78, v79
    ds_write_b128 v245, v[190:193] offset:48
    v_pk_mul_f32 v[32:33], v[32:33], v[90:91] op_sel_hi:[1,0]
    v_pk_mul_f32 v[34:35], v[34:35], v[90:91] op_sel_hi:[1,0]
    v_pk_mul_f32 v[36:37], v[36:37], v[90:91] op_sel_hi:[1,0]
    v_pk_mul_f32 v[38:39], v[38:39], v[90:91] op_sel_hi:[1,0]
    v_pk_mul_f32 v[40:41], v[40:41], v[90:91] op_sel_hi:[1,0]
    v_pk_mul_f32 v[42:43], v[42:43], v[90:91] op_sel_hi:[1,0]
    v_pk_mul_f32 v[44:45], v[44:45], v[90:91] op_sel_hi:[1,0]
    v_pk_mul_f32 v[46:47], v[46:47], v[90:91] op_sel_hi:[1,0]
    v_pk_mul_f32 v[160:161], v[160:161], v[90:91] op_sel_hi:[1,0]
    v_cvt_pk_bf16_f32 v194, v80, v81
    v_cvt_pk_bf16_f32 v195, v32, v33
    v_cvt_pk_bf16_f32 v196, v34, v35
    v_cvt_pk_bf16_f32 v197, v36, v37
    ds_write_b128 v245, v[194:197] offset:64
    v_cvt_pk_bf16_f32 v198, v38, v39
    v_cvt_pk_bf16_f32 v199, v40, v41
    v_cvt_pk_bf16_f32 v200, v42, v43
    v_cvt_pk_bf16_f32 v201, v44, v45
    ds_write_b128 v245, v[198:201] offset:80
    v_cvt_pk_bf16_f32 v202, v46, v47
    v_cvt_pk_bf16_f32 v203, v160, v161
    ds_write_b128 v245, v[202:205] offset:96
    v_max3_f32 v84, v48, v49, v50
    v_min3_f32 v86, v48, v49, v50
    v_max3_f32 v84, v84, v51, v52
    v_min3_f32 v86, v86, v51, v52
    v_max3_f32 v84, v84, v53, v54
    v_min3_f32 v86, v86, v53, v54
    v_max3_f32 v84, v84, v55, v56
    v_min3_f32 v86, v86, v55, v56
    v_max3_f32 v84, v84, v57, v58
    v_min3_f32 v86, v86, v57, v58
    v_max3_f32 v84, v84, v59, v60
    v_min3_f32 v86, v86, v59, v60
    v_max3_f32 v84, v84, v61, v62
    v_min3_f32 v86, v86, v61, v62
    v_max3_f32 v84, v84, v63, v164
    v_min3_f32 v86, v86, v63, v164
    v_max_f32 v84, v84, v165
    v_min_f32 v86, v86, v165
    v_mul_f32 v84, s82, v84
    v_mul_f32 v86, s80, v86
    v_pk_fma_f32 v[64:65], v[48:49], s[80:81], v[84:85] op_sel_hi:[1,1,0]
    v_pk_fma_f32 v[48:49], v[48:49], s[82:83], v[86:87] op_sel_hi:[1,1,0]
    v_pk_fma_f32 v[66:67], v[50:51], s[80:81], v[84:85] op_sel_hi:[1,1,0]
    v_pk_fma_f32 v[50:51], v[50:51], s[82:83], v[86:87] op_sel_hi:[1,1,0]
    v_pk_fma_f32 v[68:69], v[52:53], s[80:81], v[84:85] op_sel_hi:[1,1,0]
    v_pk_fma_f32 v[52:53], v[52:53], s[82:83], v[86:87] op_sel_hi:[1,1,0]
    v_pk_fma_f32 v[70:71], v[54:55], s[80:81], v[84:85] op_sel_hi:[1,1,0]
    v_pk_fma_f32 v[54:55], v[54:55], s[82:83], v[86:87] op_sel_hi:[1,1,0]
    v_pk_fma_f32 v[72:73], v[56:57], s[80:81], v[84:85] op_sel_hi:[1,1,0]
    v_pk_fma_f32 v[56:57], v[56:57], s[82:83], v[86:87] op_sel_hi:[1,1,0]
    v_pk_fma_f32 v[74:75], v[58:59], s[80:81], v[84:85] op_sel_hi:[1,1,0]
    v_pk_fma_f32 v[58:59], v[58:59], s[82:83], v[86:87] op_sel_hi:[1,1,0]
    v_pk_fma_f32 v[76:77], v[60:61], s[80:81], v[84:85] op_sel_hi:[1,1,0]
    v_pk_fma_f32 v[60:61], v[60:61], s[82:83], v[86:87] op_sel_hi:[1,1,0]
    v_pk_fma_f32 v[78:79], v[62:63], s[80:81], v[84:85] op_sel_hi:[1,1,0]
    v_pk_fma_f32 v[62:63], v[62:63], s[82:83], v[86:87] op_sel_hi:[1,1,0]
    v_pk_fma_f32 v[80:81], v[164:165], s[80:81], v[84:85] op_sel_hi:[1,1,0]
    v_pk_fma_f32 v[164:165], v[164:165], s[82:83], v[86:87] op_sel_hi:[1,1,0]
    v_exp_f32 v64, v64
    v_exp_f32 v65, v65
    v_exp_f32 v66, v66
    v_exp_f32 v67, v67
    v_exp_f32 v68, v68
    v_exp_f32 v69, v69
    v_exp_f32 v70, v70
    v_exp_f32 v71, v71
    v_exp_f32 v72, v72
    v_exp_f32 v73, v73
    v_exp_f32 v74, v74
    v_exp_f32 v75, v75
    v_exp_f32 v76, v76
    v_exp_f32 v77, v77
    v_exp_f32 v78, v78
    v_exp_f32 v79, v79
    v_exp_f32 v80, v80
    v_exp_f32 v81, v81
    v_exp_f32 v48, v48
    v_exp_f32 v49, v49
    v_exp_f32 v50, v50
    v_exp_f32 v51, v51
    v_exp_f32 v52, v52
    v_exp_f32 v53, v53
    v_exp_f32 v54, v54
    v_exp_f32 v55, v55
    v_exp_f32 v56, v56
    v_exp_f32 v57, v57
    v_exp_f32 v58, v58
    v_exp_f32 v59, v59
    v_exp_f32 v60, v60
    v_exp_f32 v61, v61
    v_exp_f32 v62, v62
    v_exp_f32 v63, v63
    v_exp_f32 v164, v164
    v_exp_f32 v165, v165
    v_pk_add_f32 v[88:89], v[64:65], v[66:67]
    v_pk_add_f32 v[90:91], v[48:49], v[50:51]
    v_pk_add_f32 v[88:89], v[88:89], v[68:69]
    v_pk_add_f32 v[90:91], v[90:91], v[52:53]
    v_pk_add_f32 v[88:89], v[88:89], v[70:71]
    v_pk_add_f32 v[90:91], v[90:91], v[54:55]
    v_pk_add_f32 v[88:89], v[88:89], v[72:73]
    v_pk_add_f32 v[90:91], v[90:91], v[56:57]
    v_pk_add_f32 v[88:89], v[88:89], v[74:75]
    v_pk_add_f32 v[90:91], v[90:91], v[58:59]
    v_pk_add_f32 v[88:89], v[88:89], v[76:77]
    v_pk_add_f32 v[90:91], v[90:91], v[60:61]
    v_pk_add_f32 v[88:89], v[88:89], v[78:79]
    v_pk_add_f32 v[90:91], v[90:91], v[62:63]
    v_pk_add_f32 v[88:89], v[88:89], v[80:81]
    v_pk_add_f32 v[90:91], v[90:91], v[164:165]
    v_add_f32 v88, v88, v89
    v_add_f32 v90, v90, v91
    v_rcp_f32 v88, v88
    v_rcp_f32 v90, v90
    v_mov_b32 v224, v156
    v_mov_b32 v225, 0x3f80
    v_pk_mul_f32 v[64:65], v[64:65], v[88:89] op_sel_hi:[1,0]
    v_pk_mul_f32 v[66:67], v[66:67], v[88:89] op_sel_hi:[1,0]
    v_pk_mul_f32 v[68:69], v[68:69], v[88:89] op_sel_hi:[1,0]
    v_pk_mul_f32 v[70:71], v[70:71], v[88:89] op_sel_hi:[1,0]
    v_pk_mul_f32 v[72:73], v[72:73], v[88:89] op_sel_hi:[1,0]
    v_pk_mul_f32 v[74:75], v[74:75], v[88:89] op_sel_hi:[1,0]
    v_pk_mul_f32 v[76:77], v[76:77], v[88:89] op_sel_hi:[1,0]
    v_pk_mul_f32 v[78:79], v[78:79], v[88:89] op_sel_hi:[1,0]
    v_pk_mul_f32 v[80:81], v[80:81], v[88:89] op_sel_hi:[1,0]
    v_cvt_pk_bf16_f32 v206, v64, v65
    v_cvt_pk_bf16_f32 v207, v66, v67
    v_cvt_pk_bf16_f32 v208, v68, v69
    v_cvt_pk_bf16_f32 v209, v70, v71
    ds_write_b128 v245, v[206:209] offset:14368
    v_cvt_pk_bf16_f32 v210, v72, v73
    v_cvt_pk_bf16_f32 v211, v74, v75
    v_cvt_pk_bf16_f32 v212, v76, v77
    v_cvt_pk_bf16_f32 v213, v78, v79
    ds_write_b128 v245, v[210:213] offset:14384
    v_pk_mul_f32 v[48:49], v[48:49], v[90:91] op_sel_hi:[1,0]
    v_pk_mul_f32 v[50:51], v[50:51], v[90:91] op_sel_hi:[1,0]
    v_pk_mul_f32 v[52:53], v[52:53], v[90:91] op_sel_hi:[1,0]
    v_pk_mul_f32 v[54:55], v[54:55], v[90:91] op_sel_hi:[1,0]
    v_pk_mul_f32 v[56:57], v[56:57], v[90:91] op_sel_hi:[1,0]
    v_pk_mul_f32 v[58:59], v[58:59], v[90:91] op_sel_hi:[1,0]
    v_pk_mul_f32 v[60:61], v[60:61], v[90:91] op_sel_hi:[1,0]
    v_pk_mul_f32 v[62:63], v[62:63], v[90:91] op_sel_hi:[1,0]
    v_pk_mul_f32 v[164:165], v[164:165], v[90:91] op_sel_hi:[1,0]
    v_cvt_pk_bf16_f32 v214, v80, v81
    v_cvt_pk_bf16_f32 v215, v48, v49
    v_cvt_pk_bf16_f32 v216, v50, v51
    v_cvt_pk_bf16_f32 v217, v52, v53
    ds_write_b128 v245, v[214:217] offset:14400
    v_cvt_pk_bf16_f32 v218, v54, v55
    v_cvt_pk_bf16_f32 v219, v56, v57
    v_cvt_pk_bf16_f32 v220, v58, v59
    v_cvt_pk_bf16_f32 v221, v60, v61
    ds_write_b128 v245, v[218:221] offset:14416
    v_cvt_pk_bf16_f32 v222, v62, v63
    v_cvt_pk_bf16_f32 v223, v164, v165
    ds_write_b128 v245, v[222:225] offset:14432
    s_waitcnt lgkmcnt(0)
    s_cbranch_execz L_dry_ret
    s_barrier
    v_mov_b32 v90, 147968
    ds_read_b32 v91, v90
    ds_read_b64_tr_b16 v[128:129], v246 offset:32
    ds_read_b64_tr_b16 v[130:131], v246 offset:144
    ds_read_b64_tr_b16 v[132:133], v246 offset:64
    ds_read_b64_tr_b16 v[134:135], v246 offset:176
    ds_read_b64_tr_b16 v[136:137], v246 offset:96
    ds_read_b64_tr_b16 v[138:139], v246 offset:208
    ds_read_b64_tr_b16 v[140:141], v246 offset:0
    ds_read_b64_tr_b16 v[142:143], v246 offset:112
    ds_read_b64_tr_b16 v[144:145], v246 offset:104
    ds_read_b64_tr_b16 v[146:147], v246 offset:216
    ds_read_b64_tr_b16 v[148:149], v246 offset:3616
    ds_read_b64_tr_b16 v[150:151], v246 offset:3728
    ds_read_b64_tr_b16 v[152:153], v246 offset:3648
    ds_read_b64_tr_b16 v[154:155], v246 offset:3760
    ds_read_b64_tr_b16 v[156:157], v246 offset:3680
    ds_read_b64_tr_b16 v[158:159], v246 offset:3792
    ds_read_b64_tr_b16 v[160:161], v246 offset:3584
    ds_read_b64_tr_b16 v[162:163], v246 offset:3696
    ds_read_b64_tr_b16 v[164:165], v246 offset:3688
    ds_read_b64_tr_b16 v[166:167], v246 offset:3800
    ds_read_b64_tr_b16 v[56:57], v246 offset:7200
    ds_read_b64_tr_b16 v[58:59], v246 offset:7312
    ds_read_b64_tr_b16 v[60:61], v246 offset:7232
    ds_read_b64_tr_b16 v[62:63], v246 offset:7344
    s_waitcnt lgkmcnt(14)
    v_mfma_f32_16x16x32_bf16 v[32:35], v[128:131], v[140:143], 0
    v_mfma_f32_16x16x32_bf16 v[36:39], v[132:135], v[140:143], 0
    v_mfma_f32_16x16x32_bf16 v[40:43], v[136:139], v[140:143], 0
    v_mfma_f32_16x16x32_bf16 v[44:47], v[128:131], v[144:147], 0
    v_mfma_f32_16x16x32_bf16 v[48:51], v[132:135], v[144:147], 0
    v_mfma_f32_16x16x32_bf16 v[52:55], v[136:139], v[144:147], 0
    ds_read_b64_tr_b16 v[64:65], v246 offset:7264
    ds_read_b64_tr_b16 v[66:67], v246 offset:7376
    ds_read_b64_tr_b16 v[68:69], v246 offset:7168
    ds_read_b64_tr_b16 v[70:71], v246 offset:7280
    ds_read_b64_tr_b16 v[72:73], v246 offset:7272
    ds_read_b64_tr_b16 v[74:75], v246 offset:7384
    ds_read_b64_tr_b16 v[128:129], v246 offset:10784
    ds_read_b64_tr_b16 v[130:131], v246 offset:10896
    ds_read_b64_tr_b16 v[132:133], v246 offset:10816
    ds_read_b64_tr_b16 v[134:135], v246 offset:10928
    ds_read_b64_tr_b16 v[136:137], v246 offset:10848
    ds_read_b64_tr_b16 v[138:139], v246 offset:10960
    ds_read_b64_tr_b16 v[140:141], v246 offset:10752
    ds_read_b64_tr_b16 v[142:143], v246 offset:10864
    ds_read_b64_tr_b16 v[144:145], v246 offset:10856
    ds_read_b64_tr_b16 v[146:147], v246 offset:10968
    s_waitcnt lgkmcnt(14)
    v_mfma_f32_16x16x32_bf16 v[32:35], v[148:151], v[160:163], v[32:35]
    v_mfma_f32_16x16x32_bf16 v[36:39], v[152:155], v[160:163], v[36:39]
    v_mfma_f32_16x16x32_bf16 v[40:43], v[156:159], v[160:163], v[40:43]
    v_mfma_f32_16x16x32_bf16 v[44:47], v[148:151], v[164:167], v[44:47]
    v_mfma_f32_16x16x32_bf16 v[48:51], v[152:155], v[164:167], v[48:51]
    v_mfma_f32_16x16x32_bf16 v[52:55], v[156:159], v[164:167], v[52:55]
    s_waitcnt lgkmcnt(10)
    v_mfma_f32_16x16x32_bf16 v[32:35], v[56:59], v[68:71], v[32:35]
    v_mfma_f32_16x16x32_bf16 v[36:39], v[60:63], v[68:71], v[36:39]
    v_mfma_f32_16x16x32_bf16 v[40:43], v[64:67], v[68:71], v[40:43]
    v_mfma_f32_16x16x32_bf16 v[44:47], v[56:59], v[72:75], v[44:47]
    v_mfma_f32_16x16x32_bf16 v[48:51], v[60:63], v[72:75], v[48:51]
    v_mfma_f32_16x16x32_bf16 v[52:55], v[64:67], v[72:75], v[52:55]
    s_waitcnt lgkmcnt(0)
    v_mfma_f32_16x16x32_bf16 v[32:35], v[128:131], v[140:143], v[32:35]
    v_mfma_f32_16x16x32_bf16 v[36:39], v[132:135], v[140:143], v[36:39]
    v_mfma_f32_16x16x32_bf16 v[40:43], v[136:139], v[140:143], v[40:43]
    v_mfma_f32_16x16x32_bf16 v[44:47], v[128:131], v[144:147], v[44:47]
    v_mfma_f32_16x16x32_bf16 v[48:51], v[132:135], v[144:147], v[48:51]
    v_mfma_f32_16x16x32_bf16 v[52:55], v[136:139], v[144:147], v[52:55]
    v_readfirstlane_b32 s42, v91
    s_mov_b32 s32, 0x00070007
    s_mov_b32 s33, 0x00070007
    s_mov_b32 s34, 0x00070007
    s_mov_b32 s35, 0
    v_cvt_pk_bf16_f32 v168, v32, v33
    v_cvt_pk_bf16_f32 v169, v34, v35
    v_cvt_pk_bf16_f32 v170, v36, v37
    v_cvt_pk_bf16_f32 v171, v38, v39
    v_cvt_pk_bf16_f32 v172, v40, v41
    v_cvt_pk_bf16_f32 v173, v42, v43
    v_cvt_pk_bf16_f32 v174, v44, v45
    v_cvt_pk_bf16_f32 v175, v46, v47
    v_cvt_pk_bf16_f32 v176, v48, v49
    v_cvt_pk_bf16_f32 v177, v50, v51
    v_cvt_pk_bf16_f32 v178, v52, v53
    v_cvt_pk_bf16_f32 v179, v54, v55
    ds_write_b64 v247, v[168:169] offset:0
    ds_write_b64 v247, v[170:171] offset:32
    s_mov_b32 exec_hi, 0
    ds_write_b64 v247, v[172:173] offset:64
    s_mov_b64 exec, s[32:33]
    ds_write_b64 v247, v[174:175] offset:1280
    ds_write_b64 v247, v[176:177] offset:1312
    s_mov_b64 exec, s[34:35]
    ds_write_b64 v247, v[178:179] offset:1344
    s_mov_b64 exec, -1
    s_waitcnt lgkmcnt(0)
    s_barrier
    ds_read_b64_tr_b16 v[186:187], v242 offset:0
    ds_read_b64_tr_b16 v[188:189], v242 offset:160
    ds_read_b64_tr_b16 v[190:191], v242 offset:320
    ds_read_b64_tr_b16 v[192:193], v242 offset:480
    ds_read_b64_tr_b16 v[194:195], v242 offset:640
    ds_read_b64_tr_b16 v[196:197], v242 offset:800
    ds_read_b64_tr_b16 v[198:199], v242 offset:960
    ds_read_b64_tr_b16 v[200:201], v242 offset:1120
    ds_read_b64_tr_b16 v[202:203], v242 offset:1280
    ds_read_b64_tr_b16 v[204:205], v242 offset:1440
    ds_read_b64_tr_b16 v[206:207], v242 offset:1600
    ds_read_b64_tr_b16 v[208:209], v242 offset:1760
    ds_read_b64_tr_b16 v[210:211], v243 offset:0
    ds_read_b64_tr_b16 v[212:213], v243 offset:160
    ds_read_b64_tr_b16 v[214:215], v243 offset:320
    ds_read_b64_tr_b16 v[216:217], v243 offset:480
    ds_read_b64_tr_b16 v[218:219], v243 offset:640
    ds_read_b64_tr_b16 v[220:221], v243 offset:800
    ds_read_b64_tr_b16 v[222:223], v244 offset:0
    ds_read_b64_tr_b16 v[224:225], v244 offset:160
    ds_read_b64_tr_b16 v[226:227], v244 offset:320
    ds_read_b64_tr_b16 v[228:229], v244 offset:480
    ds_read_b64_tr_b16 v[230:231], v244 offset:640
    ds_read_b64_tr_b16 v[232:233], v244 offset:800
    v_cvt_pk_bf16_f32 v136, v0, v1
    v_cvt_pk_bf16_f32 v137, v2, v3
    v_cvt_pk_bf16_f32 v138, v4, v5
    v_cvt_pk_bf16_f32 v139, v6, v7
    v_cvt_pk_bf16_f32 v140, v8, v9
    v_cvt_pk_bf16_f32 v141, v10, v11
    v_cvt_pk_bf16_f32 v142, v12, v13
    v_cvt_pk_bf16_f32 v143, v14, v15
    v_cvt_pk_bf16_f32 v149, v16, v17
    v_cvt_pk_bf16_f32 v150, v18, v19
    v_cvt_pk_bf16_f32 v151, v20, v21
    v_cvt_pk_bf16_f32 v152, v22, v23
    v_cvt_pk_bf16_f32 v153, v24, v25
    v_cvt_pk_bf16_f32 v154, v26, v27
    v_cvt_pk_bf16_f32 v155, v28, v29
    v_cvt_pk_bf16_f32 v156, v30, v31
    v_permlane32_swap_b32 v136, v140
    v_permlane32_swap_b32 v137, v141
    v_permlane32_swap_b32 v138, v142
    v_permlane32_swap_b32 v139, v143
    s_nop 0
    v_permlane16_swap_b32 v136, v138
    v_permlane16_swap_b32 v137, v139
    v_permlane16_swap_b32 v140, v142
    v_permlane16_swap_b32 v141, v143
    v_permlane32_swap_b32 v149, v153
    v_permlane32_swap_b32 v150, v154
    v_permlane32_swap_b32 v151, v155
    v_permlane32_swap_b32 v152, v156
    s_nop 0
    v_permlane16_swap_b32 v149, v151
    v_permlane16_swap_b32 v150, v152
    v_permlane16_swap_b32 v153, v155
    v_permlane16_swap_b32 v154, v156
    v_mov_b32 v144, v182
    v_mov_b32 v148, v183
    v_mov_b32 v145, 0
    v_mov_b32 v146, 0
    v_mov_b32 v147, 0
    v_mov_b32 v157, 0
    v_mov_b32 v158, 0
    v_mov_b32 v159, 0
    s_waitcnt lgkmcnt(0)
    v_mfma_f32_32x32x16_bf16 v[0:15], v[186:189], v[136:139], 0
    v_mfma_f32_32x32x16_bf16 v[0:15], v[190:193], v[140:143], v[0:15]
    v_mfma_f32_32x32x16_bf16 v[0:15], v[194:197], v[144:147], v[0:15]
    v_mfma_f32_32x32x16_bf16 v[112:127], v[210:213], v[136:139], 0
    v_mfma_f32_32x32x16_bf16 v[112:127], v[214:217], v[140:143], v[112:127]
    v_mfma_f32_32x32x16_bf16 v[112:127], v[218:221], v[144:147], v[112:127]
    v_mfma_f32_32x32x16_bf16 v[112:127], v[222:225], v[148:151], v[112:127]
    v_mfma_f32_32x32x16_bf16 v[112:127], v[226:229], v[152:155], v[112:127]
    v_mfma_f32_32x32x16_bf16 v[112:127], v[230:233], v[156:159], v[112:127]
    v_mfma_f32_32x32x16_bf16 v[16:31], v[198:201], v[148:151], 0
    v_mfma_f32_32x32x16_bf16 v[16:31], v[202:205], v[152:155], v[16:31]
    v_mfma_f32_32x32x16_bf16 v[16:31], v[206:209], v[156:159], v[16:31]
    s_nop 2
    v_max3_f32 v128, v0, v1, v2
    v_min3_f32 v130, v0, v1, v2
    v_max3_f32 v128, v128, v3, v4
    v_min3_f32 v130, v130, v3, v4
    v_max3_f32 v128, v128, v5, v6
    v_min3_f32 v130, v130, v5, v6
    v_max3_f32 v128, v128, v7, v8
    v_min3_f32 v130, v130, v7, v8
    v_max3_f32 v128, v128, v9, v10
    v_min3_f32 v130, v130, v9, v10
    v_max3_f32 v128, v128, v11, v12
    v_min3_f32 v130, v130, v11, v12
    v_max3_f32 v128, v128, v13, v14
    v_min3_f32 v130, v130, v13, v14
    v_max3_f32 v128, v128, v15, v112
    v_min3_f32 v130, v130, v15, v112
    v_max_f32 v128, v128, v113
    v_min_f32 v130, v130, v113
    v_mul_f32 v128, s82, v128
    v_mul_f32 v130, s80, v130
    v_pk_fma_f32 v[96:97], v[0:1], s[80:81], v[128:129] op_sel_hi:[1,1,0]
    v_pk_fma_f32 v[0:1], v[0:1], s[82:83], v[130:131] op_sel_hi:[1,1,0]
    v_pk_fma_f32 v[98:99], v[2:3], s[80:81], v[128:129] op_sel_hi:[1,1,0]
    v_pk_fma_f32 v[2:3], v[2:3], s[82:83], v[130:131] op_sel_hi:[1,1,0]
    v_pk_fma_f32 v[100:101], v[4:5], s[80:81], v[128:129] op_sel_hi:[1,1,0]
    v_pk_fma_f32 v[4:5], v[4:5], s[82:83], v[130:131] op_sel_hi:[1,1,0]
    v_pk_fma_f32 v[102:103], v[6:7], s[80:81], v[128:129] op_sel_hi:[1,1,0]
    v_pk_fma_f32 v[6:7], v[6:7], s[82:83], v[130:131] op_sel_hi:[1,1,0]
    v_pk_fma_f32 v[108:109], v[8:9], s[80:81], v[128:129] op_sel_hi:[1,1,0]
    v_pk_fma_f32 v[8:9], v[8:9], s[82:83], v[130:131] op_sel_hi:[1,1,0]
    v_pk_fma_f32 v[110:111], v[10:11], s[80:81], v[128:129] op_sel_hi:[1,1,0]
    v_pk_fma_f32 v[10:11], v[10:11], s[82:83], v[130:131] op_sel_hi:[1,1,0]
    v_pk_fma_f32 v[166:167], v[12:13], s[80:81], v[128:129] op_sel_hi:[1,1,0]
    v_pk_fma_f32 v[12:13], v[12:13], s[82:83], v[130:131] op_sel_hi:[1,1,0]
    v_pk_fma_f32 v[168:169], v[14:15], s[80:81], v[128:129] op_sel_hi:[1,1,0]
    v_pk_fma_f32 v[14:15], v[14:15], s[82:83], v[130:131] op_sel_hi:[1,1,0]
    v_pk_fma_f32 v[170:171], v[112:113], s[80:81], v[128:129] op_sel_hi:[1,1,0]
    v_pk_fma_f32 v[112:113], v[112:113], s[82:83], v[130:131] op_sel_hi:[1,1,0]
    v_exp_f32 v96, v96
    v_exp_f32 v97, v97
    v_exp_f32 v98, v98
    v_exp_f32 v99, v99
    v_exp_f32 v100, v100
    v_exp_f32 v101, v101
    v_exp_f32 v102, v102
    v_exp_f32 v103, v103
    v_exp_f32 v108, v108
    v_exp_f32 v109, v109
    v_exp_f32 v110, v110
    v_exp_f32 v111, v111
    v_exp_f32 v166, v166
    v_exp_f32 v167, v167
    v_exp_f32 v168, v168
    v_exp_f32 v169, v169
    v_exp_f32 v170, v170
    v_exp_f32 v171, v171
    v_exp_f32 v0, v0
    v_exp_f32 v1, v1
    v_exp_f32 v2, v2
    v_exp_f32 v3, v3
    v_exp_f32 v4, v4
    v_exp_f32 v5, v5
    v_exp_f32 v6, v6
    v_exp_f32 v7, v7
    v_exp_f32 v8, v8
    v_exp_f32 v9, v9
    v_exp_f32 v10, v10
    v_exp_f32 v11, v11
    v_exp_f32 v12, v12
    v_exp_f32 v13, v13
    v_exp_f32 v14, v14
    v_exp_f32 v15, v15
    v_exp_f32 v112, v112
    v_exp_f32 v113, v113
    v_pk_add_f32 v[132:133], v[96:97], v[98:99]
    v_pk_add_f32 v[134:135], v[0:1], v[2:3]
    v_pk_add_f32 v[132:133], v[132:133], v[100:101]
    v_pk_add_f32 v[134:135], v[134:135], v[4:5]
    v_pk_add_f32 v[132:133], v[132:133], v[102:103]
    v_pk_add_f32 v[134:135], v[134:135], v[6:7]
    v_pk_add_f32 v[132:133], v[132:133], v[108:109]
    v_pk_add_f32 v[134:135], v[134:135], v[8:9]
    v_pk_add_f32 v[132:133], v[132:133], v[110:111]
    v_pk_add_f32 v[134:135], v[134:135], v[10:11]
    v_pk_add_f32 v[132:133], v[132:133], v[166:167]
    v_pk_add_f32 v[134:135], v[134:135], v[12:13]
    v_pk_add_f32 v[132:133], v[132:133], v[168:169]
    v_pk_add_f32 v[134:135], v[134:135], v[14:15]
    v_pk_add_f32 v[132:133], v[132:133], v[170:171]
    v_pk_add_f32 v[134:135], v[134:135], v[112:113]
    v_add_f32 v132, v132, v133
    v_add_f32 v134, v134, v135
    v_rcp_f32 v132, v132
    v_rcp_f32 v134, v134
    v_pk_mul_f32 v[96:97], v[96:97], v[132:133] op_sel_hi:[1,0]
    v_pk_mul_f32 v[98:99], v[98:99], v[132:133] op_sel_hi:[1,0]
    v_pk_mul_f32 v[100:101], v[100:101], v[132:133] op_sel_hi:[1,0]
    v_pk_mul_f32 v[102:103], v[102:103], v[132:133] op_sel_hi:[1,0]
    v_pk_mul_f32 v[108:109], v[108:109], v[132:133] op_sel_hi:[1,0]
    v_pk_mul_f32 v[110:111], v[110:111], v[132:133] op_sel_hi:[1,0]
    v_pk_mul_f32 v[166:167], v[166:167], v[132:133] op_sel_hi:[1,0]
    v_pk_mul_f32 v[168:169], v[168:169], v[132:133] op_sel_hi:[1,0]
    v_pk_mul_f32 v[170:171], v[170:171], v[132:133] op_sel_hi:[1,0]
    v_pk_mul_f32 v[0:1], v[0:1], v[134:135] op_sel_hi:[1,0]
    v_pk_mul_f32 v[2:3], v[2:3], v[134:135] op_sel_hi:[1,0]
    v_pk_mul_f32 v[4:5], v[4:5], v[134:135] op_sel_hi:[1,0]
    v_pk_mul_f32 v[6:7], v[6:7], v[134:135] op_sel_hi:[1,0]
    v_pk_mul_f32 v[8:9], v[8:9], v[134:135] op_sel_hi:[1,0]
    v_pk_mul_f32 v[10:11], v[10:11], v[134:135] op_sel_hi:[1,0]
    v_pk_mul_f32 v[12:13], v[12:13], v[134:135] op_sel_hi:[1,0]
    v_pk_mul_f32 v[14:15], v[14:15], v[134:135] op_sel_hi:[1,0]
    v_pk_mul_f32 v[112:113], v[112:113], v[134:135] op_sel_hi:[1,0]
    v_cvt_pk_bf16_f32 v186, v96, v97
    v_cvt_pk_bf16_f32 v187, v98, v99
    v_cvt_pk_bf16_f32 v188, v100, v101
    v_cvt_pk_bf16_f32 v189, v102, v103
    v_cvt_pk_bf16_f32 v190, v108, v109
    v_cvt_pk_bf16_f32 v191, v110, v111
    v_cvt_pk_bf16_f32 v192, v166, v167
    v_cvt_pk_bf16_f32 v193, v168, v169
    v_cvt_pk_bf16_f32 v194, v170, v171
    v_cvt_pk_bf16_f32 v195, v0, v1
    v_cvt_pk_bf16_f32 v196, v2, v3
    v_cvt_pk_bf16_f32 v197, v4, v5
    v_cvt_pk_bf16_f32 v198, v6, v7
    v_cvt_pk_bf16_f32 v199, v8, v9
    v_cvt_pk_bf16_f32 v200, v10, v11
    v_cvt_pk_bf16_f32 v201, v12, v13
    v_cvt_pk_bf16_f32 v202, v14, v15
    v_cvt_pk_bf16_f32 v203, v112, v113
    v_max3_f32 v128, v16, v17, v18
    v_min3_f32 v130, v16, v17, v18
    v_max3_f32 v128, v128, v19, v20
    v_min3_f32 v130, v130, v19, v20
    v_max3_f32 v128, v128, v21, v22
    v_min3_f32 v130, v130, v21, v22
    v_max3_f32 v128, v128, v23, v24
    v_min3_f32 v130, v130, v23, v24
    v_max3_f32 v128, v128, v25, v26
    v_min3_f32 v130, v130, v25, v26
    v_max3_f32 v128, v128, v27, v28
    v_min3_f32 v130, v130, v27, v28
    v_max3_f32 v128, v128, v29, v30
    v_min3_f32 v130, v130, v29, v30
    v_max3_f32 v128, v128, v31, v116
    v_min3_f32 v130, v130, v31, v116
    v_max_f32 v128, v128, v117
    v_min_f32 v130, v130, v117
    v_mul_f32 v128, s82, v128
    v_mul_f32 v130, s80, v130
    v_pk_fma_f32 v[96:97], v[16:17], s[80:81], v[128:129] op_sel_hi:[1,1,0]
    v_pk_fma_f32 v[16:17], v[16:17], s[82:83], v[130:131] op_sel_hi:[1,1,0]
    v_pk_fma_f32 v[98:99], v[18:19], s[80:81], v[128:129] op_sel_hi:[1,1,0]
    v_pk_fma_f32 v[18:19], v[18:19], s[82:83], v[130:131] op_sel_hi:[1,1,0]
    v_pk_fma_f32 v[100:101], v[20:21], s[80:81], v[128:129] op_sel_hi:[1,1,0]
    v_pk_fma_f32 v[20:21], v[20:21], s[82:83], v[130:131] op_sel_hi:[1,1,0]
    v_pk_fma_f32 v[102:103], v[22:23], s[80:81], v[128:129] op_sel_hi:[1,1,0]
    v_pk_fma_f32 v[22:23], v[22:23], s[82:83], v[130:131] op_sel_hi:[1,1,0]
    v_pk_fma_f32 v[108:109], v[24:25], s[80:81], v[128:129] op_sel_hi:[1,1,0]
    v_pk_fma_f32 v[24:25], v[24:25], s[82:83], v[130:131] op_sel_hi:[1,1,0]
    v_pk_fma_f32 v[110:111], v[26:27], s[80:81], v[128:129] op_sel_hi:[1,1,0]
    v_pk_fma_f32 v[26:27], v[26:27], s[82:83], v[130:131] op_sel_hi:[1,1,0]
    v_pk_fma_f32 v[166:167], v[28:29], s[80:81], v[128:129] op_sel_hi:[1,1,0]
    v_pk_fma_f32 v[28:29], v[28:29], s[82:83], v[130:131] op_sel_hi:[1,1,0]
    v_pk_fma_f32 v[168:169], v[30:31], s[80:81], v[128:129] op_sel_hi:[1,1,0]
    v_pk_fma_f32 v[30:31], v[30:31], s[82:83], v[130:131] op_sel_hi:[1,1,0]
    v_pk_fma_f32 v[170:171], v[116:117], s[80:81], v[128:129] op_sel_hi:[1,1,0]
    v_pk_fma_f32 v[116:117], v[116:117], s[82:83], v[130:131] op_sel_hi:[1,1,0]
    v_exp_f32 v96, v96
    v_exp_f32 v97, v97
    v_exp_f32 v98, v98
    v_exp_f32 v99, v99
    v_exp_f32 v100, v100
    v_exp_f32 v101, v101
    v_exp_f32 v102, v102
    v_exp_f32 v103, v103
    v_exp_f32 v108, v108
    v_exp_f32 v109, v109
    v_exp_f32 v110, v110
    v_exp_f32 v111, v111
    v_exp_f32 v166, v166
    v_exp_f32 v167, v167
    v_exp_f32 v168, v168
    v_exp_f32 v169, v169
    v_exp_f32 v170, v170
    v_exp_f32 v171, v171
    v_exp_f32 v16, v16
    v_exp_f32 v17, v17
    v_exp_f32 v18, v18
    v_exp_f32 v19, v19
    v_exp_f32 v20, v20
    v_exp_f32 v21, v21
    v_exp_f32 v22, v22
    v_exp_f32 v23, v23
    v_exp_f32 v24, v24
    v_exp_f32 v25, v25
    v_exp_f32 v26, v26
    v_exp_f32 v27, v27
    v_exp_f32 v28, v28
    v_exp_f32 v29, v29
    v_exp_f32 v30, v30
    v_exp_f32 v31, v31
    v_exp_f32 v116, v116
    v_exp_f32 v117, v117
    v_pk_add_f32 v[132:133], v[96:97], v[98:99]
    v_pk_add_f32 v[134:135], v[16:17], v[18:19]
    v_pk_add_f32 v[132:133], v[132:133], v[100:101]
    v_pk_add_f32 v[134:135], v[134:135], v[20:21]
    v_pk_add_f32 v[132:133], v[132:133], v[102:103]
    v_pk_add_f32 v[134:135], v[134:135], v[22:23]
    v_pk_add_f32 v[132:133], v[132:133], v[108:109]
    v_pk_add_f32 v[134:135], v[134:135], v[24:25]
    v_pk_add_f32 v[132:133], v[132:133], v[110:111]
    v_pk_add_f32 v[134:135], v[134:135], v[26:27]
    v_pk_add_f32 v[132:133], v[132:133], v[166:167]
    v_pk_add_f32 v[134:135], v[134:135], v[28:29]
    v_pk_add_f32 v[132:133], v[132:133], v[168:169]
    v_pk_add_f32 v[134:135], v[134:135], v[30:31]
    v_pk_add_f32 v[132:133], v[132:133], v[170:171]
    v_pk_add_f32 v[134:135], v[134:135], v[116:117]
    v_add_f32 v132, v132, v133
    v_add_f32 v134, v134, v135
    v_rcp_f32 v132, v132
    v_rcp_f32 v134, v134
    v_pk_mul_f32 v[96:97], v[96:97], v[132:133] op_sel_hi:[1,0]
    v_pk_mul_f32 v[98:99], v[98:99], v[132:133] op_sel_hi:[1,0]
    v_pk_mul_f32 v[100:101], v[100:101], v[132:133] op_sel_hi:[1,0]
    v_pk_mul_f32 v[102:103], v[102:103], v[132:133] op_sel_hi:[1,0]
    v_pk_mul_f32 v[108:109], v[108:109], v[132:133] op_sel_hi:[1,0]
    v_pk_mul_f32 v[110:111], v[110:111], v[132:133] op_sel_hi:[1,0]
    v_pk_mul_f32 v[166:167], v[166:167], v[132:133] op_sel_hi:[1,0]
    v_pk_mul_f32 v[168:169], v[168:169], v[132:133] op_sel_hi:[1,0]
    v_pk_mul_f32 v[170:171], v[170:171], v[132:133] op_sel_hi:[1,0]
    v_pk_mul_f32 v[16:17], v[16:17], v[134:135] op_sel_hi:[1,0]
    v_pk_mul_f32 v[18:19], v[18:19], v[134:135] op_sel_hi:[1,0]
    v_pk_mul_f32 v[20:21], v[20:21], v[134:135] op_sel_hi:[1,0]
    v_pk_mul_f32 v[22:23], v[22:23], v[134:135] op_sel_hi:[1,0]
    v_pk_mul_f32 v[24:25], v[24:25], v[134:135] op_sel_hi:[1,0]
    v_pk_mul_f32 v[26:27], v[26:27], v[134:135] op_sel_hi:[1,0]
    v_pk_mul_f32 v[28:29], v[28:29], v[134:135] op_sel_hi:[1,0]
    v_pk_mul_f32 v[30:31], v[30:31], v[134:135] op_sel_hi:[1,0]
    v_pk_mul_f32 v[116:117], v[116:117], v[134:135] op_sel_hi:[1,0]
    v_cvt_pk_bf16_f32 v206, v96, v97
    v_cvt_pk_bf16_f32 v207, v98, v99
    v_cvt_pk_bf16_f32 v208, v100, v101
    v_cvt_pk_bf16_f32 v209, v102, v103
    v_cvt_pk_bf16_f32 v210, v108, v109
    v_cvt_pk_bf16_f32 v211, v110, v111
    v_cvt_pk_bf16_f32 v212, v166, v167
    v_cvt_pk_bf16_f32 v213, v168, v169
    v_cvt_pk_bf16_f32 v214, v170, v171
    v_cvt_pk_bf16_f32 v215, v16, v17
    v_cvt_pk_bf16_f32 v216, v18, v19
    v_cvt_pk_bf16_f32 v217, v20, v21
    v_cvt_pk_bf16_f32 v218, v22, v23
    v_cvt_pk_bf16_f32 v219, v24, v25
    v_cvt_pk_bf16_f32 v220, v26, v27
    v_cvt_pk_bf16_f32 v221, v28, v29
    v_cvt_pk_bf16_f32 v222, v30, v31
    v_cvt_pk_bf16_f32 v223, v116, v117
    v_mov_b32 v204, 0
    v_mov_b32 v205, 0
    v_mov_b32 v224, 0
    v_mov_b32 v225, 0
    s_barrier
L_dry_Bo:
    ds_read_b128 v[148:151], v250 offset:0
    ds_read_b128 v[152:155], v250 offset:16
    ds_read_b128 v[156:159], v250 offset:32
    ds_read_b128 v[160:163], v250 offset:48
    ds_read_b128 v[164:167], v250 offset:64
    ds_read_b128 v[32:35], v251 offset:0
    ds_read_b128 v[36:39], v251 offset:16
    ds_read_b128 v[40:43], v251 offset:32
    ds_read_b128 v[44:47], v251 offset:48
    ds_read_b128 v[48:51], v251 offset:64
    ds_read_b128 v[128:131], v249 offset:0
    ds_read_b128 v[132:135], v249 offset:16
    ds_read_b128 v[136:139], v249 offset:32
    ds_read_b128 v[140:143], v249 offset:48
    ds_read_b128 v[144:147], v249 offset:64
    s_waitcnt lgkmcnt(14)
    v_mfma_f32_32x32x16_bf16 v[112:127], v[148:151], v[186:189], 0
    ds_read_b128 v[90:93], v249 offset:1536
    s_waitcnt lgkmcnt(14)
    v_mfma_f32_32x32x16_bf16 v[112:127], v[152:155], v[190:193], v[112:127]
    ds_read_b128 v[94:97], v249 offset:1552
    s_waitcnt lgkmcnt(14)
    v_mfma_f32_32x32x16_bf16 v[112:127], v[156:159], v[194:197], v[112:127]
    ds_read_b128 v[98:101], v249 offset:1568
    s_waitcnt lgkmcnt(14)
    v_mfma_f32_32x32x16_bf16 v[112:127], v[160:163], v[198:201], v[112:127]
    ds_read_b128 v[102:105], v249 offset:1584
    s_waitcnt lgkmcnt(14)
    v_mfma_f32_32x32x16_bf16 v[112:127], v[164:167], v[202:205], v[112:127]
    ds_read_b128 v[106:109], v249 offset:1600
    s_waitcnt lgkmcnt(10)
    v_mfma_f32_32x32x16_bf16 v[112:127], v[32:35], v[206:209], v[112:127]
    v_mfma_f32_32x32x16_bf16 v[112:127], v[36:39], v[210:213], v[112:127]
    v_mfma_f32_32x32x16_bf16 v[112:127], v[40:43], v[214:217], v[112:127]
    v_mfma_f32_32x32x16_bf16 v[112:127], v[44:47], v[218:221], v[112:127]
    v_mfma_f32_32x32x16_bf16 v[112:127], v[48:51], v[222:225], v[112:127]
    s_waitcnt lgkmcnt(0)
    v_mfma_f32_32x32x16_bf16 v[0:15], v[128:131], v[186:189], 0
    v_mfma_f32_32x32x16_bf16 v[0:15], v[132:135], v[190:193], v[0:15]
    v_mfma_f32_32x32x16_bf16 v[0:15], v[136:139], v[194:197], v[0:15]
    v_mfma_f32_32x32x16_bf16 v[0:15], v[140:143], v[198:201], v[0:15]
    v_mfma_f32_32x32x16_bf16 v[0:15], v[144:147], v[202:205], v[0:15]
    v_mfma_f32_32x32x16_bf16 v[16:31], v[90:93], v[206:209], 0
    s_nop 4
    v_add_f32 v52, 0x358637bd, v114
    v_add_f32 v54, 0x358637bd, v118
    v_rcp_f32 v52, v52
    v_rcp_f32 v54, v54
    v_mul_f32 v52, v52, v253
    v_mul_f32 v54, v54, v253
    v_pk_mul_f32 v[112:113], v[112:113], v[52:53] op_sel_hi:[1,0]
    v_mfma_f32_32x32x16_bf16 v[16:31], v[94:97], v[210:213], v[16:31]
    v_pk_mul_f32 v[0:1], v[0:1], v[52:53] op_sel_hi:[1,0]
    v_pk_mul_f32 v[2:3], v[2:3], v[52:53] op_sel_hi:[1,0]
    v_pk_mul_f32 v[4:5], v[4:5], v[52:53] op_sel_hi:[1,0]
    v_pk_mul_f32 v[6:7], v[6:7], v[52:53] op_sel_hi:[1,0]
    v_pk_mul_f32 v[8:9], v[8:9], v[52:53] op_sel_hi:[1,0]
    v_mfma_f32_32x32x16_bf16 v[16:31], v[98:101], v[214:217], v[16:31]
    v_pk_mul_f32 v[10:11], v[10:11], v[52:53] op_sel_hi:[1,0]
    v_pk_mul_f32 v[12:13], v[12:13], v[52:53] op_sel_hi:[1,0]
    v_pk_mul_f32 v[14:15], v[14:15], v[52:53] op_sel_hi:[1,0]
    v_cvt_pk_bf16_f32 v176, v112, v113
    v_cvt_pk_bf16_f32 v168, v0, v1
    v_mfma_f32_32x32x16_bf16 v[16:31], v[102:105], v[218:221], v[16:31]
    v_cvt_pk_bf16_f32 v169, v2, v3
    v_cvt_pk_bf16_f32 v170, v4, v5
    v_cvt_pk_bf16_f32 v171, v6, v7
    v_cvt_pk_bf16_f32 v172, v8, v9
    v_cvt_pk_bf16_f32 v173, v10, v11
    v_mfma_f32_32x32x16_bf16 v[16:31], v[106:109], v[222:225], v[16:31]
    v_cvt_pk_bf16_f32 v174, v12, v13
    v_cvt_pk_bf16_f32 v175, v14, v15
    v_pk_mul_f32 v[116:117], v[116:117], v[54:55] op_sel_hi:[1,0]
    s_nop 8
    v_pk_mul_f32 v[16:17], v[16:17], v[54:55] op_sel_hi:[1,0]
    ds_write_b64 v252, v[168:169] offset:0
    v_pk_mul_f32 v[18:19], v[18:19], v[54:55] op_sel_hi:[1,0]
    v_pk_mul_f32 v[20:21], v[20:21], v[54:55] op_sel_hi:[1,0]
    ds_write_b64 v252, v[170:171] offset:8
    v_pk_mul_f32 v[22:23], v[22:23], v[54:55] op_sel_hi:[1,0]
    v_pk_mul_f32 v[24:25], v[24:25], v[54:55] op_sel_hi:[1,0]
    ds_write_b64 v252, v[172:173] offset:16
    v_pk_mul_f32 v[26:27], v[26:27], v[54:55] op_sel_hi:[1,0]
    v_pk_mul_f32 v[28:29], v[28:29], v[54:55] op_sel_hi:[1,0]
    ds_write_b64 v252, v[174:175] offset:24
    v_pk_mul_f32 v[30:31], v[30:31], v[54:55] op_sel_hi:[1,0]
    v_cvt_pk_bf16_f32 v185, v116, v117
    v_cvt_pk_bf16_f32 v177, v16, v17
    v_cvt_pk_bf16_f32 v178, v18, v19
    v_cvt_pk_bf16_f32 v179, v20, v21
    v_cvt_pk_bf16_f32 v180, v22, v23
    v_cvt_pk_bf16_f32 v181, v24, v25
    v_cvt_pk_bf16_f32 v182, v26, v27
    v_cvt_pk_bf16_f32 v183, v28, v29
    v_cvt_pk_bf16_f32 v184, v30, v31
    ds_write_b64 v252, v[176:177] offset:32
    ds_write_b64 v252, v[178:179] offset:40
    ds_write_b64 v252, v[180:181] offset:48
    ds_write_b64 v252, v[182:183] offset:56
    ds_write_b64 v252, v[184:185] offset:64
    s_waitcnt lgkmcnt(0)
    s_cbranch_execz L_dry_ret
L12_P3B_compute:
    s_barrier
    s_cmp_eq_u32 s43, 0
    s_cbranch_scc1 L12_P3_fin
    v_and_b32 v20, 31, v255
    v_lshrrev_b32 v245, 5, v255
    v_bfe_u32 v21, v255, 2, 2
    v_lshlrev_b32 v23, 7, v21
    v_lshrrev_b32 v21, 1, v21
    s_and_b32 s30, s28, 1
    v_xor_b32 v21, s30, v21
    v_lshl_add_u32 v23, v21, 6, v23
    v_bfe_u32 v21, v255, 4, 1
    v_lshl_add_u32 v23, v21, 5, v23
    v_and_b32 v21, 3, v255
    v_lshl_add_u32 v244, v21, 3, v23
    s_cmp_ge_u32 s28, 2
    s_cbranch_scc1 L12_P3B_sp1
L_dry_PB0:
    s_mov_b32 s30, 9216
    v_mad_i32_i24 v24, v245, s30, v244
    v_add_u32 v24, 151552, v24
    ds_read_b64_tr_b16 v[96:97], v24 offset:0
    ds_read_b64_tr_b16 v[98:99], v24 offset:512
    s_mov_b32 s30, 9216
    v_mad_i32_i24 v25, v245, s30, v244
    v_add_u32 v25, 153600, v25
    ds_read_b64_tr_b16 v[100:101], v25 offset:0
    ds_read_b64_tr_b16 v[102:103], v25 offset:512
    s_mov_b32 s30, -122288
    v_mad_i32_i24 v26, v245, s30, v244
    v_add_u32 v26, 155648, v26
    ds_read_b64_tr_b16 v[104:105], v26 offset:0
    ds_read_b64_tr_b16 v[106:107], v26 offset:512
    s_mov_b32 s30, -62736
    v_mad_i32_i24 v27, v245, s30, v244
    v_add_u32 v27, 157696, v27
    ds_read_b64_tr_b16 v[108:109], v27 offset:0
    ds_read_b64_tr_b16 v[110:111], v27 offset:512
    s_mov_b32 s30, -125360
    v_mad_i32_i24 v28, v245, s30, v244
    v_add_u32 v28, 159744, v28
    ds_read_b64_tr_b16 v[112:113], v28 offset:0
    ds_read_b64_tr_b16 v[114:115], v28 offset:512
    s_mov_b32 s30, -86240
    v_mad_i32_i24 v29, v245, s30, v244
    v_add_u32 v29, 95984, v29
    ds_read_b64_tr_b16 v[116:117], v29 offset:0
    ds_read_b64_tr_b16 v[118:119], v29 offset:512
    s_mov_b32 s30, 35936
    v_mad_i32_i24 v30, v245, s30, v244
    v_add_u32 v30, 35408, v30
    ds_read_b64_tr_b16 v[120:121], v30 offset:0
    ds_read_b64_tr_b16 v[122:123], v30 offset:512
    s_mov_b32 s30, -86240
    v_mad_i32_i24 v31, v245, s30, v244
    v_add_u32 v31, 97008, v31
    ds_read_b64_tr_b16 v[124:125], v31 offset:0
    ds_read_b64_tr_b16 v[126:127], v31 offset:512
    s_mov_b32 s30, 32848
    v_mad_i32_i24 v24, v245, s30, v244
    v_add_u32 v24, 39520, v24
    ds_read_b64_tr_b16 v[128:129], v24 offset:0
    ds_read_b64_tr_b16 v[130:131], v24 offset:512
    s_mov_b32 s30, 32848
    v_mad_i32_i24 v25, v245, s30, v244
    v_add_u32 v25, 14880, v25
    ds_read_b64_tr_b16 v[132:133], v25 offset:0
    ds_read_b64_tr_b16 v[134:135], v25 offset:512
    s_mov_b32 s30, 32848
    v_mad_i32_i24 v26, v245, s30, v244
    v_add_u32 v26, 76480, v26
    ds_read_b64_tr_b16 v[136:137], v26 offset:0
    ds_read_b64_tr_b16 v[138:139], v26 offset:512
    s_mov_b32 s30, 35936
    v_mad_i32_i24 v27, v245, s30, v244
    v_add_u32 v27, 15904, v27
    ds_read_b64_tr_b16 v[140:141], v27 offset:0
    ds_read_b64_tr_b16 v[142:143], v27 offset:512
    s_mov_b32 s30, 35936
    v_mad_i32_i24 v28, v245, s30, v244
    v_add_u32 v28, 77504, v28
    ds_read_b64_tr_b16 v[144:145], v28 offset:0
    ds_read_b64_tr_b16 v[146:147], v28 offset:512
    s_mov_b32 s30, 35936
    v_mad_i32_i24 v29, v245, s30, v244
    v_add_u32 v29, 16928, v29
    ds_read_b64_tr_b16 v[148:149], v29 offset:0
    ds_read_b64_tr_b16 v[150:151], v29 offset:512
    s_mov_b32 s30, -86240
    v_mad_i32_i24 v30, v245, s30, v244
    v_add_u32 v30, 114464, v30
    ds_read_b64_tr_b16 v[152:153], v30 offset:0
    ds_read_b64_tr_b16 v[154:155], v30 offset:512
    s_mov_b32 s30, 35936
    v_mad_i32_i24 v31, v245, s30, v244
    v_add_u32 v31, 53888, v31
    ds_read_b64_tr_b16 v[156:157], v31 offset:0
    ds_read_b64_tr_b16 v[158:159], v31 offset:512
    s_mov_b32 s30, -86240
    v_mad_i32_i24 v24, v245, s30, v244
    v_add_u32 v24, 115488, v24
    ds_read_b64_tr_b16 v[160:161], v24 offset:0
    ds_read_b64_tr_b16 v[162:163], v24 offset:512
    s_mov_b32 s30, 32848
    v_mad_i32_i24 v25, v245, s30, v244
    v_add_u32 v25, 58000, v25
    ds_read_b64_tr_b16 v[164:165], v25 offset:0
    ds_read_b64_tr_b16 v[166:167], v25 offset:512
    s_waitcnt lgkmcnt(0)
    s_cbranch_execz L_dry_ret
    s_barrier
L12_P3B_pb0:
    v_mul_u32_u24 v21, 9216, v245
    s_mov_b32 s30, 49152
    v_add3_u32 v246, v244, v21, s30
    v_mul_u32_u24 v20, 144, v20
    v_mul_u32_u24 v21, 13824, v245
    v_add_u32 v240, v20, v21
    v_add_u32 v241, 49152, v240
    v_add_u32 v242, 98304, v240
    v_mov_b32 v0, 0
    v_mov_b32 v1, 0
    v_mov_b32 v2, 0
    v_mov_b32 v3, 0
    v_mov_b32 v4, 0
    v_mov_b32 v5, 0
    v_mov_b32 v6, 0
    v_mov_b32 v7, 0
    v_mov_b32 v8, 0
    v_mov_b32 v9, 0
    v_mov_b32 v10, 0
    v_mov_b32 v11, 0
    v_mov_b32 v12, 0
    v_mov_b32 v13, 0
    v_mov_b32 v14, 0
    v_mov_b32 v15, 0
    v_mov_b32 v16, 0
    v_mov_b32 v17, 0
    v_mov_b32 v18, 0
    v_mov_b32 v19, 0
    v_mov_b32 v20, 0
    v_mov_b32 v21, 0
    v_mov_b32 v22, 0
    v_mov_b32 v23, 0
    v_mov_b32 v24, 0
    v_mov_b32 v25, 0
    v_mov_b32 v26, 0
    v_mov_b32 v27, 0
    v_mov_b32 v28, 0
    v_mov_b32 v29, 0
    v_mov_b32 v30, 0
    v_mov_b32 v31, 0
    v_mov_b32 v32, 0
    v_mov_b32 v33, 0
    v_mov_b32 v34, 0
    v_mov_b32 v35, 0
    v_mov_b32 v36, 0
    v_mov_b32 v37, 0
    v_mov_b32 v38, 0
    v_mov_b32 v39, 0
    v_mov_b32 v40, 0
    v_mov_b32 v41, 0
    v_mov_b32 v42, 0
    v_mov_b32 v43, 0
    v_mov_b32 v44, 0
    v_mov_b32 v45, 0
    v_mov_b32 v46, 0
    v_mov_b32 v47, 0
    s_mov_b32 s20, s54
    s_mov_b32 s21, s55
    s_mov_b32 s22, 2359296
    s_mov_b32 s23, 0x20000
    s_lshl_b32 s30, s28, 3
    v_lshrrev_b32 v60, 3, v255
    v_add_u32 v60, s30, v60
    v_and_b32 v61, 7, v255
    v_lshlrev_b32 v61, 4, v61
    v_mul_u32_u24 v251, 144, v60
    s_mov_b32 s30, 24576
    v_add3_u32 v251, v251, v61, s30
    v_add_u32 v60, s84, v60
    v_mul_u32_u24 v60, 1152, v60
    s_lshl_b32 s30, s85, 7
    v_add3_u32 v252, v60, v61, s30
    s_mov_b32 s73, 73728
    s_lshl_b32 s72, s26, 2
    s_xor_b32 s31, s28, 2
    s_mul_i32 s30, s28, 6144
    s_mul_i32 s31, s31, 6144
    s_add_u32 s30, s30, 82944
    s_add_u32 s31, s31, 82944
    v_add_u32 v247, s30, v248
    v_add_u32 v249, s31, v248
    v_and_b32 v250, 31, v255
    v_mul_u32_u24 v250, 144, v250
    v_lshl_add_u32 v250, v245, 3, v250
    s_and_b32 s30, s28, 1
    s_lshl_b32 s30, s30, 6
    s_add_u32 s30, s30, 24576
    v_add_u32 v250, s30, v250
    s_barrier
L12_P3B_s0:
    ds_read_b64_tr_b16 v[168:169], v246 offset:0
    ds_read_b64_tr_b16 v[170:171], v246 offset:512
    ds_read_b64_tr_b16 v[172:173], v246 offset:2048
    ds_read_b64_tr_b16 v[174:175], v246 offset:2560
    ds_read_b64_tr_b16 v[176:177], v246 offset:4096
    ds_read_b64_tr_b16 v[178:179], v246 offset:4608
    ds_read_b64_tr_b16 v[180:181], v246 offset:6144
    ds_read_b64_tr_b16 v[182:183], v246 offset:6656
    ds_read_b64_tr_b16 v[184:185], v246 offset:8192
    ds_read_b64_tr_b16 v[186:187], v246 offset:8704
    ds_read_b64_tr_b16 v[188:189], v246 offset:19456
    ds_read_b64_tr_b16 v[190:191], v246 offset:19968
    ds_read_b64_tr_b16 v[192:193], v246 offset:21504
    ds_read_b64_tr_b16 v[194:195], v246 offset:22016
    ds_read_b64_tr_b16 v[196:197], v246 offset:23552
    ds_read_b64_tr_b16 v[198:199], v246 offset:24064
    ds_read_b64_tr_b16 v[200:201], v246 offset:25600
    ds_read_b64_tr_b16 v[202:203], v246 offset:26112
    ds_read_b64_tr_b16 v[204:205], v246 offset:36864
    ds_read_b64_tr_b16 v[206:207], v246 offset:37376
    ds_read_b64_tr_b16 v[208:209], v246 offset:38912
    ds_read_b64_tr_b16 v[210:211], v246 offset:39424
    ds_read_b64_tr_b16 v[212:213], v246 offset:40960
    ds_read_b64_tr_b16 v[214:215], v246 offset:41472
    ds_read_b64_tr_b16 v[216:217], v246 offset:43008
    ds_read_b64_tr_b16 v[218:219], v246 offset:43520
    ds_read_b64_tr_b16 v[220:221], v246 offset:45056
    ds_read_b64_tr_b16 v[222:223], v246 offset:45568
    ds_read_b64_tr_b16 v[224:225], v246 offset:56320
    ds_read_b64_tr_b16 v[226:227], v246 offset:56832
    ds_read_b64_tr_b16 v[228:229], v246 offset:58368
    ds_read_b64_tr_b16 v[230:231], v246 offset:58880
    ds_read_b64_tr_b16 v[232:233], v246 offset:60416
    ds_read_b64_tr_b16 v[234:235], v246 offset:60928
    ds_read_b64_tr_b16 v[236:237], v246 offset:62464
    ds_read_b64_tr_b16 v[238:239], v246 offset:62976
    s_waitcnt lgkmcnt(0)
    s_barrier
    s_barrier
    ds_read_b128 v[48:51], v240 offset:0
    ds_read_b128 v[52:55], v240 offset:4608
    ds_read_b128 v[56:59], v240 offset:9216
    ds_read_b128 v[60:63], v240 offset:32
    ds_read_b128 v[64:67], v240 offset:4640
    ds_read_b128 v[68:71], v240 offset:9248
    ds_read_b128 v[72:75], v240 offset:64
    ds_read_b128 v[76:79], v240 offset:4672
    ds_read_b128 v[80:83], v240 offset:9280
    s_waitcnt lgkmcnt(6)
    v_mfma_f32_32x32x16_bf16 v[0:15], v[96:99], v[48:51], v[0:15]
    ds_read_b128 v[84:87], v240 offset:96
    ds_read_b128 v[88:91], v240 offset:4704
    ds_read_b128 v[92:95], v240 offset:9312
    v_mfma_f32_32x32x16_bf16 v[16:31], v[96:99], v[52:55], v[16:31]
    v_mfma_f32_32x32x16_bf16 v[32:47], v[96:99], v[56:59], v[32:47]
    s_waitcnt lgkmcnt(6)
    v_mfma_f32_32x32x16_bf16 v[0:15], v[100:103], v[60:63], v[0:15]
    ds_read_b128 v[48:51], v240 offset:128
    ds_read_b128 v[52:55], v240 offset:4736
    ds_read_b128 v[56:59], v240 offset:9344
    v_mfma_f32_32x32x16_bf16 v[16:31], v[100:103], v[64:67], v[16:31]
    v_mfma_f32_32x32x16_bf16 v[32:47], v[100:103], v[68:71], v[32:47]
    s_waitcnt lgkmcnt(6)
    v_mfma_f32_32x32x16_bf16 v[0:15], v[104:107], v[72:75], v[0:15]
    s_barrier
    ds_read_b128 v[60:63], v240 offset:27664
    ds_read_b128 v[64:67], v240 offset:32272
    ds_read_b128 v[68:71], v240 offset:36880
    v_mfma_f32_32x32x16_bf16 v[16:31], v[104:107], v[76:79], v[16:31]
    v_mfma_f32_32x32x16_bf16 v[32:47], v[104:107], v[80:83], v[32:47]
    s_waitcnt lgkmcnt(6)
    v_mfma_f32_32x32x16_bf16 v[0:15], v[108:111], v[84:87], v[0:15]
    ds_read_b128 v[72:75], v240 offset:27696
    ds_read_b128 v[76:79], v240 offset:32304
    ds_read_b128 v[80:83], v240 offset:36912
    v_mfma_f32_32x32x16_bf16 v[16:31], v[108:111], v[88:91], v[16:31]
    v_mfma_f32_32x32x16_bf16 v[32:47], v[108:111], v[92:95], v[32:47]
    s_waitcnt lgkmcnt(6)
    v_mfma_f32_32x32x16_bf16 v[0:15], v[112:115], v[48:51], v[0:15]
    ds_read_b128 v[84:87], v240 offset:27728
    ds_read_b128 v[88:91], v240 offset:32336
    ds_read_b128 v[92:95], v240 offset:36944
    v_mfma_f32_32x32x16_bf16 v[16:31], v[112:115], v[52:55], v[16:31]
    v_mfma_f32_32x32x16_bf16 v[32:47], v[112:115], v[56:59], v[32:47]
    s_waitcnt lgkmcnt(6)
    v_mfma_f32_32x32x16_bf16 v[0:15], v[116:119], v[60:63], v[0:15]
    ds_read_b128 v[48:51], v240 offset:27760
    ds_read_b128 v[52:55], v240 offset:32368
    ds_read_b128 v[56:59], v240 offset:36976
    v_mfma_f32_32x32x16_bf16 v[16:31], v[116:119], v[64:67], v[16:31]
    v_mfma_f32_32x32x16_bf16 v[32:47], v[116:119], v[68:71], v[32:47]
    s_waitcnt lgkmcnt(6)
    v_mfma_f32_32x32x16_bf16 v[0:15], v[120:123], v[72:75], v[0:15]
    s_barrier
    ds_read_b128 v[60:63], v241 offset:6144
    ds_read_b128 v[64:67], v241 offset:10752
    ds_read_b128 v[68:71], v241 offset:15360
    v_mfma_f32_32x32x16_bf16 v[16:31], v[120:123], v[76:79], v[16:31]
    v_mfma_f32_32x32x16_bf16 v[32:47], v[120:123], v[80:83], v[32:47]
    s_waitcnt lgkmcnt(6)
    v_mfma_f32_32x32x16_bf16 v[0:15], v[124:127], v[84:87], v[0:15]
    ds_read_b128 v[72:75], v241 offset:6176
    ds_read_b128 v[76:79], v241 offset:10784
    ds_read_b128 v[80:83], v241 offset:15392
    v_mfma_f32_32x32x16_bf16 v[16:31], v[124:127], v[88:91], v[16:31]
    v_mfma_f32_32x32x16_bf16 v[32:47], v[124:127], v[92:95], v[32:47]
    s_waitcnt lgkmcnt(6)
    v_mfma_f32_32x32x16_bf16 v[0:15], v[128:131], v[48:51], v[0:15]
    ds_read_b128 v[84:87], v241 offset:6208
    ds_read_b128 v[88:91], v241 offset:10816
    ds_read_b128 v[92:95], v241 offset:15424
    v_mfma_f32_32x32x16_bf16 v[16:31], v[128:131], v[52:55], v[16:31]
    v_mfma_f32_32x32x16_bf16 v[32:47], v[128:131], v[56:59], v[32:47]
    s_waitcnt lgkmcnt(6)
    v_mfma_f32_32x32x16_bf16 v[0:15], v[132:135], v[60:63], v[0:15]
    ds_read_b128 v[48:51], v241 offset:6240
    ds_read_b128 v[52:55], v241 offset:10848
    ds_read_b128 v[56:59], v241 offset:15456
    v_mfma_f32_32x32x16_bf16 v[16:31], v[132:135], v[64:67], v[16:31]
    v_mfma_f32_32x32x16_bf16 v[32:47], v[132:135], v[68:71], v[32:47]
    s_waitcnt lgkmcnt(6)
    v_mfma_f32_32x32x16_bf16 v[0:15], v[136:139], v[72:75], v[0:15]
    ds_read_b128 v[60:63], v241 offset:6272
    ds_read_b128 v[64:67], v241 offset:10880
    ds_read_b128 v[68:71], v241 offset:15488
    v_mfma_f32_32x32x16_bf16 v[16:31], v[136:139], v[76:79], v[16:31]
    v_mfma_f32_32x32x16_bf16 v[32:47], v[136:139], v[80:83], v[32:47]
    s_waitcnt lgkmcnt(6)
    v_mfma_f32_32x32x16_bf16 v[0:15], v[140:143], v[84:87], v[0:15]
    s_barrier
    ds_read_b128 v[72:75], v241 offset:33808
    ds_read_b128 v[76:79], v241 offset:38416
    ds_read_b128 v[80:83], v241 offset:43024
    v_mfma_f32_32x32x16_bf16 v[16:31], v[140:143], v[88:91], v[16:31]
    v_mfma_f32_32x32x16_bf16 v[32:47], v[140:143], v[92:95], v[32:47]
    s_waitcnt lgkmcnt(6)
    v_mfma_f32_32x32x16_bf16 v[0:15], v[144:147], v[48:51], v[0:15]
    ds_read_b128 v[84:87], v241 offset:33840
    ds_read_b128 v[88:91], v241 offset:38448
    ds_read_b128 v[92:95], v241 offset:43056
    v_mfma_f32_32x32x16_bf16 v[16:31], v[144:147], v[52:55], v[16:31]
    v_mfma_f32_32x32x16_bf16 v[32:47], v[144:147], v[56:59], v[32:47]
    s_waitcnt lgkmcnt(6)
    v_mfma_f32_32x32x16_bf16 v[0:15], v[148:151], v[60:63], v[0:15]
    ds_read_b128 v[48:51], v241 offset:33872
    ds_read_b128 v[52:55], v241 offset:38480
    ds_read_b128 v[56:59], v241 offset:43088
    v_mfma_f32_32x32x16_bf16 v[16:31], v[148:151], v[64:67], v[16:31]
    v_mfma_f32_32x32x16_bf16 v[32:47], v[148:151], v[68:71], v[32:47]
    s_waitcnt lgkmcnt(6)
    v_mfma_f32_32x32x16_bf16 v[0:15], v[152:155], v[72:75], v[0:15]
    ds_read_b128 v[60:63], v241 offset:33904
    ds_read_b128 v[64:67], v241 offset:38512
    ds_read_b128 v[68:71], v241 offset:43120
    v_mfma_f32_32x32x16_bf16 v[16:31], v[152:155], v[76:79], v[16:31]
    v_mfma_f32_32x32x16_bf16 v[32:47], v[152:155], v[80:83], v[32:47]
    s_waitcnt lgkmcnt(6)
    v_mfma_f32_32x32x16_bf16 v[0:15], v[156:159], v[84:87], v[0:15]
    s_barrier
    ds_read_b128 v[72:75], v242 offset:12288
    ds_read_b128 v[76:79], v242 offset:16896
    ds_read_b128 v[80:83], v242 offset:21504
    v_mfma_f32_32x32x16_bf16 v[16:31], v[156:159], v[88:91], v[16:31]
    v_mfma_f32_32x32x16_bf16 v[32:47], v[156:159], v[92:95], v[32:47]
    s_waitcnt lgkmcnt(6)
    v_mfma_f32_32x32x16_bf16 v[0:15], v[160:163], v[48:51], v[0:15]
    ds_read_b128 v[84:87], v242 offset:12320
    ds_read_b128 v[88:91], v242 offset:16928
    ds_read_b128 v[92:95], v242 offset:21536
    v_mfma_f32_32x32x16_bf16 v[16:31], v[160:163], v[52:55], v[16:31]
    v_mfma_f32_32x32x16_bf16 v[32:47], v[160:163], v[56:59], v[32:47]
    s_waitcnt lgkmcnt(6)
    v_mfma_f32_32x32x16_bf16 v[0:15], v[164:167], v[60:63], v[0:15]
    ds_read_b128 v[48:51], v242 offset:12352
    ds_read_b128 v[52:55], v242 offset:16960
    ds_read_b128 v[56:59], v242 offset:21568
    v_mfma_f32_32x32x16_bf16 v[16:31], v[164:167], v[64:67], v[16:31]
    v_mfma_f32_32x32x16_bf16 v[32:47], v[164:167], v[68:71], v[32:47]
    s_waitcnt lgkmcnt(6)
    v_mfma_f32_32x32x16_bf16 v[0:15], v[168:171], v[72:75], v[0:15]
    ds_read_b128 v[60:63], v242 offset:12384
    ds_read_b128 v[64:67], v242 offset:16992
    ds_read_b128 v[68:71], v242 offset:21600
    v_mfma_f32_32x32x16_bf16 v[16:31], v[168:171], v[76:79], v[16:31]
    v_mfma_f32_32x32x16_bf16 v[32:47], v[168:171], v[80:83], v[32:47]
    s_waitcnt lgkmcnt(6)
    v_mfma_f32_32x32x16_bf16 v[0:15], v[172:175], v[84:87], v[0:15]
    ds_read_b128 v[72:75], v242 offset:12416
    ds_read_b128 v[76:79], v242 offset:17024
    ds_read_b128 v[80:83], v242 offset:21632
    v_mfma_f32_32x32x16_bf16 v[16:31], v[172:175], v[88:91], v[16:31]
    v_mfma_f32_32x32x16_bf16 v[32:47], v[172:175], v[92:95], v[32:47]
    s_waitcnt lgkmcnt(6)
    v_mfma_f32_32x32x16_bf16 v[0:15], v[176:179], v[48:51], v[0:15]
    s_barrier
    ds_read_b128 v[84:87], v240 offset:16
    ds_read_b128 v[88:91], v240 offset:4624
    ds_read_b128 v[92:95], v240 offset:9232
    v_mfma_f32_32x32x16_bf16 v[16:31], v[176:179], v[52:55], v[16:31]
    v_mfma_f32_32x32x16_bf16 v[32:47], v[176:179], v[56:59], v[32:47]
    s_waitcnt lgkmcnt(6)
    v_mfma_f32_32x32x16_bf16 v[0:15], v[180:183], v[60:63], v[0:15]
    ds_read_b128 v[48:51], v240 offset:48
    ds_read_b128 v[52:55], v240 offset:4656
    ds_read_b128 v[56:59], v240 offset:9264
    v_mfma_f32_32x32x16_bf16 v[16:31], v[180:183], v[64:67], v[16:31]
    v_mfma_f32_32x32x16_bf16 v[32:47], v[180:183], v[68:71], v[32:47]
    s_waitcnt lgkmcnt(6)
    v_mfma_f32_32x32x16_bf16 v[0:15], v[184:187], v[72:75], v[0:15]
    ds_read_b128 v[60:63], v240 offset:80
    ds_read_b128 v[64:67], v240 offset:4688
    ds_read_b128 v[68:71], v240 offset:9296
    v_mfma_f32_32x32x16_bf16 v[16:31], v[184:187], v[76:79], v[16:31]
    v_mfma_f32_32x32x16_bf16 v[32:47], v[184:187], v[80:83], v[32:47]
    s_waitcnt lgkmcnt(6)
    v_mfma_f32_32x32x16_bf16 v[0:15], v[188:191], v[84:87], v[0:15]
    ds_read_b128 v[72:75], v240 offset:112
    ds_read_b128 v[76:79], v240 offset:4720
    ds_read_b128 v[80:83], v240 offset:9328
    v_mfma_f32_32x32x16_bf16 v[16:31], v[188:191], v[88:91], v[16:31]
    v_mfma_f32_32x32x16_bf16 v[32:47], v[188:191], v[92:95], v[32:47]
    s_waitcnt lgkmcnt(6)
    v_mfma_f32_32x32x16_bf16 v[0:15], v[192:195], v[48:51], v[0:15]
    s_barrier
    ds_read_b128 v[84:87], v240 offset:27648
    ds_read_b128 v[88:91], v240 offset:32256
    ds_read_b128 v[92:95], v240 offset:36864
    v_mfma_f32_32x32x16_bf16 v[16:31], v[192:195], v[52:55], v[16:31]
    v_mfma_f32_32x32x16_bf16 v[32:47], v[192:195], v[56:59], v[32:47]
    s_waitcnt lgkmcnt(6)
    v_mfma_f32_32x32x16_bf16 v[0:15], v[196:199], v[60:63], v[0:15]
    ds_read_b128 v[48:51], v240 offset:27680
    ds_read_b128 v[52:55], v240 offset:32288
    ds_read_b128 v[56:59], v240 offset:36896
    v_mfma_f32_32x32x16_bf16 v[16:31], v[196:199], v[64:67], v[16:31]
    v_mfma_f32_32x32x16_bf16 v[32:47], v[196:199], v[68:71], v[32:47]
    s_waitcnt lgkmcnt(6)
    v_mfma_f32_32x32x16_bf16 v[0:15], v[200:203], v[72:75], v[0:15]
    ds_read_b128 v[60:63], v240 offset:27712
    ds_read_b128 v[64:67], v240 offset:32320
    ds_read_b128 v[68:71], v240 offset:36928
    v_mfma_f32_32x32x16_bf16 v[16:31], v[200:203], v[76:79], v[16:31]
    v_mfma_f32_32x32x16_bf16 v[32:47], v[200:203], v[80:83], v[32:47]
    s_waitcnt lgkmcnt(6)
    v_mfma_f32_32x32x16_bf16 v[0:15], v[204:207], v[84:87], v[0:15]
    ds_read_b128 v[72:75], v240 offset:27744
    ds_read_b128 v[76:79], v240 offset:32352
    ds_read_b128 v[80:83], v240 offset:36960
    v_mfma_f32_32x32x16_bf16 v[16:31], v[204:207], v[88:91], v[16:31]
    v_mfma_f32_32x32x16_bf16 v[32:47], v[204:207], v[92:95], v[32:47]
    s_waitcnt lgkmcnt(6)
    v_mfma_f32_32x32x16_bf16 v[0:15], v[208:211], v[48:51], v[0:15]
    ds_read_b128 v[84:87], v240 offset:27776
    ds_read_b128 v[88:91], v240 offset:32384
    ds_read_b128 v[92:95], v240 offset:36992
    v_mfma_f32_32x32x16_bf16 v[16:31], v[208:211], v[52:55], v[16:31]
    v_mfma_f32_32x32x16_bf16 v[32:47], v[208:211], v[56:59], v[32:47]
    s_waitcnt lgkmcnt(6)
    v_mfma_f32_32x32x16_bf16 v[0:15], v[212:215], v[60:63], v[0:15]
    s_barrier
    ds_read_b128 v[48:51], v241 offset:6160
    ds_read_b128 v[52:55], v241 offset:10768
    ds_read_b128 v[56:59], v241 offset:15376
    v_mfma_f32_32x32x16_bf16 v[16:31], v[212:215], v[64:67], v[16:31]
    v_mfma_f32_32x32x16_bf16 v[32:47], v[212:215], v[68:71], v[32:47]
    s_waitcnt lgkmcnt(6)
    v_mfma_f32_32x32x16_bf16 v[0:15], v[216:219], v[72:75], v[0:15]
    ds_read_b128 v[60:63], v241 offset:6192
    ds_read_b128 v[64:67], v241 offset:10800
    ds_read_b128 v[68:71], v241 offset:15408
    v_mfma_f32_32x32x16_bf16 v[16:31], v[216:219], v[76:79], v[16:31]
    v_mfma_f32_32x32x16_bf16 v[32:47], v[216:219], v[80:83], v[32:47]
    s_waitcnt lgkmcnt(6)
    v_mfma_f32_32x32x16_bf16 v[0:15], v[220:223], v[84:87], v[0:15]
    ds_read_b128 v[72:75], v241 offset:6224
    ds_read_b128 v[76:79], v241 offset:10832
    ds_read_b128 v[80:83], v241 offset:15440
    v_mfma_f32_32x32x16_bf16 v[16:31], v[220:223], v[88:91], v[16:31]
    v_mfma_f32_32x32x16_bf16 v[32:47], v[220:223], v[92:95], v[32:47]
    s_waitcnt lgkmcnt(6)
    v_mfma_f32_32x32x16_bf16 v[0:15], v[224:227], v[48:51], v[0:15]
    ds_read_b128 v[84:87], v241 offset:6256
    ds_read_b128 v[88:91], v241 offset:10864
    ds_read_b128 v[92:95], v241 offset:15472
    v_mfma_f32_32x32x16_bf16 v[16:31], v[224:227], v[52:55], v[16:31]
    v_mfma_f32_32x32x16_bf16 v[32:47], v[224:227], v[56:59], v[32:47]
    s_waitcnt lgkmcnt(6)
    v_mfma_f32_32x32x16_bf16 v[0:15], v[228:231], v[60:63], v[0:15]
    v_mfma_f32_32x32x16_bf16 v[16:31], v[228:231], v[64:67], v[16:31]
    v_mfma_f32_32x32x16_bf16 v[32:47], v[228:231], v[68:71], v[32:47]
    s_waitcnt lgkmcnt(3)
    v_mfma_f32_32x32x16_bf16 v[0:15], v[232:235], v[72:75], v[0:15]
    v_mfma_f32_32x32x16_bf16 v[16:31], v[232:235], v[76:79], v[16:31]
    v_mfma_f32_32x32x16_bf16 v[32:47], v[232:235], v[80:83], v[32:47]
    s_waitcnt lgkmcnt(0)
    v_mfma_f32_32x32x16_bf16 v[0:15], v[236:239], v[84:87], v[0:15]
    v_mfma_f32_32x32x16_bf16 v[16:31], v[236:239], v[88:91], v[16:31]
    v_mfma_f32_32x32x16_bf16 v[32:47], v[236:239], v[92:95], v[32:47]
    s_nop 10
    ds_write_b128 v247, v[24:27] offset:0
    ds_write_b128 v247, v[28:31] offset:1024
    ds_write_b128 v247, v[32:35] offset:2048
    ds_write_b128 v247, v[36:39] offset:3072
    ds_write_b128 v247, v[40:43] offset:4096
    ds_write_b128 v247, v[44:47] offset:5120
    s_waitcnt lgkmcnt(0)
    s_barrier
    ds_read_b128 v[48:51], v249 offset:0
    ds_read_b128 v[52:55], v249 offset:1024
    ds_read_b128 v[56:59], v249 offset:2048
    ds_read_b128 v[60:63], v249 offset:3072
    ds_read_b128 v[64:67], v249 offset:4096
    ds_read_b128 v[68:71], v249 offset:5120
    s_waitcnt lgkmcnt(5)
    v_pk_add_f32 v[0:1], v[0:1], v[48:49]
    v_pk_add_f32 v[2:3], v[2:3], v[50:51]
    v_cvt_pk_bf16_f32 v104, v0, v1
    v_cvt_pk_bf16_f32 v105, v2, v3
    ds_write_b64 v250, v[104:105] offset:0
    s_waitcnt lgkmcnt(5)
    v_pk_add_f32 v[4:5], v[4:5], v[52:53]
    v_pk_add_f32 v[6:7], v[6:7], v[54:55]
    v_cvt_pk_bf16_f32 v106, v4, v5
    v_cvt_pk_bf16_f32 v107, v6, v7
    ds_write_b64 v250, v[106:107] offset:16
    s_waitcnt lgkmcnt(5)
    v_pk_add_f32 v[8:9], v[8:9], v[56:57]
    v_pk_add_f32 v[10:11], v[10:11], v[58:59]
    v_cvt_pk_bf16_f32 v108, v8, v9
    v_cvt_pk_bf16_f32 v109, v10, v11
    ds_write_b64 v250, v[108:109] offset:32
    s_waitcnt lgkmcnt(5)
    v_pk_add_f32 v[12:13], v[12:13], v[60:61]
    v_pk_add_f32 v[14:15], v[14:15], v[62:63]
    v_cvt_pk_bf16_f32 v110, v12, v13
    v_cvt_pk_bf16_f32 v111, v14, v15
    ds_write_b64 v250, v[110:111] offset:48
    s_waitcnt lgkmcnt(5)
    v_pk_add_f32 v[16:17], v[16:17], v[64:65]
    v_pk_add_f32 v[18:19], v[18:19], v[66:67]
    v_cvt_pk_bf16_f32 v112, v16, v17
    v_cvt_pk_bf16_f32 v113, v18, v19
    ds_write_b64 v250, v[112:113] offset:4608
    s_waitcnt lgkmcnt(5)
    v_pk_add_f32 v[20:21], v[20:21], v[68:69]
    v_pk_add_f32 v[22:23], v[22:23], v[70:71]
    v_cvt_pk_bf16_f32 v114, v20, v21
    v_cvt_pk_bf16_f32 v115, v22, v23
    ds_write_b64 v250, v[114:115] offset:4624
    s_waitcnt lgkmcnt(0)
    s_barrier
    s_branch L12_P3_store
L12_P3B_sp1:
L_dry_PB1:
    s_mov_b32 s30, 9216
    v_mad_i32_i24 v24, v245, s30, v244
    v_add_u32 v24, 152576, v24
    ds_read_b64_tr_b16 v[96:97], v24 offset:0
    ds_read_b64_tr_b16 v[98:99], v24 offset:512
    s_mov_b32 s30, -152064
    v_mad_i32_i24 v25, v245, s30, v244
    v_add_u32 v25, 154624, v25
    ds_read_b64_tr_b16 v[100:101], v25 offset:0
    ds_read_b64_tr_b16 v[102:103], v25 offset:512
    s_mov_b32 s30, -92512
    v_mad_i32_i24 v26, v245, s30, v244
    v_add_u32 v26, 156672, v26
    ds_read_b64_tr_b16 v[104:105], v26 offset:0
    ds_read_b64_tr_b16 v[106:107], v26 offset:512
    s_mov_b32 s30, -155136
    v_mad_i32_i24 v27, v245, s30, v244
    v_add_u32 v27, 158720, v27
    ds_read_b64_tr_b16 v[108:109], v27 offset:0
    ds_read_b64_tr_b16 v[110:111], v27 offset:512
    s_mov_b32 s30, 35936
    v_mad_i32_i24 v28, v245, s30, v244
    v_add_u32 v28, 65184, v28
    ds_read_b64_tr_b16 v[112:113], v28 offset:0
    ds_read_b64_tr_b16 v[114:115], v28 offset:512
    s_mov_b32 s30, 35936
    v_mad_i32_i24 v29, v245, s30, v244
    v_add_u32 v29, 4608, v29
    ds_read_b64_tr_b16 v[116:117], v29 offset:0
    ds_read_b64_tr_b16 v[118:119], v29 offset:512
    s_mov_b32 s30, 35936
    v_mad_i32_i24 v30, v245, s30, v244
    v_add_u32 v30, 66208, v30
    ds_read_b64_tr_b16 v[120:121], v30 offset:0
    ds_read_b64_tr_b16 v[122:123], v30 offset:512
    s_mov_b32 s30, 32848
    v_mad_i32_i24 v31, v245, s30, v244
    v_add_u32 v31, 8720, v31
    ds_read_b64_tr_b16 v[124:125], v31 offset:0
    ds_read_b64_tr_b16 v[126:127], v31 offset:512
    s_mov_b32 s30, 32848
    v_mad_i32_i24 v24, v245, s30, v244
    v_add_u32 v24, 70320, v24
    ds_read_b64_tr_b16 v[128:129], v24 offset:0
    ds_read_b64_tr_b16 v[130:131], v24 offset:512
    s_mov_b32 s30, 32848
    v_mad_i32_i24 v25, v245, s30, v244
    v_add_u32 v25, 45680, v25
    ds_read_b64_tr_b16 v[132:133], v25 offset:0
    ds_read_b64_tr_b16 v[134:135], v25 offset:512
    s_mov_b32 s30, -86240
    v_mad_i32_i24 v26, v245, s30, v244
    v_add_u32 v26, 107280, v26
    ds_read_b64_tr_b16 v[136:137], v26 offset:0
    ds_read_b64_tr_b16 v[138:139], v26 offset:512
    s_mov_b32 s30, 35936
    v_mad_i32_i24 v27, v245, s30, v244
    v_add_u32 v27, 46704, v27
    ds_read_b64_tr_b16 v[140:141], v27 offset:0
    ds_read_b64_tr_b16 v[142:143], v27 offset:512
    s_mov_b32 s30, -86240
    v_mad_i32_i24 v28, v245, s30, v244
    v_add_u32 v28, 108304, v28
    ds_read_b64_tr_b16 v[144:145], v28 offset:0
    ds_read_b64_tr_b16 v[146:147], v28 offset:512
    s_mov_b32 s30, 35936
    v_mad_i32_i24 v29, v245, s30, v244
    v_add_u32 v29, 83664, v29
    ds_read_b64_tr_b16 v[148:149], v29 offset:0
    ds_read_b64_tr_b16 v[150:151], v29 offset:512
    s_mov_b32 s30, 35936
    v_mad_i32_i24 v30, v245, s30, v244
    v_add_u32 v30, 23088, v30
    ds_read_b64_tr_b16 v[152:153], v30 offset:0
    ds_read_b64_tr_b16 v[154:155], v30 offset:512
    s_mov_b32 s30, 35936
    v_mad_i32_i24 v31, v245, s30, v244
    v_add_u32 v31, 84688, v31
    ds_read_b64_tr_b16 v[156:157], v31 offset:0
    ds_read_b64_tr_b16 v[158:159], v31 offset:512
    s_mov_b32 s30, 32848
    v_mad_i32_i24 v24, v245, s30, v244
    v_add_u32 v24, 27200, v24
    ds_read_b64_tr_b16 v[160:161], v24 offset:0
    ds_read_b64_tr_b16 v[162:163], v24 offset:512
    s_mov_b32 s30, 32848
    v_mad_i32_i24 v25, v245, s30, v244
    v_add_u32 v25, 88800, v25
    ds_read_b64_tr_b16 v[164:165], v25 offset:0
    ds_read_b64_tr_b16 v[166:167], v25 offset:512
    s_waitcnt lgkmcnt(0)
    s_cbranch_execz L_dry_ret
    s_barrier
L12_P3B_pb1:
    v_mul_u32_u24 v21, 9216, v245
    s_mov_b32 s30, 49152
    v_add3_u32 v246, v244, v21, s30
    v_mul_u32_u24 v20, 144, v20
    v_mul_u32_u24 v21, 13824, v245
    v_add_u32 v240, v20, v21
    v_add_u32 v241, 49152, v240
    v_add_u32 v242, 98304, v240
    v_mov_b32 v0, 0
    v_mov_b32 v1, 0
    v_mov_b32 v2, 0
    v_mov_b32 v3, 0
    v_mov_b32 v4, 0
    v_mov_b32 v5, 0
    v_mov_b32 v6, 0
    v_mov_b32 v7, 0
    v_mov_b32 v8, 0
    v_mov_b32 v9, 0
    v_mov_b32 v10, 0
    v_mov_b32 v11, 0
    v_mov_b32 v12, 0
    v_mov_b32 v13, 0
    v_mov_b32 v14, 0
    v_mov_b32 v15, 0
    v_mov_b32 v16, 0
    v_mov_b32 v17, 0
    v_mov_b32 v18, 0
    v_mov_b32 v19, 0
    v_mov_b32 v20, 0
    v_mov_b32 v21, 0
    v_mov_b32 v22, 0
    v_mov_b32 v23, 0
    v_mov_b32 v24, 0
    v_mov_b32 v25, 0
    v_mov_b32 v26, 0
    v_mov_b32 v27, 0
    v_mov_b32 v28, 0
    v_mov_b32 v29, 0
    v_mov_b32 v30, 0
    v_mov_b32 v31, 0
    v_mov_b32 v32, 0
    v_mov_b32 v33, 0
    v_mov_b32 v34, 0
    v_mov_b32 v35, 0
    v_mov_b32 v36, 0
    v_mov_b32 v37, 0
    v_mov_b32 v38, 0
    v_mov_b32 v39, 0
    v_mov_b32 v40, 0
    v_mov_b32 v41, 0
    v_mov_b32 v42, 0
    v_mov_b32 v43, 0
    v_mov_b32 v44, 0
    v_mov_b32 v45, 0
    v_mov_b32 v46, 0
    v_mov_b32 v47, 0
    s_mov_b32 s20, s54
    s_mov_b32 s21, s55
    s_mov_b32 s22, 2359296
    s_mov_b32 s23, 0x20000
    s_lshl_b32 s30, s28, 3
    v_lshrrev_b32 v60, 3, v255
    v_add_u32 v60, s30, v60
    v_and_b32 v61, 7, v255
    v_lshlrev_b32 v61, 4, v61
    v_mul_u32_u24 v251, 144, v60
    s_mov_b32 s30, 24576
    v_add3_u32 v251, v251, v61, s30
    v_add_u32 v60, s84, v60
    v_mul_u32_u24 v60, 1152, v60
    s_lshl_b32 s30, s85, 7
    v_add3_u32 v252, v60, v61, s30
    s_mov_b32 s73, 73728
    s_lshl_b32 s72, s26, 2
    s_xor_b32 s31, s28, 2
    s_mul_i32 s30, s28, 6144
    s_mul_i32 s31, s31, 6144
    s_add_u32 s30, s30, 82944
    s_add_u32 s31, s31, 82944
    v_add_u32 v247, s30, v248
    v_add_u32 v249, s31, v248
    v_and_b32 v250, 31, v255
    v_mul_u32_u24 v250, 144, v250
    v_lshl_add_u32 v250, v245, 3, v250
    s_and_b32 s30, s28, 1
    s_lshl_b32 s30, s30, 6
    s_add_u32 s30, s30, 24576
    v_add_u32 v250, s30, v250
    s_barrier
L12_P3B_s1:
    ds_read_b64_tr_b16 v[168:169], v246 offset:1024
    ds_read_b64_tr_b16 v[170:171], v246 offset:1536
    ds_read_b64_tr_b16 v[172:173], v246 offset:3072
    ds_read_b64_tr_b16 v[174:175], v246 offset:3584
    ds_read_b64_tr_b16 v[176:177], v246 offset:5120
    ds_read_b64_tr_b16 v[178:179], v246 offset:5632
    ds_read_b64_tr_b16 v[180:181], v246 offset:7168
    ds_read_b64_tr_b16 v[182:183], v246 offset:7680
    ds_read_b64_tr_b16 v[184:185], v246 offset:18432
    ds_read_b64_tr_b16 v[186:187], v246 offset:18944
    ds_read_b64_tr_b16 v[188:189], v246 offset:20480
    ds_read_b64_tr_b16 v[190:191], v246 offset:20992
    ds_read_b64_tr_b16 v[192:193], v246 offset:22528
    ds_read_b64_tr_b16 v[194:195], v246 offset:23040
    ds_read_b64_tr_b16 v[196:197], v246 offset:24576
    ds_read_b64_tr_b16 v[198:199], v246 offset:25088
    ds_read_b64_tr_b16 v[200:201], v246 offset:26624
    ds_read_b64_tr_b16 v[202:203], v246 offset:27136
    ds_read_b64_tr_b16 v[204:205], v246 offset:37888
    ds_read_b64_tr_b16 v[206:207], v246 offset:38400
    ds_read_b64_tr_b16 v[208:209], v246 offset:39936
    ds_read_b64_tr_b16 v[210:211], v246 offset:40448
    ds_read_b64_tr_b16 v[212:213], v246 offset:41984
    ds_read_b64_tr_b16 v[214:215], v246 offset:42496
    ds_read_b64_tr_b16 v[216:217], v246 offset:44032
    ds_read_b64_tr_b16 v[218:219], v246 offset:44544
    ds_read_b64_tr_b16 v[220:221], v246 offset:55296
    ds_read_b64_tr_b16 v[222:223], v246 offset:55808
    ds_read_b64_tr_b16 v[224:225], v246 offset:57344
    ds_read_b64_tr_b16 v[226:227], v246 offset:57856
    ds_read_b64_tr_b16 v[228:229], v246 offset:59392
    ds_read_b64_tr_b16 v[230:231], v246 offset:59904
    ds_read_b64_tr_b16 v[232:233], v246 offset:61440
    ds_read_b64_tr_b16 v[234:235], v246 offset:61952
    ds_read_b64_tr_b16 v[236:237], v246 offset:63488
    ds_read_b64_tr_b16 v[238:239], v246 offset:64000
    s_waitcnt lgkmcnt(0)
    s_barrier
    s_barrier
    ds_read_b128 v[48:51], v240 offset:16
    ds_read_b128 v[52:55], v240 offset:4624
    ds_read_b128 v[56:59], v240 offset:9232
    ds_read_b128 v[60:63], v240 offset:48
    ds_read_b128 v[64:67], v240 offset:4656
    ds_read_b128 v[68:71], v240 offset:9264
    ds_read_b128 v[72:75], v240 offset:80
    ds_read_b128 v[76:79], v240 offset:4688
    ds_read_b128 v[80:83], v240 offset:9296
    s_waitcnt lgkmcnt(6)
    v_mfma_f32_32x32x16_bf16 v[0:15], v[96:99], v[48:51], v[0:15]
    ds_read_b128 v[84:87], v240 offset:112
    ds_read_b128 v[88:91], v240 offset:4720
    ds_read_b128 v[92:95], v240 offset:9328
    v_mfma_f32_32x32x16_bf16 v[16:31], v[96:99], v[52:55], v[16:31]
    v_mfma_f32_32x32x16_bf16 v[32:47], v[96:99], v[56:59], v[32:47]
    s_waitcnt lgkmcnt(6)
    v_mfma_f32_32x32x16_bf16 v[0:15], v[100:103], v[60:63], v[0:15]
    v_mfma_f32_32x32x16_bf16 v[16:31], v[100:103], v[64:67], v[16:31]
    v_mfma_f32_32x32x16_bf16 v[32:47], v[100:103], v[68:71], v[32:47]
    s_waitcnt lgkmcnt(3)
    v_mfma_f32_32x32x16_bf16 v[0:15], v[104:107], v[72:75], v[0:15]
    s_barrier
    ds_read_b128 v[48:51], v240 offset:27648
    ds_read_b128 v[52:55], v240 offset:32256
    ds_read_b128 v[56:59], v240 offset:36864
    ds_read_b128 v[60:63], v240 offset:27680
    ds_read_b128 v[64:67], v240 offset:32288
    ds_read_b128 v[68:71], v240 offset:36896
    v_mfma_f32_32x32x16_bf16 v[16:31], v[104:107], v[76:79], v[16:31]
    v_mfma_f32_32x32x16_bf16 v[32:47], v[104:107], v[80:83], v[32:47]
    s_waitcnt lgkmcnt(6)
    v_mfma_f32_32x32x16_bf16 v[0:15], v[108:111], v[84:87], v[0:15]
    ds_read_b128 v[72:75], v240 offset:27712
    ds_read_b128 v[76:79], v240 offset:32320
    ds_read_b128 v[80:83], v240 offset:36928
    v_mfma_f32_32x32x16_bf16 v[16:31], v[108:111], v[88:91], v[16:31]
    v_mfma_f32_32x32x16_bf16 v[32:47], v[108:111], v[92:95], v[32:47]
    s_waitcnt lgkmcnt(6)
    v_mfma_f32_32x32x16_bf16 v[0:15], v[112:115], v[48:51], v[0:15]
    ds_read_b128 v[84:87], v240 offset:27744
    ds_read_b128 v[88:91], v240 offset:32352
    ds_read_b128 v[92:95], v240 offset:36960
    v_mfma_f32_32x32x16_bf16 v[16:31], v[112:115], v[52:55], v[16:31]
    v_mfma_f32_32x32x16_bf16 v[32:47], v[112:115], v[56:59], v[32:47]
    s_waitcnt lgkmcnt(6)
    v_mfma_f32_32x32x16_bf16 v[0:15], v[116:119], v[60:63], v[0:15]
    ds_read_b128 v[48:51], v240 offset:27776
    ds_read_b128 v[52:55], v240 offset:32384
    ds_read_b128 v[56:59], v240 offset:36992
    v_mfma_f32_32x32x16_bf16 v[16:31], v[116:119], v[64:67], v[16:31]
    v_mfma_f32_32x32x16_bf16 v[32:47], v[116:119], v[68:71], v[32:47]
    s_waitcnt lgkmcnt(6)
    v_mfma_f32_32x32x16_bf16 v[0:15], v[120:123], v[72:75], v[0:15]
    s_barrier
    ds_read_b128 v[60:63], v241 offset:6160
    ds_read_b128 v[64:67], v241 offset:10768
    ds_read_b128 v[68:71], v241 offset:15376
    v_mfma_f32_32x32x16_bf16 v[16:31], v[120:123], v[76:79], v[16:31]
    v_mfma_f32_32x32x16_bf16 v[32:47], v[120:123], v[80:83], v[32:47]
    s_waitcnt lgkmcnt(6)
    v_mfma_f32_32x32x16_bf16 v[0:15], v[124:127], v[84:87], v[0:15]
    ds_read_b128 v[72:75], v241 offset:6192
    ds_read_b128 v[76:79], v241 offset:10800
    ds_read_b128 v[80:83], v241 offset:15408
    v_mfma_f32_32x32x16_bf16 v[16:31], v[124:127], v[88:91], v[16:31]
    v_mfma_f32_32x32x16_bf16 v[32:47], v[124:127], v[92:95], v[32:47]
    s_waitcnt lgkmcnt(6)
    v_mfma_f32_32x32x16_bf16 v[0:15], v[128:131], v[48:51], v[0:15]
    ds_read_b128 v[84:87], v241 offset:6224
    ds_read_b128 v[88:91], v241 offset:10832
    ds_read_b128 v[92:95], v241 offset:15440
    v_mfma_f32_32x32x16_bf16 v[16:31], v[128:131], v[52:55], v[16:31]
    v_mfma_f32_32x32x16_bf16 v[32:47], v[128:131], v[56:59], v[32:47]
    s_waitcnt lgkmcnt(6)
    v_mfma_f32_32x32x16_bf16 v[0:15], v[132:135], v[60:63], v[0:15]
    ds_read_b128 v[48:51], v241 offset:6256
    ds_read_b128 v[52:55], v241 offset:10864
    ds_read_b128 v[56:59], v241 offset:15472
    v_mfma_f32_32x32x16_bf16 v[16:31], v[132:135], v[64:67], v[16:31]
    v_mfma_f32_32x32x16_bf16 v[32:47], v[132:135], v[68:71], v[32:47]
    s_waitcnt lgkmcnt(6)
    v_mfma_f32_32x32x16_bf16 v[0:15], v[136:139], v[72:75], v[0:15]
    v_mfma_f32_32x32x16_bf16 v[16:31], v[136:139], v[76:79], v[16:31]
    v_mfma_f32_32x32x16_bf16 v[32:47], v[136:139], v[80:83], v[32:47]
    s_waitcnt lgkmcnt(3)
    v_mfma_f32_32x32x16_bf16 v[0:15], v[140:143], v[84:87], v[0:15]
    s_barrier
    ds_read_b128 v[60:63], v241 offset:33792
    ds_read_b128 v[64:67], v241 offset:38400
    ds_read_b128 v[68:71], v241 offset:43008
    ds_read_b128 v[72:75], v241 offset:33824
    ds_read_b128 v[76:79], v241 offset:38432
    ds_read_b128 v[80:83], v241 offset:43040
    v_mfma_f32_32x32x16_bf16 v[16:31], v[140:143], v[88:91], v[16:31]
    v_mfma_f32_32x32x16_bf16 v[32:47], v[140:143], v[92:95], v[32:47]
    s_waitcnt lgkmcnt(6)
    v_mfma_f32_32x32x16_bf16 v[0:15], v[144:147], v[48:51], v[0:15]
    ds_read_b128 v[84:87], v241 offset:33856
    ds_read_b128 v[88:91], v241 offset:38464
    ds_read_b128 v[92:95], v241 offset:43072
    v_mfma_f32_32x32x16_bf16 v[16:31], v[144:147], v[52:55], v[16:31]
    v_mfma_f32_32x32x16_bf16 v[32:47], v[144:147], v[56:59], v[32:47]
    s_waitcnt lgkmcnt(6)
    v_mfma_f32_32x32x16_bf16 v[0:15], v[148:151], v[60:63], v[0:15]
    ds_read_b128 v[48:51], v241 offset:33888
    ds_read_b128 v[52:55], v241 offset:38496
    ds_read_b128 v[56:59], v241 offset:43104
    v_mfma_f32_32x32x16_bf16 v[16:31], v[148:151], v[64:67], v[16:31]
    v_mfma_f32_32x32x16_bf16 v[32:47], v[148:151], v[68:71], v[32:47]
    s_waitcnt lgkmcnt(6)
    v_mfma_f32_32x32x16_bf16 v[0:15], v[152:155], v[72:75], v[0:15]
    ds_read_b128 v[60:63], v241 offset:33920
    ds_read_b128 v[64:67], v241 offset:38528
    ds_read_b128 v[68:71], v241 offset:43136
    v_mfma_f32_32x32x16_bf16 v[16:31], v[152:155], v[76:79], v[16:31]
    v_mfma_f32_32x32x16_bf16 v[32:47], v[152:155], v[80:83], v[32:47]
    s_waitcnt lgkmcnt(6)
    v_mfma_f32_32x32x16_bf16 v[0:15], v[156:159], v[84:87], v[0:15]
    s_barrier
    ds_read_b128 v[72:75], v242 offset:12304
    ds_read_b128 v[76:79], v242 offset:16912
    ds_read_b128 v[80:83], v242 offset:21520
    v_mfma_f32_32x32x16_bf16 v[16:31], v[156:159], v[88:91], v[16:31]
    v_mfma_f32_32x32x16_bf16 v[32:47], v[156:159], v[92:95], v[32:47]
    s_waitcnt lgkmcnt(6)
    v_mfma_f32_32x32x16_bf16 v[0:15], v[160:163], v[48:51], v[0:15]
    ds_read_b128 v[84:87], v242 offset:12336
    ds_read_b128 v[88:91], v242 offset:16944
    ds_read_b128 v[92:95], v242 offset:21552
    v_mfma_f32_32x32x16_bf16 v[16:31], v[160:163], v[52:55], v[16:31]
    v_mfma_f32_32x32x16_bf16 v[32:47], v[160:163], v[56:59], v[32:47]
    s_waitcnt lgkmcnt(6)
    v_mfma_f32_32x32x16_bf16 v[0:15], v[164:167], v[60:63], v[0:15]
    ds_read_b128 v[48:51], v242 offset:12368
    ds_read_b128 v[52:55], v242 offset:16976
    ds_read_b128 v[56:59], v242 offset:21584
    v_mfma_f32_32x32x16_bf16 v[16:31], v[164:167], v[64:67], v[16:31]
    v_mfma_f32_32x32x16_bf16 v[32:47], v[164:167], v[68:71], v[32:47]
    s_waitcnt lgkmcnt(6)
    v_mfma_f32_32x32x16_bf16 v[0:15], v[168:171], v[72:75], v[0:15]
    ds_read_b128 v[60:63], v242 offset:12400
    ds_read_b128 v[64:67], v242 offset:17008
    ds_read_b128 v[68:71], v242 offset:21616
    v_mfma_f32_32x32x16_bf16 v[16:31], v[168:171], v[76:79], v[16:31]
    v_mfma_f32_32x32x16_bf16 v[32:47], v[168:171], v[80:83], v[32:47]
    s_waitcnt lgkmcnt(6)
    v_mfma_f32_32x32x16_bf16 v[0:15], v[172:175], v[84:87], v[0:15]
    v_mfma_f32_32x32x16_bf16 v[16:31], v[172:175], v[88:91], v[16:31]
    v_mfma_f32_32x32x16_bf16 v[32:47], v[172:175], v[92:95], v[32:47]
    s_waitcnt lgkmcnt(3)
    v_mfma_f32_32x32x16_bf16 v[0:15], v[176:179], v[48:51], v[0:15]
    s_barrier
    ds_read_b128 v[72:75], v240 offset:0
    ds_read_b128 v[76:79], v240 offset:4608
    ds_read_b128 v[80:83], v240 offset:9216
    ds_read_b128 v[84:87], v240 offset:32
    ds_read_b128 v[88:91], v240 offset:4640
    ds_read_b128 v[92:95], v240 offset:9248
    v_mfma_f32_32x32x16_bf16 v[16:31], v[176:179], v[52:55], v[16:31]
    v_mfma_f32_32x32x16_bf16 v[32:47], v[176:179], v[56:59], v[32:47]
    s_waitcnt lgkmcnt(6)
    v_mfma_f32_32x32x16_bf16 v[0:15], v[180:183], v[60:63], v[0:15]
    ds_read_b128 v[48:51], v240 offset:64
    ds_read_b128 v[52:55], v240 offset:4672
    ds_read_b128 v[56:59], v240 offset:9280
    v_mfma_f32_32x32x16_bf16 v[16:31], v[180:183], v[64:67], v[16:31]
    v_mfma_f32_32x32x16_bf16 v[32:47], v[180:183], v[68:71], v[32:47]
    s_waitcnt lgkmcnt(6)
    v_mfma_f32_32x32x16_bf16 v[0:15], v[184:187], v[72:75], v[0:15]
    ds_read_b128 v[60:63], v240 offset:96
    ds_read_b128 v[64:67], v240 offset:4704
    ds_read_b128 v[68:71], v240 offset:9312
    v_mfma_f32_32x32x16_bf16 v[16:31], v[184:187], v[76:79], v[16:31]
    v_mfma_f32_32x32x16_bf16 v[32:47], v[184:187], v[80:83], v[32:47]
    s_waitcnt lgkmcnt(6)
    v_mfma_f32_32x32x16_bf16 v[0:15], v[188:191], v[84:87], v[0:15]
    ds_read_b128 v[72:75], v240 offset:128
    ds_read_b128 v[76:79], v240 offset:4736
    ds_read_b128 v[80:83], v240 offset:9344
    v_mfma_f32_32x32x16_bf16 v[16:31], v[188:191], v[88:91], v[16:31]
    v_mfma_f32_32x32x16_bf16 v[32:47], v[188:191], v[92:95], v[32:47]
    s_waitcnt lgkmcnt(6)
    v_mfma_f32_32x32x16_bf16 v[0:15], v[192:195], v[48:51], v[0:15]
    s_barrier
    ds_read_b128 v[84:87], v240 offset:27664
    ds_read_b128 v[88:91], v240 offset:32272
    ds_read_b128 v[92:95], v240 offset:36880
    v_mfma_f32_32x32x16_bf16 v[16:31], v[192:195], v[52:55], v[16:31]
    v_mfma_f32_32x32x16_bf16 v[32:47], v[192:195], v[56:59], v[32:47]
    s_waitcnt lgkmcnt(6)
    v_mfma_f32_32x32x16_bf16 v[0:15], v[196:199], v[60:63], v[0:15]
    ds_read_b128 v[48:51], v240 offset:27696
    ds_read_b128 v[52:55], v240 offset:32304
    ds_read_b128 v[56:59], v240 offset:36912
    v_mfma_f32_32x32x16_bf16 v[16:31], v[196:199], v[64:67], v[16:31]
    v_mfma_f32_32x32x16_bf16 v[32:47], v[196:199], v[68:71], v[32:47]
    s_waitcnt lgkmcnt(6)
    v_mfma_f32_32x32x16_bf16 v[0:15], v[200:203], v[72:75], v[0:15]
    ds_read_b128 v[60:63], v240 offset:27728
    ds_read_b128 v[64:67], v240 offset:32336
    ds_read_b128 v[68:71], v240 offset:36944
    v_mfma_f32_32x32x16_bf16 v[16:31], v[200:203], v[76:79], v[16:31]
    v_mfma_f32_32x32x16_bf16 v[32:47], v[200:203], v[80:83], v[32:47]
    s_waitcnt lgkmcnt(6)
    v_mfma_f32_32x32x16_bf16 v[0:15], v[204:207], v[84:87], v[0:15]
    ds_read_b128 v[72:75], v240 offset:27760
    ds_read_b128 v[76:79], v240 offset:32368
    ds_read_b128 v[80:83], v240 offset:36976
    v_mfma_f32_32x32x16_bf16 v[16:31], v[204:207], v[88:91], v[16:31]
    v_mfma_f32_32x32x16_bf16 v[32:47], v[204:207], v[92:95], v[32:47]
    s_waitcnt lgkmcnt(6)
    v_mfma_f32_32x32x16_bf16 v[0:15], v[208:211], v[48:51], v[0:15]
    v_mfma_f32_32x32x16_bf16 v[16:31], v[208:211], v[52:55], v[16:31]
    v_mfma_f32_32x32x16_bf16 v[32:47], v[208:211], v[56:59], v[32:47]
    s_waitcnt lgkmcnt(3)
    v_mfma_f32_32x32x16_bf16 v[0:15], v[212:215], v[60:63], v[0:15]
    s_barrier
    ds_read_b128 v[84:87], v241 offset:6144
    ds_read_b128 v[88:91], v241 offset:10752
    ds_read_b128 v[92:95], v241 offset:15360
    ds_read_b128 v[48:51], v241 offset:6176
    ds_read_b128 v[52:55], v241 offset:10784
    ds_read_b128 v[56:59], v241 offset:15392
    v_mfma_f32_32x32x16_bf16 v[16:31], v[212:215], v[64:67], v[16:31]
    v_mfma_f32_32x32x16_bf16 v[32:47], v[212:215], v[68:71], v[32:47]
    s_waitcnt lgkmcnt(6)
    v_mfma_f32_32x32x16_bf16 v[0:15], v[216:219], v[72:75], v[0:15]
    ds_read_b128 v[60:63], v241 offset:6208
    ds_read_b128 v[64:67], v241 offset:10816
    ds_read_b128 v[68:71], v241 offset:15424
    v_mfma_f32_32x32x16_bf16 v[16:31], v[216:219], v[76:79], v[16:31]
    v_mfma_f32_32x32x16_bf16 v[32:47], v[216:219], v[80:83], v[32:47]
    s_waitcnt lgkmcnt(6)
    v_mfma_f32_32x32x16_bf16 v[0:15], v[220:223], v[84:87], v[0:15]
    ds_read_b128 v[72:75], v241 offset:6240
    ds_read_b128 v[76:79], v241 offset:10848
    ds_read_b128 v[80:83], v241 offset:15456
    v_mfma_f32_32x32x16_bf16 v[16:31], v[220:223], v[88:91], v[16:31]
    v_mfma_f32_32x32x16_bf16 v[32:47], v[220:223], v[92:95], v[32:47]
    s_waitcnt lgkmcnt(6)
    v_mfma_f32_32x32x16_bf16 v[0:15], v[224:227], v[48:51], v[0:15]
    ds_read_b128 v[84:87], v241 offset:6272
    ds_read_b128 v[88:91], v241 offset:10880
    ds_read_b128 v[92:95], v241 offset:15488
    v_mfma_f32_32x32x16_bf16 v[16:31], v[224:227], v[52:55], v[16:31]
    v_mfma_f32_32x32x16_bf16 v[32:47], v[224:227], v[56:59], v[32:47]
    s_waitcnt lgkmcnt(6)
    v_mfma_f32_32x32x16_bf16 v[0:15], v[228:231], v[60:63], v[0:15]
    v_mfma_f32_32x32x16_bf16 v[16:31], v[228:231], v[64:67], v[16:31]
    v_mfma_f32_32x32x16_bf16 v[32:47], v[228:231], v[68:71], v[32:47]
    s_waitcnt lgkmcnt(3)
    v_mfma_f32_32x32x16_bf16 v[0:15], v[232:235], v[72:75], v[0:15]
    v_mfma_f32_32x32x16_bf16 v[16:31], v[232:235], v[76:79], v[16:31]
    v_mfma_f32_32x32x16_bf16 v[32:47], v[232:235], v[80:83], v[32:47]
    s_waitcnt lgkmcnt(0)
    v_mfma_f32_32x32x16_bf16 v[0:15], v[236:239], v[84:87], v[0:15]
    v_mfma_f32_32x32x16_bf16 v[16:31], v[236:239], v[88:91], v[16:31]
    v_mfma_f32_32x32x16_bf16 v[32:47], v[236:239], v[92:95], v[32:47]
    s_nop 9
    ds_write_b128 v247, v[0:3] offset:0
    ds_write_b128 v247, v[4:7] offset:1024
    ds_write_b128 v247, v[8:11] offset:2048
    ds_write_b128 v247, v[12:15] offset:3072
    ds_write_b128 v247, v[16:19] offset:4096
    ds_write_b128 v247, v[20:23] offset:5120
    s_waitcnt lgkmcnt(0)
    s_barrier
    ds_read_b128 v[48:51], v249 offset:0
    ds_read_b128 v[52:55], v249 offset:1024
    ds_read_b128 v[56:59], v249 offset:2048
    ds_read_b128 v[60:63], v249 offset:3072
    ds_read_b128 v[64:67], v249 offset:4096
    ds_read_b128 v[68:71], v249 offset:5120
    s_waitcnt lgkmcnt(5)
    v_pk_add_f32 v[24:25], v[24:25], v[48:49]
    v_pk_add_f32 v[26:27], v[26:27], v[50:51]
    v_cvt_pk_bf16_f32 v104, v24, v25
    v_cvt_pk_bf16_f32 v105, v26, v27
    ds_write_b64 v250, v[104:105] offset:4640
    s_waitcnt lgkmcnt(5)
    v_pk_add_f32 v[28:29], v[28:29], v[52:53]
    v_pk_add_f32 v[30:31], v[30:31], v[54:55]
    v_cvt_pk_bf16_f32 v106, v28, v29
    v_cvt_pk_bf16_f32 v107, v30, v31
    ds_write_b64 v250, v[106:107] offset:4656
    s_waitcnt lgkmcnt(5)
    v_pk_add_f32 v[32:33], v[32:33], v[56:57]
    v_pk_add_f32 v[34:35], v[34:35], v[58:59]
    v_cvt_pk_bf16_f32 v108, v32, v33
    v_cvt_pk_bf16_f32 v109, v34, v35
    ds_write_b64 v250, v[108:109] offset:9216
    s_waitcnt lgkmcnt(5)
    v_pk_add_f32 v[36:37], v[36:37], v[60:61]
    v_pk_add_f32 v[38:39], v[38:39], v[62:63]
    v_cvt_pk_bf16_f32 v110, v36, v37
    v_cvt_pk_bf16_f32 v111, v38, v39
    ds_write_b64 v250, v[110:111] offset:9232
    s_waitcnt lgkmcnt(5)
    v_pk_add_f32 v[40:41], v[40:41], v[64:65]
    v_pk_add_f32 v[42:43], v[42:43], v[66:67]
    v_cvt_pk_bf16_f32 v112, v40, v41
    v_cvt_pk_bf16_f32 v113, v42, v43
    ds_write_b64 v250, v[112:113] offset:9248
    s_waitcnt lgkmcnt(5)
    v_pk_add_f32 v[44:45], v[44:45], v[68:69]
    v_pk_add_f32 v[46:47], v[46:47], v[70:71]
    v_cvt_pk_bf16_f32 v114, v44, v45
    v_cvt_pk_bf16_f32 v115, v46, v47
    ds_write_b64 v250, v[114:115] offset:9264
    s_waitcnt lgkmcnt(0)
    s_barrier
    s_branch L12_P3_store
L12_loader:
    v_lshlrev_b32 v239, 4, v255
    v_lshlrev_b32 v248, 4, v255
    s_and_b32 s30, s2, 7
    s_lshr_b32 s31, s2, 3
    s_bfe_u32 s26, s31, 0x10003
    s_and_b32 s24, s31, 7
    s_lshr_b32 s32, s31, 4
    s_lshl_b32 s32, s32, 3
    s_add_u32 s24, s24, s32
    s_mov_b32 s27, s30
    s_lshl_b32 s25, s26, 3
    s_add_u32 s25, s25, s27
    s_and_b32 s29, s28, 3
    s_lshr_b32 s74, s24, 1
    s_mul_i32 s74, s74, 1
    s_mul_i32 s30, s26, 0
    s_add_u32 s74, s74, s30
    s_mul_i32 s30, s27, 1
    s_add_u32 s74, s74, s30
    s_mul_i32 s30, s74, 7282
    s_lshr_b32 s30, s30, 16
    s_mul_i32 s30, s30, 9
    s_sub_u32 s74, s74, s30
    s_mov_b32 s79, s74
    s_lshl_b32 s77, s29, 12
    s_mul_i32 s78, s29, 7168
    s_add_u32 s78, s78, 16384
    v_lshrrev_b32 v1, 3, v255
    s_lshl_b32 s30, s24, 7
    s_lshl_b32 s31, s29, 5
    s_add_u32 s30, s30, s31
    v_add_u32 v1, s30, v1
    v_mul_u32_u24 v1, 1152, v1
    v_lshrrev_b32 v2, 4, v255
    v_xor_b32 v2, v2, v255
    v_and_b32 v2, 7, v2
    v_xor_b32 v3, 4, v2
    v_lshl_add_u32 v10, v2, 4, v1
    v_lshl_add_u32 v11, v3, 4, v1
    v_add_u32 v11, 9216, v11
    v_add_u32 v12, 18432, v10
    v_add_u32 v13, 18432, v11
    s_mul_i32 s34, s29, 448
    s_mul_i32 s35, s27, 144
    s_waitcnt lgkmcnt(0)
    s_mov_b32 s8, s44
    s_mov_b32 s9, s45
    s_mov_b32 s10, 2359296
    s_mov_b32 s11, 0x20000
    s_lshl_b32 s75, s74, 7
    s_mul_i32 s76, s74, 221184
    s_add_u32 m0, s77, 0
    s_nop 0
    buffer_load_dwordx4 v10, s[8:11], s75 offen lds
    s_add_u32 m0, s77, 1024
    s_nop 0
    buffer_load_dwordx4 v11, s[8:11], s75 offen lds
    s_add_u32 m0, s77, 2048
    s_nop 0
    buffer_load_dwordx4 v12, s[8:11], s75 offen lds
    s_add_u32 m0, s77, 3072
    s_nop 0
    buffer_load_dwordx4 v13, s[8:11], s75 offen lds
    s_cmp_eq_u32 s26, 0
    s_cselect_b32 s12, s46, s48
    s_cselect_b32 s13, s47, s49
    s_mov_b32 s14, 1990656
    s_mov_b32 s15, 0x20000
    s_add_u32 s32, s34, 0
    v_add_u32 v1, s32, v255
    v_mul_u32_u24 v2, 2341, v1
    v_lshrrev_b32 v2, 16, v2
    v_mul_u32_u24 v3, 28, v2
    v_sub_u32 v3, v1, v3
    v_bfe_u32 v4, v2, 3, 1
    v_lshlrev_b32 v4, 1, v4
    v_sub_u32 v3, v3, v4
    v_add_u32 v4, 28, v3
    v_min_u32 v3, v3, v4
    v_cmp_ne_u32 s[60:61], 27, v3
    v_mul_u32_u24 v4, 57, v3
    v_lshrrev_b32 v4, 9, v4
    v_mul_u32_u24 v4, 1008, v4
    v_lshl_add_u32 v4, v3, 4, v4
    v_mul_u32_u24 v2, 3456, v2
    v_add3_u32 v14, v2, v4, s35
    s_add_u32 m0, s78, 0
    s_mov_b64 exec, s[60:61]
    buffer_load_dwordx4 v14, s[12:15], s76 offen lds
    s_mov_b64 exec, -1
    s_add_u32 s32, s34, 64
    v_add_u32 v1, s32, v255
    v_mul_u32_u24 v2, 2341, v1
    v_lshrrev_b32 v2, 16, v2
    v_mul_u32_u24 v3, 28, v2
    v_sub_u32 v3, v1, v3
    v_bfe_u32 v4, v2, 3, 1
    v_lshlrev_b32 v4, 1, v4
    v_sub_u32 v3, v3, v4
    v_add_u32 v4, 28, v3
    v_min_u32 v3, v3, v4
    v_cmp_ne_u32 s[62:63], 27, v3
    v_mul_u32_u24 v4, 57, v3
    v_lshrrev_b32 v4, 9, v4
    v_mul_u32_u24 v4, 1008, v4
    v_lshl_add_u32 v4, v3, 4, v4
    v_mul_u32_u24 v2, 3456, v2
    v_add3_u32 v15, v2, v4, s35
    s_add_u32 m0, s78, 1024
    s_mov_b64 exec, s[62:63]
    buffer_load_dwordx4 v15, s[12:15], s76 offen lds
    s_mov_b64 exec, -1
    s_add_u32 s32, s34, 128
    v_add_u32 v1, s32, v255
    v_mul_u32_u24 v2, 2341, v1
    v_lshrrev_b32 v2, 16, v2
    v_mul_u32_u24 v3, 28, v2
    v_sub_u32 v3, v1, v3
    v_bfe_u32 v4, v2, 3, 1
    v_lshlrev_b32 v4, 1, v4
    v_sub_u32 v3, v3, v4
    v_add_u32 v4, 28, v3
    v_min_u32 v3, v3, v4
    v_cmp_ne_u32 s[64:65], 27, v3
    v_mul_u32_u24 v4, 57, v3
    v_lshrrev_b32 v4, 9, v4
    v_mul_u32_u24 v4, 1008, v4
    v_lshl_add_u32 v4, v3, 4, v4
    v_mul_u32_u24 v2, 3456, v2
    v_add3_u32 v16, v2, v4, s35
    s_add_u32 m0, s78, 2048
    s_mov_b64 exec, s[64:65]
    buffer_load_dwordx4 v16, s[12:15], s76 offen lds
    s_mov_b64 exec, -1
    s_add_u32 s32, s34, 192
    v_add_u32 v1, s32, v255
    v_mul_u32_u24 v2, 2341, v1
    v_lshrrev_b32 v2, 16, v2
    v_mul_u32_u24 v3, 28, v2
    v_sub_u32 v3, v1, v3
    v_bfe_u32 v4, v2, 3, 1
    v_lshlrev_b32 v4, 1, v4
    v_sub_u32 v3, v3, v4
    v_add_u32 v4, 28, v3
    v_min_u32 v3, v3, v4
    v_cmp_ne_u32 s[66:67], 27, v3
    v_mul_u32_u24 v4, 57, v3
    v_lshrrev_b32 v4, 9, v4
    v_mul_u32_u24 v4, 1008, v4
    v_lshl_add_u32 v4, v3, 4, v4
    v_mul_u32_u24 v2, 3456, v2
    v_add3_u32 v17, v2, v4, s35
    s_add_u32 m0, s78, 3072
    s_mov_b64 exec, s[66:67]
    buffer_load_dwordx4 v17, s[12:15], s76 offen lds
    s_mov_b64 exec, -1
    s_add_u32 s32, s34, 256
    v_add_u32 v1, s32, v255
    v_mul_u32_u24 v2, 2341, v1
    v_lshrrev_b32 v2, 16, v2
    v_mul_u32_u24 v3, 28, v2
    v_sub_u32 v3, v1, v3
    v_bfe_u32 v4, v2, 3, 1
    v_lshlrev_b32 v4, 1, v4
    v_sub_u32 v3, v3, v4
    v_add_u32 v4, 28, v3
    v_min_u32 v3, v3, v4
    v_cmp_ne_u32 s[68:69], 27, v3
    v_mul_u32_u24 v4, 57, v3
    v_lshrrev_b32 v4, 9, v4
    v_mul_u32_u24 v4, 1008, v4
    v_lshl_add_u32 v4, v3, 4, v4
    v_mul_u32_u24 v2, 3456, v2
    v_add3_u32 v18, v2, v4, s35
    s_add_u32 m0, s78, 4096
    s_mov_b64 exec, s[68:69]
    buffer_load_dwordx4 v18, s[12:15], s76 offen lds
    s_mov_b64 exec, -1
    s_add_u32 s32, s34, 320
    v_add_u32 v1, s32, v255
    v_mul_u32_u24 v2, 2341, v1
    v_lshrrev_b32 v2, 16, v2
    v_mul_u32_u24 v3, 28, v2
    v_sub_u32 v3, v1, v3
    v_bfe_u32 v4, v2, 3, 1
    v_lshlrev_b32 v4, 1, v4
    v_sub_u32 v3, v3, v4
    v_add_u32 v4, 28, v3
    v_min_u32 v3, v3, v4
    v_cmp_ne_u32 s[70:71], 27, v3
    v_mul_u32_u24 v4, 57, v3
    v_lshrrev_b32 v4, 9, v4
    v_mul_u32_u24 v4, 1008, v4
    v_lshl_add_u32 v4, v3, 4, v4
    v_mul_u32_u24 v2, 3456, v2
    v_add3_u32 v19, v2, v4, s35
    s_add_u32 m0, s78, 5120
    s_mov_b64 exec, s[70:71]
    buffer_load_dwordx4 v19, s[12:15], s76 offen lds
    s_mov_b64 exec, -1
    s_add_u32 s32, s34, 384
    v_add_u32 v1, s32, v255
    v_mul_u32_u24 v2, 2341, v1
    v_lshrrev_b32 v2, 16, v2
    v_mul_u32_u24 v3, 28, v2
    v_sub_u32 v3, v1, v3
    v_bfe_u32 v4, v2, 3, 1
    v_lshlrev_b32 v4, 1, v4
    v_sub_u32 v3, v3, v4
    v_add_u32 v4, 28, v3
    v_min_u32 v3, v3, v4
    v_cmp_ne_u32 s[72:73], 27, v3
    v_mul_u32_u24 v4, 57, v3
    v_lshrrev_b32 v4, 9, v4
    v_mul_u32_u24 v4, 1008, v4
    v_lshl_add_u32 v4, v3, 4, v4
    v_mul_u32_u24 v2, 3456, v2
    v_add3_u32 v20, v2, v4, s35
    s_add_u32 m0, s78, 6144
    s_mov_b64 exec, s[72:73]
    buffer_load_dwordx4 v20, s[12:15], s76 offen lds
    s_mov_b64 exec, -1
    s_and_b32 s30, s2, 7
    s_lshr_b32 s31, s2, 3
    s_and_b32 s32, s31, 7
    s_lshr_b32 s33, s31, 4
    s_lshl_b32 s33, s33, 3
    s_add_u32 s32, s32, s33
    s_lshl_b32 s33, s30, 4
    s_add_u32 s33, s33, s32
    s_mul_i32 s34, s30, 12
    s_min_u32 s35, s30, 3
    s_add_u32 s34, s34, s35
    s_add_u32 s34, s34, s32
    s_cmp_lt_u32 s30, 3
    s_cselect_b32 s35, 13, 12
    s_cmp_lt_u32 s32, s35
    s_cselect_b32 s43, 1, 0
    s_cmp_lt_u32 s33, 126
    s_cselect_b32 s35, 1, 0
    s_cmp_eq_u32 s26, 0
    s_cselect_b32 s85, s34, s33
    s_cselect_b32 s43, s43, s35
    s_cselect_b32 s33, 64, 96
    s_cselect_b32 s34, 1344, 0
    s_mul_i32 s32, s85, 7282
    s_lshr_b32 s32, s32, 16
    s_mul_i32 s35, s32, 9
    s_sub_u32 s85, s85, s35
    s_mul_i32 s84, s32, s33
    s_add_u32 s84, s84, s34
    v_mov_b32 v241, 0
    v_mov_b32 v242, 0
    v_mov_b32 v243, 0
    v_mov_b32 v244, 0
    v_mov_b32 v245, 0
    v_mov_b32 v246, 0
    v_mov_b32 v247, 0
    v_mov_b32 v249, 0
    v_mov_b32 v250, 0
    v_mov_b32 v251, 0
    v_mov_b32 v252, 0
    s_mov_b32 s40, 0
    s_mov_b32 s41, -1
    s_mov_b32 s16, s58
    s_mov_b32 s17, s59
    s_mov_b32 s18, 268435456
    s_mov_b32 s19, 0x20000
    s_mov_b32 s44, s58
    s_mov_b32 s45, s59
    s_mov_b32 s46, 0
    s_mov_b32 s47, 0x20000
    s_mov_b32 s20, s52
    s_mov_b32 s21, s53
    s_mov_b32 s22, 1152
    s_mov_b32 s23, 0x20000
    v_lshrrev_b32 v1, 4, v255
    v_add_u32 v1, s79, v1
    v_and_b32 v3, 15, v255
    s_lshl_b32 s30, s29, 4
    v_add_u32 v3, s30, v3
    v_subrev_u32 v2, 9, v1
    v_min_u32 v1, v1, v2
    v_lshlrev_b32 v2, 6, v1
    v_add_lshl_u32 v2, v2, v3, 1
    buffer_load_ushort v21, v2, s[20:23], 0 offen
    v_add_u32 v1, 4, v1
    v_subrev_u32 v2, 9, v1
    v_min_u32 v1, v1, v2
    v_lshlrev_b32 v2, 6, v1
    v_add_lshl_u32 v2, v2, v3, 1
    buffer_load_ushort v22, v2, s[20:23], 0 offen
    v_add_u32 v1, 4, v1
    v_subrev_u32 v2, 9, v1
    v_min_u32 v1, v1, v2
    v_lshlrev_b32 v2, 6, v1
    v_add_lshl_u32 v2, v2, v3, 1
    buffer_load_ushort v23, v2, s[20:23], 0 offen
    v_mul_u32_u24 v30, 448, v3
    v_bfe_u32 v2, v3, 3, 1
    v_mul_u32_u24 v2, 416, v2
    v_sub_u32 v30, v30, v2
    v_add_u32 v30, 16816, v30
    v_mov_b32 v31, 0
    s_lshl_b32 s30, s29, 4
    s_lshl_b64 s[82:83], 0xffff, s30
    s_cmp_lg_u32 s2, 0
    s_cbranch_scc1 L12_nononce
    s_cmp_lg_u32 s28, 4
    s_cbranch_scc1 L12_nononce
    s_memrealtime s[30:31]
    v_mov_b32 v1, 0
    s_waitcnt lgkmcnt(0)
    s_or_b32 s30, s30, 1
    v_mov_b32 v2, s30
    s_mov_b64 exec, 1
    global_store_dword v1, v2, s[56:57] sc1
    s_mov_b64 exec, -1
L12_nononce:
    s_add_u32 s74, s74, 1
    s_cmp_eq_u32 s74, 9
    s_cselect_b32 s74, 0, s74
    s_lshl_b32 s75, s74, 7
    s_mul_i32 s76, s74, 221184
    s_add_u32 m0, s77, 45056
    s_nop 0
    buffer_load_dwordx4 v10, s[8:11], s75 offen lds
    s_add_u32 m0, s77, 46080
    s_nop 0
    buffer_load_dwordx4 v11, s[8:11], s75 offen lds
    s_add_u32 m0, s77, 47104
    s_nop 0
    buffer_load_dwordx4 v12, s[8:11], s75 offen lds
    s_add_u32 m0, s77, 48128
    s_nop 0
    buffer_load_dwordx4 v13, s[8:11], s75 offen lds
    s_add_u32 m0, s78, 45056
    s_mov_b64 exec, s[60:61]
    buffer_load_dwordx4 v14, s[12:15], s76 offen lds
    s_add_u32 m0, s78, 46080
    s_mov_b64 exec, s[62:63]
    buffer_load_dwordx4 v15, s[12:15], s76 offen lds
    s_add_u32 m0, s78, 47104
    s_mov_b64 exec, s[64:65]
    buffer_load_dwordx4 v16, s[12:15], s76 offen lds
    s_add_u32 m0, s78, 48128
    s_mov_b64 exec, s[66:67]
    buffer_load_dwordx4 v17, s[12:15], s76 offen lds
    s_mov_b64 exec, -1
    s_waitcnt vmcnt(8)
    v_add_u32 v2, 0, v30
    s_mov_b32 exec_lo, 0xffff
    s_mov_b32 exec_hi, 0x0
    ds_write2_b32 v2, v21, v31 offset0:0 offset1:1
    s_mov_b64 exec, -1
    v_add_u32 v2, 45056, v30
    s_mov_b32 exec_lo, 0xffff0000
    s_mov_b32 exec_hi, 0x0
    ds_write2_b32 v2, v21, v31 offset0:0 offset1:1
    s_mov_b64 exec, -1
    s_waitcnt lgkmcnt(0)
    s_barrier
    s_add_u32 m0, s78, 49152
    s_mov_b64 exec, s[68:69]
    buffer_load_dwordx4 v18, s[12:15], s76 offen lds
    s_add_u32 m0, s78, 50176
    s_mov_b64 exec, s[70:71]
    buffer_load_dwordx4 v19, s[12:15], s76 offen lds
    s_add_u32 m0, s78, 51200
    s_mov_b64 exec, s[72:73]
    buffer_load_dwordx4 v20, s[12:15], s76 offen lds
    s_mov_b64 exec, -1
    s_waitcnt lgkmcnt(0)
    v_add_u32 v2, 90112, v30
    s_mov_b32 exec_lo, 0x0
    s_mov_b32 exec_hi, 0xffff
    ds_write2_b32 v2, v21, v31 offset0:0 offset1:1
    s_mov_b64 exec, -1
    s_add_u32 s74, s74, 1
    s_cmp_eq_u32 s74, 9
    s_cselect_b32 s74, 0, s74
    s_lshl_b32 s75, s74, 7
    s_mul_i32 s76, s74, 221184
    s_add_u32 m0, s77, 90112
    s_nop 0
    buffer_load_dwordx4 v10, s[8:11], s75 offen lds
    s_add_u32 m0, s77, 91136
    s_nop 0
    buffer_load_dwordx4 v11, s[8:11], s75 offen lds
    s_add_u32 m0, s77, 92160
    s_nop 0
    buffer_load_dwordx4 v12, s[8:11], s75 offen lds
    s_add_u32 m0, s77, 93184
    s_nop 0
    buffer_load_dwordx4 v13, s[8:11], s75 offen lds
    s_add_u32 m0, s78, 90112
    s_mov_b64 exec, s[60:61]
    buffer_load_dwordx4 v14, s[12:15], s76 offen lds
    s_add_u32 m0, s78, 91136
    s_mov_b64 exec, s[62:63]
    buffer_load_dwordx4 v15, s[12:15], s76 offen lds
    s_add_u32 m0, s78, 92160
    s_mov_b64 exec, s[64:65]
    buffer_load_dwordx4 v16, s[12:15], s76 offen lds
    s_add_u32 m0, s78, 93184
    s_mov_b64 exec, s[66:67]
    buffer_load_dwordx4 v17, s[12:15], s76 offen lds
    s_mov_b64 exec, -1
    s_waitcnt vmcnt(8)
    s_barrier
    s_add_u32 m0, s78, 94208
    s_mov_b64 exec, s[68:69]
    buffer_load_dwordx4 v18, s[12:15], s76 offen lds
    s_add_u32 m0, s78, 95232
    s_mov_b64 exec, s[70:71]
    buffer_load_dwordx4 v19, s[12:15], s76 offen lds
    s_add_u32 m0, s78, 96256
    s_mov_b64 exec, s[72:73]
    buffer_load_dwordx4 v20, s[12:15], s76 offen lds
    s_mov_b64 exec, -1
    s_waitcnt lgkmcnt(0)
    v_add_u32 v2, 0, v30
    s_mov_b32 exec_lo, 0x0
    s_mov_b32 exec_hi, 0xffff0000
    ds_write_b32 v2, v21
    s_mov_b64 exec, -1
    s_add_u32 s74, s74, 1
    s_cmp_eq_u32 s74, 9
    s_cselect_b32 s74, 0, s74
    s_lshl_b32 s75, s74, 7
    s_mul_i32 s76, s74, 221184
    s_add_u32 m0, s77, 0
    s_nop 0
    buffer_load_dwordx4 v10, s[8:11], s75 offen lds
    s_add_u32 m0, s77, 1024
    s_nop 0
    buffer_load_dwordx4 v11, s[8:11], s75 offen lds
    s_add_u32 m0, s77, 2048
    s_nop 0
    buffer_load_dwordx4 v12, s[8:11], s75 offen lds
    s_add_u32 m0, s77, 3072
    s_nop 0
    buffer_load_dwordx4 v13, s[8:11], s75 offen lds
    s_add_u32 m0, s78, 0
    s_mov_b64 exec, s[60:61]
    buffer_load_dwordx4 v14, s[12:15], s76 offen lds
    s_add_u32 m0, s78, 1024
    s_mov_b64 exec, s[62:63]
    buffer_load_dwordx4 v15, s[12:15], s76 offen lds
    s_add_u32 m0, s78, 2048
    s_mov_b64 exec, s[64:65]
    buffer_load_dwordx4 v16, s[12:15], s76 offen lds
    s_add_u32 m0, s78, 3072
    s_mov_b64 exec, s[66:67]
    buffer_load_dwordx4 v17, s[12:15], s76 offen lds
    s_mov_b64 exec, -1
    s_waitcnt vmcnt(8)
    s_barrier
    s_add_u32 m0, s78, 4096
    s_mov_b64 exec, s[68:69]
    buffer_load_dwordx4 v18, s[12:15], s76 offen lds
    s_add_u32 m0, s78, 5120
    s_mov_b64 exec, s[70:71]
    buffer_load_dwordx4 v19, s[12:15], s76 offen lds
    s_add_u32 m0, s78, 6144
    s_mov_b64 exec, s[72:73]
    buffer_load_dwordx4 v20, s[12:15], s76 offen lds
    s_mov_b64 exec, -1
    s_waitcnt lgkmcnt(0)
    v_add_u32 v2, 45056, v30
    s_mov_b32 exec_lo, 0xffff
    s_mov_b32 exec_hi, 0x0
    ds_write_b32 v2, v22
    s_mov_b64 exec, -1
    s_add_u32 s74, s74, 1
    s_cmp_eq_u32 s74, 9
    s_cselect_b32 s74, 0, s74
    s_lshl_b32 s75, s74, 7
    s_mul_i32 s76, s74, 221184
    s_add_u32 m0, s77, 45056
    s_nop 0
    buffer_load_dwordx4 v10, s[8:11], s75 offen lds
    s_add_u32 m0, s77, 46080
    s_nop 0
    buffer_load_dwordx4 v11, s[8:11], s75 offen lds
    s_add_u32 m0, s77, 47104
    s_nop 0
    buffer_load_dwordx4 v12, s[8:11], s75 offen lds
    s_add_u32 m0, s77, 48128
    s_nop 0
    buffer_load_dwordx4 v13, s[8:11], s75 offen lds
    s_add_u32 m0, s78, 45056
    s_mov_b64 exec, s[60:61]
    buffer_load_dwordx4 v14, s[12:15], s76 offen lds
    s_add_u32 m0, s78, 46080
    s_mov_b64 exec, s[62:63]
    buffer_load_dwordx4 v15, s[12:15], s76 offen lds
    s_add_u32 m0, s78, 47104
    s_mov_b64 exec, s[64:65]
    buffer_load_dwordx4 v16, s[12:15], s76 offen lds
    s_add_u32 m0, s78, 48128
    s_mov_b64 exec, s[66:67]
    buffer_load_dwordx4 v17, s[12:15], s76 offen lds
    s_mov_b64 exec, -1
    s_waitcnt vmcnt(8)
    s_barrier
    s_add_u32 m0, s78, 49152
    s_mov_b64 exec, s[68:69]
    buffer_load_dwordx4 v18, s[12:15], s76 offen lds
    s_add_u32 m0, s78, 50176
    s_mov_b64 exec, s[70:71]
    buffer_load_dwordx4 v19, s[12:15], s76 offen lds
    s_add_u32 m0, s78, 51200
    s_mov_b64 exec, s[72:73]
    buffer_load_dwordx4 v20, s[12:15], s76 offen lds
    s_mov_b64 exec, -1
    s_waitcnt lgkmcnt(0)
    v_add_u32 v2, 90112, v30
    s_mov_b32 exec_lo, 0xffff0000
    s_mov_b32 exec_hi, 0x0
    ds_write_b32 v2, v22
    s_mov_b64 exec, -1
    s_add_u32 s74, s74, 1
    s_cmp_eq_u32 s74, 9
    s_cselect_b32 s74, 0, s74
    s_lshl_b32 s75, s74, 7
    s_mul_i32 s76, s74, 221184
    s_add_u32 m0, s77, 90112
    s_nop 0
    buffer_load_dwordx4 v10, s[8:11], s75 offen lds
    s_add_u32 m0, s77, 91136
    s_nop 0
    buffer_load_dwordx4 v11, s[8:11], s75 offen lds
    s_add_u32 m0, s77, 92160
    s_nop 0
    buffer_load_dwordx4 v12, s[8:11], s75 offen lds
    s_add_u32 m0, s77, 93184
    s_nop 0
    buffer_load_dwordx4 v13, s[8:11], s75 offen lds
    s_add_u32 m0, s78, 90112
    s_mov_b64 exec, s[60:61]
    buffer_load_dwordx4 v14, s[12:15], s76 offen lds
    s_add_u32 m0, s78, 91136
    s_mov_b64 exec, s[62:63]
    buffer_load_dwordx4 v15, s[12:15], s76 offen lds
    s_add_u32 m0, s78, 92160
    s_mov_b64 exec, s[64:65]
    buffer_load_dwordx4 v16, s[12:15], s76 offen lds
    s_add_u32 m0, s78, 93184
    s_mov_b64 exec, s[66:67]
    buffer_load_dwordx4 v17, s[12:15], s76 offen lds
    s_mov_b64 exec, -1
    s_waitcnt vmcnt(8)
    s_barrier
    s_add_u32 m0, s78, 94208
    s_mov_b64 exec, s[68:69]
    buffer_load_dwordx4 v18, s[12:15], s76 offen lds
    s_add_u32 m0, s78, 95232
    s_mov_b64 exec, s[70:71]
    buffer_load_dwordx4 v19, s[12:15], s76 offen lds
    s_add_u32 m0, s78, 96256
    s_mov_b64 exec, s[72:73]
    buffer_load_dwordx4 v20, s[12:15], s76 offen lds
    s_mov_b64 exec, -1
    s_waitcnt lgkmcnt(0)
    v_add_u32 v2, 0, v30
    s_mov_b32 exec_lo, 0x0
    s_mov_b32 exec_hi, 0xffff
    ds_write_b32 v2, v22
    s_mov_b64 exec, -1
    s_add_u32 s74, s74, 1
    s_cmp_eq_u32 s74, 9
    s_cselect_b32 s74, 0, s74
    s_lshl_b32 s75, s74, 7
    s_mul_i32 s76, s74, 221184
    s_add_u32 m0, s77, 0
    s_nop 0
    buffer_load_dwordx4 v10, s[8:11], s75 offen lds
    s_add_u32 m0, s77, 1024
    s_nop 0
    buffer_load_dwordx4 v11, s[8:11], s75 offen lds
    s_add_u32 m0, s77, 2048
    s_nop 0
    buffer_load_dwordx4 v12, s[8:11], s75 offen lds
    s_add_u32 m0, s77, 3072
    s_nop 0
    buffer_load_dwordx4 v13, s[8:11], s75 offen lds
    s_add_u32 m0, s78, 0
    s_mov_b64 exec, s[60:61]
    buffer_load_dwordx4 v14, s[12:15], s76 offen lds
    s_add_u32 m0, s78, 1024
    s_mov_b64 exec, s[62:63]
    buffer_load_dwordx4 v15, s[12:15], s76 offen lds
    s_add_u32 m0, s78, 2048
    s_mov_b64 exec, s[64:65]
    buffer_load_dwordx4 v16, s[12:15], s76 offen lds
    s_add_u32 m0, s78, 3072
    s_mov_b64 exec, s[66:67]
    buffer_load_dwordx4 v17, s[12:15], s76 offen lds
    s_mov_b64 exec, -1
    s_waitcnt vmcnt(8)
    s_barrier
    s_add_u32 m0, s78, 4096
    s_mov_b64 exec, s[68:69]
    buffer_load_dwordx4 v18, s[12:15], s76 offen lds
    s_add_u32 m0, s78, 5120
    s_mov_b64 exec, s[70:71]
    buffer_load_dwordx4 v19, s[12:15], s76 offen lds
    s_add_u32 m0, s78, 6144
    s_mov_b64 exec, s[72:73]
    buffer_load_dwordx4 v20, s[12:15], s76 offen lds
    s_mov_b64 exec, -1
    s_waitcnt lgkmcnt(0)
    v_add_u32 v2, 45056, v30
    s_mov_b32 exec_lo, 0x0
    s_mov_b32 exec_hi, 0xffff0000
    ds_write_b32 v2, v22
    s_mov_b64 exec, -1
    s_add_u32 s74, s74, 1
    s_cmp_eq_u32 s74, 9
    s_cselect_b32 s74, 0, s74
    s_lshl_b32 s75, s74, 7
    s_mul_i32 s76, s74, 221184
    s_add_u32 m0, s77, 45056
    s_nop 0
    buffer_load_dwordx4 v10, s[8:11], s75 offen lds
    s_add_u32 m0, s77, 46080
    s_nop 0
    buffer_load_dwordx4 v11, s[8:11], s75 offen lds
    s_add_u32 m0, s77, 47104
    s_nop 0
    buffer_load_dwordx4 v12, s[8:11], s75 offen lds
    s_add_u32 m0, s77, 48128
    s_nop 0
    buffer_load_dwordx4 v13, s[8:11], s75 offen lds
    s_add_u32 m0, s78, 45056
    s_mov_b64 exec, s[60:61]
    buffer_load_dwordx4 v14, s[12:15], s76 offen lds
    s_add_u32 m0, s78, 46080
    s_mov_b64 exec, s[62:63]
    buffer_load_dwordx4 v15, s[12:15], s76 offen lds
    s_add_u32 m0, s78, 47104
    s_mov_b64 exec, s[64:65]
    buffer_load_dwordx4 v16, s[12:15], s76 offen lds
    s_add_u32 m0, s78, 48128
    s_mov_b64 exec, s[66:67]
    buffer_load_dwordx4 v17, s[12:15], s76 offen lds
    s_mov_b64 exec, -1
    s_waitcnt vmcnt(8)
    s_barrier
    s_add_u32 m0, s78, 49152
    s_mov_b64 exec, s[68:69]
    buffer_load_dwordx4 v18, s[12:15], s76 offen lds
    s_add_u32 m0, s78, 50176
    s_mov_b64 exec, s[70:71]
    buffer_load_dwordx4 v19, s[12:15], s76 offen lds
    s_add_u32 m0, s78, 51200
    s_mov_b64 exec, s[72:73]
    buffer_load_dwordx4 v20, s[12:15], s76 offen lds
    s_mov_b64 exec, -1
    s_waitcnt lgkmcnt(0)
    v_add_u32 v2, 90112, v30
    s_mov_b32 exec_lo, 0xffff
    s_mov_b32 exec_hi, 0x0
    ds_write_b32 v2, v23
    s_mov_b64 exec, -1
    s_add_u32 s74, s74, 1
    s_cmp_eq_u32 s74, 9
    s_cselect_b32 s74, 0, s74
    s_lshl_b32 s75, s74, 7
    s_mul_i32 s76, s74, 221184
    s_add_u32 m0, s77, 90112
    s_nop 0
    buffer_load_dwordx4 v10, s[8:11], s75 offen lds
    s_add_u32 m0, s77, 91136
    s_nop 0
    buffer_load_dwordx4 v11, s[8:11], s75 offen lds
    s_add_u32 m0, s77, 92160
    s_nop 0
    buffer_load_dwordx4 v12, s[8:11], s75 offen lds
    s_add_u32 m0, s77, 93184
    s_nop 0
    buffer_load_dwordx4 v13, s[8:11], s75 offen lds
    s_add_u32 m0, s78, 90112
    s_mov_b64 exec, s[60:61]
    buffer_load_dwordx4 v14, s[12:15], s76 offen lds
    s_add_u32 m0, s78, 91136
    s_mov_b64 exec, s[62:63]
    buffer_load_dwordx4 v15, s[12:15], s76 offen lds
    s_add_u32 m0, s78, 92160
    s_mov_b64 exec, s[64:65]
    buffer_load_dwordx4 v16, s[12:15], s76 offen lds
    s_add_u32 m0, s78, 93184
    s_mov_b64 exec, s[66:67]
    buffer_load_dwordx4 v17, s[12:15], s76 offen lds
    s_mov_b64 exec, -1
    s_waitcnt vmcnt(8)
    s_barrier
    s_add_u32 m0, s78, 94208
    s_mov_b64 exec, s[68:69]
    buffer_load_dwordx4 v18, s[12:15], s76 offen lds
    s_add_u32 m0, s78, 95232
    s_mov_b64 exec, s[70:71]
    buffer_load_dwordx4 v19, s[12:15], s76 offen lds
    s_add_u32 m0, s78, 96256
    s_mov_b64 exec, s[72:73]
    buffer_load_dwordx4 v20, s[12:15], s76 offen lds
    s_mov_b64 exec, -1
    s_waitcnt lgkmcnt(0)
    v_mov_b32 v1, 0
    global_load_dword v32, v1, s[56:57] sc1
    s_lshl_b32 s30, s24, 2
    s_add_u32 s30, s30, s29
    s_cmp_lt_u32 s30, 32
    s_cselect_b32 s20, s4, s6
    s_cselect_b32 s21, s5, s7
    s_mov_b32 s22, 663552
    s_and_b32 s30, s30, 31
    s_mul_i32 s33, s30, 4352
    s_mul_i32 s30, s30, 16384
    s_add_u32 s30, s30, 139264
    s_cmp_eq_u32 s26, 0
    s_cselect_b32 s33, s33, s30
    v_lshlrev_b32 v2, 7, v255
    s_cmp_eq_u32 s26, 0
    s_mov_b32 s30, 0xffffffff
    s_cselect_b32 exec_lo, s30, 0xffffffff
    s_mov_b32 s30, 0x3
    s_cselect_b32 exec_hi, s30, 0xffffffff
    buffer_load_dword v254, v2, s[20:23], s33 offen
    s_add_u32 s33, s33, 8192
    s_mov_b64 exec, -1
    s_lshl_b32 s30, s27, 4
    s_add_u32 s30, s30, s24
    s_lshl_b32 s30, s30, 7
    s_add_u32 s30, s30, 11796480
    s_lshl_b32 s31, s27, 2
    s_add_u32 s31, s31, s29
    s_lshl_b32 s31, s31, 7
    s_add_u32 s31, s31, 11862016
    s_cmp_eq_u32 s26, 0
    s_cselect_b32 s30, s30, s31
    s_mov_b64 exec, 1
    buffer_load_dword v254, v2, s[16:19], s30 offen
    s_mov_b64 exec, -1
    s_waitcnt vmcnt(3) lgkmcnt(0)
    s_barrier
    s_barrier
    s_cmp_eq_u32 s26, 0
    s_mov_b32 s30, 0x1
    s_cselect_b32 exec_lo, s30, 0xffffffff
    s_mov_b32 s30, 0x0
    s_cselect_b32 exec_hi, s30, 0xffffffff
    buffer_load_dword v254, v2, s[20:23], s33 offen
    s_add_u32 s33, s33, 8192
    s_mov_b64 exec, -1
    s_waitcnt vmcnt(3)
    s_mov_b32 s30, 20000
L12_nonce_poll:
    v_cmp_ne_u32 vcc, 0, v32
    s_cbranch_vccnz L12_nonce_ok
    s_sleep 2
    global_load_dword v32, v1, s[56:57] sc1
    s_waitcnt vmcnt(0)
    s_sub_u32 s30, s30, 1
    s_cmp_lg_u32 s30, 0
    s_cbranch_scc1 L12_nonce_poll
L12_nonce_ok:
    v_mov_b32 v34, 147968
    v_mov_b32 v33, 0
    ds_write_b64 v34, v[32:33]
    v_readfirstlane_b32 s42, v32
    s_cmp_lg_u32 s26, 0
    s_cbranch_scc1 L12_B_loader
    v_lshrrev_b32 v1, 3, v255
    v_mul_u32_u24 v1, 1152, v1
    v_bfe_u32 v2, v255, 4, 1
    v_lshlrev_b32 v2, 2, v2
    v_xor_b32 v2, v2, v255
    v_and_b32 v2, 7, v2
    v_lshl_add_u32 v1, v2, 4, v1
    s_lshl_b32 s30, s85, 7
    s_mul_i32 s31, s29, 9216
    s_add_u32 s30, s30, s31
    v_add_u32 v241, s30, v1
    s_lshl_b32 s77, s29, 10
    s_mul_i32 s71, s29, 30800
    s_cmp_lt_u32 s29, 2
    s_cselect_b32 s68, -1, 1
    s_cselect_b32 s69, -1, 0
    s_cselect_b32 s70, s29, 0
    s_lshl_b32 s70, s70, 10
    s_mul_i32 s31, s84, 144
    s_add_u32 s31, s31, 6291456
    s_lshl_b32 s30, s29, 10
    s_add_u32 s32, s30, 0
    v_add_u32 v2, s32, v248
    v_add_u32 v3, 285696, v2
    v_cmp_le_u32 vcc, 9216, v2
    s_nop 1
    v_cndmask_b32 v2, v2, v3, vcc
    v_add_u32 v242, s31, v2
    s_add_u32 s32, s30, 4096
    v_add_u32 v2, s32, v248
    v_add_u32 v3, 285696, v2
    v_cmp_le_u32 vcc, 9216, v2
    s_nop 1
    v_cndmask_b32 v2, v2, v3, vcc
    v_add_u32 v243, s31, v2
    s_add_u32 s32, s30, 8192
    v_add_u32 v2, s32, v248
    v_add_u32 v3, 285696, v2
    v_cmp_le_u32 vcc, 9216, v2
    s_nop 1
    v_cndmask_b32 v2, v2, v3, vcc
    v_add_u32 v244, s31, v2
    s_add_u32 s32, s30, 12288
    v_add_u32 v2, s32, v248
    v_add_u32 v3, 285696, v2
    v_cmp_le_u32 vcc, 9216, v2
    s_nop 1
    v_cndmask_b32 v2, v2, v3, vcc
    v_add_u32 v245, s31, v2
    s_add_u32 s32, s70, 16384
    v_add_u32 v2, s32, v248
    v_add_u32 v3, 285696, v2
    v_cmp_le_u32 vcc, 9216, v2
    s_nop 1
    v_cndmask_b32 v2, v2, v3, vcc
    v_add_u32 v246, s31, v2
    v_cmp_le_u32 vcc, 8, v255
    v_subrev_u32 v1, 8, v255
    s_nop 0
    v_cndmask_b32 v1, v255, v1, vcc
    v_cndmask_b32 v2, 0, 1, vcc
    v_lshlrev_b32 v1, 7, v1
    v_mul_u32_u24 v2, 294912, v2
    s_mul_i32 s30, s29, 589824
    s_mul_i32 s32, s85, 1024
    s_add_u32 s30, s30, s32
    s_add_u32 s30, s30, s31
    v_add3_u32 v251, v1, v2, s30
    s_lshr_b32 s30, s84, 5
    v_lshrrev_b32 v1, 4, v255
    v_add_u32 v1, s30, v1
    v_and_b32 v2, 15, v255
    v_lshlrev_b32 v1, 7, v1
    v_lshl_add_u32 v1, v2, 2, v1
    v_add_u32 v250, 11665408, v1
    s_mul_i32 s30, s25, 294912
    s_mul_i32 s31, s24, 18432
    s_add_u32 s30, s30, s31
    s_mul_i32 s31, s29, 4608
    s_add_u32 s30, s30, s31
    s_add_u32 s30, s30, 6291456
    s_add_u32 s44, s58, s30
    s_addc_u32 s45, s59, 0
    s_mov_b32 s46, 4608
    s_mov_b32 s47, 0x20000
    s_add_u32 s31, s31, 123200
    v_add_u32 v253, s31, v248
    s_lshl_b32 s30, s24, 2
    s_add_u32 s30, s30, s29
    s_lshl_b32 s30, s30, 7
    s_lshl_b32 s31, s25, 2
    s_add_u32 s30, s30, s31
    s_add_u32 s30, s30, 11665408
    v_mov_b32 v252, s30
    s_mov_b32 s64, 0xff00ff00
    s_mov_b32 s65, 0x0
    s_mov_b32 s66, 0x00ff00ff
    s_mov_b32 s67, 0x0
    s_mov_b32 s36, s29
    s_cmp_lt_u32 s28, 4
    s_cselect_b32 s37, 2, 0
    s_add_u32 s38, s37, 1
    v_and_b32 v1, 31, v255
    v_lshrrev_b32 v2, 5, v255
    v_lshlrev_b32 v240, 4, v2
    v_and_b32 v3, 16, v255
    v_and_b32 v4, 3, v255
    v_lshl_add_u32 v3, v4, 2, v3
    v_bfe_u32 v5, v255, 2, 2
    v_add_u32 v3, v3, v5
    v_lshlrev_b32 v3, 4, v3
    v_add_u32 v3, 12320, v3
    v_lshl_add_u32 v5, v5, 2, v2
    v_lshlrev_b32 v5, 4, v5
    v_lshrrev_b32 v6, 1, v4
    v_mul_u32_u24 v6, 6160, v6
    v_and_b32 v4, 1, v4
    v_lshl_add_u32 v4, v4, 3, v6
    v_and_b32 v6, 16, v255
    v_cmp_ne_u32 vcc, 0, v6
    v_mov_b32 v6, 12320
    s_nop 0
    v_cndmask_b32 v4, v4, v6, vcc
    v_add_u32 v5, v5, v4
    s_mul_i32 s30, s36, 30800
    s_lshl_b32 s31, s37, 9
    s_add_u32 s30, s30, s31
    v_add_u32 v223, s30, v3
    v_mul_u32_u24 v6, 6160, v2
    s_mov_b32 s31, 6160
    v_add3_u32 v222, v223, v6, s31
    v_add_u32 v224, s30, v5
    s_lshl_b32 s30, s37, 5
    v_add_u32 v6, s30, v1
    v_mul_u32_u24 v7, 144, v6
    s_mul_i32 s30, s36, 36
    s_add_u32 s30, s30, 123200
    s_and_b32 s31, s36, 1
    s_lshl_b32 s32, s31, 2
    s_add_u32 s32, s32, s30
    s_lshl_b32 s31, s31, 5
    s_sub_u32 s30, s30, s31
    v_add_u32 v226, s30, v7
    v_add_u32 v225, s32, v7
    v_lshl_add_u32 v225, v2, 3, v225
    v_mul_u32_u24 v7, 48, v6
    s_mul_i32 s30, s36, 6144
    s_add_u32 s30, s30, 123200
    v_add_u32 v227, s30, v7
    v_lshlrev_b32 v7, 2, v6
    v_add_u32 v228, 148032, v7
    s_lshl_b32 s30, s38, 5
    v_add_u32 v6, s30, v1
    v_mul_u32_u24 v7, 144, v6
    s_mul_i32 s30, s36, 36
    s_add_u32 s30, s30, 123200
    s_and_b32 s31, s36, 1
    s_lshl_b32 s32, s31, 2
    s_add_u32 s32, s32, s30
    s_lshl_b32 s31, s31, 5
    s_sub_u32 s30, s30, s31
    v_add_u32 v233, s30, v7
    v_add_u32 v232, s32, v7
    v_lshl_add_u32 v232, v2, 3, v232
    v_mul_u32_u24 v7, 48, v6
    s_mul_i32 s30, s36, 6144
    s_add_u32 s30, s30, 123200
    v_add_u32 v234, s30, v7
    v_lshlrev_b32 v7, 2, v6
    v_add_u32 v235, 148032, v7
    v_sub_u32 v3, v1, v2
    v_mov_b32 v4, 0xf149f2ca
    v_cmp_le_i32 vcc, 0, v3
    s_nop 1
    v_cndmask_b32 v190, v4, 0, vcc
    v_cndmask_b32 v206, 0, v4, vcc
    v_cmp_le_i32 vcc, 4, v3
    s_nop 1
    v_cndmask_b32 v191, v4, 0, vcc
    v_cndmask_b32 v207, 0, v4, vcc
    v_cmp_le_i32 vcc, 8, v3
    s_nop 1
    v_cndmask_b32 v192, v4, 0, vcc
    v_cndmask_b32 v208, 0, v4, vcc
    v_cmp_le_i32 vcc, 12, v3
    s_nop 1
    v_cndmask_b32 v193, v4, 0, vcc
    v_cndmask_b32 v209, 0, v4, vcc
    v_cmp_le_i32 vcc, 2, v3
    s_nop 1
    v_cndmask_b32 v194, v4, 0, vcc
    v_cndmask_b32 v210, 0, v4, vcc
    v_cmp_le_i32 vcc, 6, v3
    s_nop 1
    v_cndmask_b32 v195, v4, 0, vcc
    v_cndmask_b32 v211, 0, v4, vcc
    v_cmp_le_i32 vcc, 10, v3
    s_nop 1
    v_cndmask_b32 v196, v4, 0, vcc
    v_cndmask_b32 v212, 0, v4, vcc
    v_cmp_le_i32 vcc, 14, v3
    s_nop 1
    v_cndmask_b32 v197, v4, 0, vcc
    v_cndmask_b32 v213, 0, v4, vcc
    v_cmp_le_i32 vcc, 16, v3
    s_nop 1
    v_cndmask_b32 v198, v4, 0, vcc
    v_cndmask_b32 v214, 0, v4, vcc
    v_cmp_le_i32 vcc, 20, v3
    s_nop 1
    v_cndmask_b32 v199, v4, 0, vcc
    v_cndmask_b32 v215, 0, v4, vcc
    v_cmp_le_i32 vcc, 24, v3
    s_nop 1
    v_cndmask_b32 v200, v4, 0, vcc
    v_cndmask_b32 v216, 0, v4, vcc
    v_cmp_le_i32 vcc, 28, v3
    s_nop 1
    v_cndmask_b32 v201, v4, 0, vcc
    v_cndmask_b32 v217, 0, v4, vcc
    v_cmp_le_i32 vcc, 18, v3
    s_nop 1
    v_cndmask_b32 v202, v4, 0, vcc
    v_cndmask_b32 v218, 0, v4, vcc
    v_cmp_le_i32 vcc, 22, v3
    s_nop 1
    v_cndmask_b32 v203, v4, 0, vcc
    v_cndmask_b32 v219, 0, v4, vcc
    v_cmp_le_i32 vcc, 26, v3
    s_nop 1
    v_cndmask_b32 v204, v4, 0, vcc
    v_cndmask_b32 v220, 0, v4, vcc
    v_cmp_le_i32 vcc, 30, v3
    s_nop 1
    v_cndmask_b32 v205, v4, 0, vcc
    v_cndmask_b32 v221, 0, v4, vcc
    s_waitcnt lgkmcnt(0)
    s_barrier
    s_branch L12_A_common
L12_B_loader:
    v_lshrrev_b32 v1, 3, v255
    v_mul_u32_u24 v1, 1152, v1
    v_bfe_u32 v2, v255, 4, 1
    v_lshlrev_b32 v2, 2, v2
    v_xor_b32 v2, v2, v255
    v_and_b32 v2, 7, v2
    v_lshl_add_u32 v1, v2, 4, v1
    s_lshl_b32 s30, s85, 7
    s_mul_i32 s31, s29, 9216
    s_add_u32 s30, s30, s31
    v_add_u32 v241, s30, v1
    s_lshl_b32 s77, s29, 10
    s_mul_i32 s71, s29, 30800
    s_cmp_lt_u32 s29, 3
    s_cselect_b32 s68, -1, 1
    s_cselect_b32 s69, -1, 0
    s_cselect_b32 s70, s29, 0
    s_lshl_b32 s70, s70, 10
    s_mul_i32 s31, s84, 144
    s_add_u32 s31, s31, 6291456
    s_lshl_b32 s30, s29, 10
    s_add_u32 s32, s30, 0
    v_add_u32 v2, s32, v248
    v_add_u32 v3, 281088, v2
    v_cmp_le_u32 vcc, 13824, v2
    s_nop 1
    v_cndmask_b32 v2, v2, v3, vcc
    v_add_u32 v242, s31, v2
    s_add_u32 s32, s30, 4096
    v_add_u32 v2, s32, v248
    v_add_u32 v3, 281088, v2
    v_cmp_le_u32 vcc, 13824, v2
    s_nop 1
    v_cndmask_b32 v2, v2, v3, vcc
    v_add_u32 v243, s31, v2
    s_add_u32 s32, s30, 8192
    v_add_u32 v2, s32, v248
    v_add_u32 v3, 281088, v2
    v_cmp_le_u32 vcc, 13824, v2
    s_nop 1
    v_cndmask_b32 v2, v2, v3, vcc
    v_add_u32 v244, s31, v2
    s_add_u32 s32, s30, 12288
    v_add_u32 v2, s32, v248
    v_add_u32 v3, 281088, v2
    v_cmp_le_u32 vcc, 13824, v2
    s_nop 1
    v_cndmask_b32 v2, v2, v3, vcc
    v_add_u32 v245, s31, v2
    s_add_u32 s32, s30, 16384
    v_add_u32 v2, s32, v248
    v_add_u32 v3, 281088, v2
    v_cmp_le_u32 vcc, 13824, v2
    s_nop 1
    v_cndmask_b32 v2, v2, v3, vcc
    v_add_u32 v246, s31, v2
    s_add_u32 s32, s30, 20480
    v_add_u32 v2, s32, v248
    v_add_u32 v3, 281088, v2
    v_cmp_le_u32 vcc, 13824, v2
    s_nop 1
    v_cndmask_b32 v2, v2, v3, vcc
    v_add_u32 v247, s31, v2
    s_add_u32 s32, s70, 24576
    v_add_u32 v2, s32, v248
    v_add_u32 v3, 281088, v2
    v_cmp_le_u32 vcc, 13824, v2
    s_nop 1
    v_cndmask_b32 v2, v2, v3, vcc
    v_add_u32 v249, s31, v2
    v_cmp_le_u32 vcc, 12, v255
    v_subrev_u32 v1, 12, v255
    s_nop 0
    v_cndmask_b32 v1, v255, v1, vcc
    v_cndmask_b32 v2, 0, 1, vcc
    v_lshlrev_b32 v1, 7, v1
    v_mul_u32_u24 v2, 294912, v2
    s_mul_i32 s30, s29, 589824
    s_mul_i32 s32, s85, 1536
    s_add_u32 s30, s30, s32
    s_add_u32 s30, s30, s31
    v_add3_u32 v251, v1, v2, s30
    s_lshr_b32 s30, s84, 5
    v_lshrrev_b32 v1, 4, v255
    v_add_u32 v1, s30, v1
    v_and_b32 v2, 15, v255
    v_lshlrev_b32 v1, 7, v1
    v_lshl_add_u32 v1, v2, 2, v1
    v_add_u32 v250, 11665408, v1
    s_mul_i32 s30, s25, 294912
    s_mul_i32 s31, s24, 18432
    s_add_u32 s30, s30, s31
    s_mul_i32 s31, s29, 4608
    s_add_u32 s30, s30, s31
    s_add_u32 s30, s30, 6291456
    s_add_u32 s44, s58, s30
    s_addc_u32 s45, s59, 0
    s_mov_b32 s46, 4608
    s_mov_b32 s47, 0x20000
    s_add_u32 s31, s31, 123200
    v_add_u32 v253, s31, v248
    s_lshl_b32 s30, s24, 2
    s_add_u32 s30, s30, s29
    s_lshl_b32 s30, s30, 7
    s_lshl_b32 s31, s25, 2
    s_add_u32 s30, s30, s31
    s_add_u32 s30, s30, 11665408
    v_mov_b32 v252, s30
    s_mov_b32 s64, 0xff00ff00
    s_mov_b32 s65, 0xff00
    s_mov_b32 s66, 0x00ff00ff
    s_mov_b32 s67, 0xff
    s_lshl_b32 s30, s27, 2
    s_add_u32 s30, s30, s29
    s_lshl_b32 s30, s30, 7
    s_add_u32 s30, s30, 11599872
    v_and_b32 v1, 15, v255
    v_lshlrev_b32 v1, 2, v1
    v_add_u32 v1, s30, v1
    v_add_u32 v2, 262144, v1
    v_cmp_gt_u32 vcc, 16, v255
    s_nop 1
    v_cndmask_b32 v1, v2, v1, vcc
    s_lshl_b32 s31, s24, 2
    s_add_u32 s30, s30, s31
    v_mov_b32 v10, s30
    v_add_u32 v27, 262144, v10
    v_lshrrev_b32 v3, 4, v255
    v_and_b32 v4, 15, v255
    v_mul_u32_u24 v5, 6144, v3
    v_lshl_add_u32 v5, v4, 4, v5
    s_mul_i32 s30, s29, 1536
    s_add_u32 s30, s30, 141632
    v_lshlrev_b32 v6, 4, v4
    v_lshl_add_u32 v6, v3, 3, v6
    v_add_u32 v6, s30, v6
    v_and_b32 v7, 1, v255
    v_lshlrev_b32 v7, 4, v7
    v_mov_b32 v8, 0x3f80
    v_lshlrev_b32 v7, v7, v8
    v_bfe_u32 v8, v255, 1, 2
    v_cmp_eq_u32 vcc, 0, v8
    s_nop 1
    v_cndmask_b32 v12, 0, v7, vcc
    v_cmp_eq_u32 vcc, 1, v8
    s_nop 1
    v_cndmask_b32 v13, 0, v7, vcc
    v_cmp_eq_u32 vcc, 2, v8
    s_nop 1
    v_cndmask_b32 v14, 0, v7, vcc
    v_cmp_eq_u32 vcc, 3, v8
    s_nop 1
    v_cndmask_b32 v15, 0, v7, vcc
    s_lshl_b32 s34, s27, 6
    s_add_u32 s34, s34, s29
    s_mul_i32 s34, s34, 1536
    s_add_u32 s34, s34, 5242880
    s_add_u32 s35, s34, 24576
    s_add_u32 s36, s34, 49152
    s_add_u32 s37, s34, 73728
    s_mul_i32 s30, s29, 1536
    s_add_u32 s30, s30, 141632
    v_add_u32 v9, s30, v248
    s_lshl_b32 s30, s27, 4
    s_add_u32 s30, s30, s24
    s_lshl_b32 s30, s30, 2
    s_add_u32 s30, s30, s29
    s_mul_i32 s30, s30, 1536
    s_add_u32 s30, s30, 5242880
    s_add_u32 s20, s58, s30
    s_addc_u32 s21, s59, 0
    s_mov_b32 s22, 1520
    s_mov_b32 s23, 0x20000
    v_mov_b32 v11, s42
    s_waitcnt lgkmcnt(0)
    s_barrier
    s_barrier
    ds_read_b128 v[16:19], v9
    ds_read_b128 v[20:23], v9 offset:1024
    s_waitcnt lgkmcnt(1)
    buffer_store_dwordx4 v[16:19], v248, s[20:23], 0 offen sc1
    s_waitcnt lgkmcnt(0)
    buffer_store_dwordx4 v[20:23], v248, s[20:23], 0 offen offset:1024 sc1
    s_waitcnt vmcnt(0)
    s_mov_b64 exec, 1
    buffer_store_dword v11, v27, s[16:19], 0 offen
    s_mov_b32 s30, 80000
    s_mov_b32 exec_hi, 0
L_poll_B:
    s_mov_b32 exec_lo, 0xffff0000
    buffer_load_dword v24, v1, s[16:19], 0 offen nt
    s_waitcnt vmcnt(0)
    v_cmp_ne_u32 vcc, v11, v24
    s_cbranch_vccz L_polled_B
    s_sub_u32 s30, s30, 1
    s_and_b32 vcc_lo, s30, 15
    s_cbranch_scc1 L_poll_B
    s_mov_b32 exec_lo, 1
    buffer_store_dword v11, v10, s[16:19], 0 offen sc1
    s_mov_b32 exec_lo, 0xffff
    buffer_load_dword v24, v1, s[16:19], 0 offen sc1
    s_waitcnt vmcnt(0)
    v_cmp_ne_u32 vcc, v11, v24
    s_cbranch_vccz L_polled_B
    s_cmp_lg_u32 s30, 0
    s_cbranch_scc1 L_poll_B
L_polled_B:
    s_cmp_eq_u32 exec_lo, 0xffff0000
    s_mov_b64 exec, -1
    buffer_load_dwordx4 v[32:35], v5, s[16:19], s34 offen offset:0 sc1
    buffer_load_dwordx4 v[36:39], v5, s[16:19], s35 offen offset:0 sc1
    buffer_load_dwordx4 v[40:43], v5, s[16:19], s36 offen offset:0 sc1
    buffer_load_dwordx4 v[44:47], v5, s[16:19], s37 offen offset:0 sc1
    buffer_load_dwordx4 v[48:51], v5, s[16:19], s34 offen offset:256 sc1
    buffer_load_dwordx4 v[52:55], v5, s[16:19], s35 offen offset:256 sc1
    buffer_load_dwordx4 v[56:59], v5, s[16:19], s36 offen offset:256 sc1
    buffer_load_dwordx4 v[60:63], v5, s[16:19], s37 offen offset:256 sc1
    buffer_load_dwordx4 v[64:67], v5, s[16:19], s34 offen offset:512 sc1
    buffer_load_dwordx4 v[68:71], v5, s[16:19], s35 offen offset:512 sc1
    buffer_load_dwordx4 v[72:75], v5, s[16:19], s36 offen offset:512 sc1
    buffer_load_dwordx4 v[76:79], v5, s[16:19], s37 offen offset:512 sc1
    buffer_load_dwordx4 v[80:83], v5, s[16:19], s34 offen offset:768 sc1
    buffer_load_dwordx4 v[84:87], v5, s[16:19], s35 offen offset:768 sc1
    buffer_load_dwordx4 v[88:91], v5, s[16:19], s36 offen offset:768 sc1
    buffer_load_dwordx4 v[92:95], v5, s[16:19], s37 offen offset:768 sc1
    buffer_load_dwordx4 v[96:99], v5, s[16:19], s34 offen offset:1024 sc1
    buffer_load_dwordx4 v[100:103], v5, s[16:19], s35 offen offset:1024 sc1
    buffer_load_dwordx4 v[104:107], v5, s[16:19], s36 offen offset:1024 sc1
    buffer_load_dwordx4 v[108:111], v5, s[16:19], s37 offen offset:1024 sc1
    buffer_load_dwordx4 v[112:115], v5, s[16:19], s34 offen offset:1280 sc1
    buffer_load_dwordx4 v[116:119], v5, s[16:19], s35 offen offset:1280 sc1
    buffer_load_dwordx4 v[120:123], v5, s[16:19], s36 offen offset:1280 sc1
    buffer_load_dwordx4 v[124:127], v5, s[16:19], s37 offen offset:1280 sc1
    s_mov_b32 exec_hi, 0
    s_mov_b32 exec_lo, 1
    buffer_store_dword v11, v10, s[16:19], 0 offen sc1
    s_mov_b64 exec, -1
    s_waitcnt vmcnt(24)
    v_mfma_f32_16x16x32_bf16 v[128:131], v[12:15], v[32:35], 0
    s_waitcnt vmcnt(23)
    v_mfma_f32_16x16x32_bf16 v[128:131], v[12:15], v[36:39], v[128:131]
    s_waitcnt vmcnt(22)
    v_mfma_f32_16x16x32_bf16 v[128:131], v[12:15], v[40:43], v[128:131]
    s_waitcnt vmcnt(21)
    v_mfma_f32_16x16x32_bf16 v[128:131], v[12:15], v[44:47], v[128:131]
    s_waitcnt vmcnt(20)
    v_mfma_f32_16x16x32_bf16 v[132:135], v[12:15], v[48:51], 0
    s_waitcnt vmcnt(19)
    v_mfma_f32_16x16x32_bf16 v[132:135], v[12:15], v[52:55], v[132:135]
    s_waitcnt vmcnt(18)
    v_mfma_f32_16x16x32_bf16 v[132:135], v[12:15], v[56:59], v[132:135]
    s_waitcnt vmcnt(17)
    v_mfma_f32_16x16x32_bf16 v[132:135], v[12:15], v[60:63], v[132:135]
    s_waitcnt vmcnt(16)
    v_mfma_f32_16x16x32_bf16 v[136:139], v[12:15], v[64:67], 0
    s_waitcnt vmcnt(15)
    v_mfma_f32_16x16x32_bf16 v[136:139], v[12:15], v[68:71], v[136:139]
    s_waitcnt vmcnt(14)
    v_mfma_f32_16x16x32_bf16 v[136:139], v[12:15], v[72:75], v[136:139]
    s_waitcnt vmcnt(13)
    v_mfma_f32_16x16x32_bf16 v[136:139], v[12:15], v[76:79], v[136:139]
    s_waitcnt vmcnt(12)
    v_mfma_f32_16x16x32_bf16 v[140:143], v[12:15], v[80:83], 0
    s_waitcnt vmcnt(11)
    v_mfma_f32_16x16x32_bf16 v[140:143], v[12:15], v[84:87], v[140:143]
    s_waitcnt vmcnt(10)
    v_mfma_f32_16x16x32_bf16 v[140:143], v[12:15], v[88:91], v[140:143]
    s_waitcnt vmcnt(9)
    v_mfma_f32_16x16x32_bf16 v[140:143], v[12:15], v[92:95], v[140:143]
    s_waitcnt vmcnt(8)
    v_mfma_f32_16x16x32_bf16 v[144:147], v[12:15], v[96:99], 0
    s_waitcnt vmcnt(7)
    v_mfma_f32_16x16x32_bf16 v[144:147], v[12:15], v[100:103], v[144:147]
    s_waitcnt vmcnt(6)
    v_mfma_f32_16x16x32_bf16 v[144:147], v[12:15], v[104:107], v[144:147]
    s_waitcnt vmcnt(5)
    v_mfma_f32_16x16x32_bf16 v[144:147], v[12:15], v[108:111], v[144:147]
    s_waitcnt vmcnt(4)
    v_mfma_f32_16x16x32_bf16 v[148:151], v[12:15], v[112:115], 0
    s_waitcnt vmcnt(3)
    v_mfma_f32_16x16x32_bf16 v[148:151], v[12:15], v[116:119], v[148:151]
    s_waitcnt vmcnt(2)
    v_mfma_f32_16x16x32_bf16 v[148:151], v[12:15], v[120:123], v[148:151]
    s_waitcnt vmcnt(1)
    v_mfma_f32_16x16x32_bf16 v[148:151], v[12:15], v[124:127], v[148:151]
    v_cvt_pk_bf16_f32 v152, v128, v129
    v_cvt_pk_bf16_f32 v153, v130, v131
    v_cvt_pk_bf16_f32 v154, v132, v133
    v_cvt_pk_bf16_f32 v155, v134, v135
    v_cvt_pk_bf16_f32 v156, v136, v137
    v_cvt_pk_bf16_f32 v157, v138, v139
    v_cvt_pk_bf16_f32 v158, v140, v141
    v_cvt_pk_bf16_f32 v159, v142, v143
    v_cvt_pk_bf16_f32 v160, v144, v145
    v_cvt_pk_bf16_f32 v161, v146, v147
    v_cvt_pk_bf16_f32 v162, v148, v149
    v_cvt_pk_bf16_f32 v163, v150, v151
    s_mov_b32 exec_hi, 0
    ds_write_b64 v6, v[152:153] offset:0
    ds_write_b64 v6, v[154:155] offset:256
    ds_write_b64 v6, v[156:157] offset:512
    ds_write_b64 v6, v[158:159] offset:768
    ds_write_b64 v6, v[160:161] offset:1024
    ds_write_b64 v6, v[162:163] offset:1280
    s_mov_b64 exec, -1
    s_waitcnt lgkmcnt(0)
    s_barrier
L12_P3B_loader:
    s_mov_b32 s8, s6
    s_mov_b32 s9, s7
    s_mov_b32 s10, 663552
    s_mov_b32 s11, 0x20000
    s_lshl_b32 s77, s29, 10
    s_mov_b32 s75, 0
    s_add_u32 m0, s77, 151552
    s_nop 0
    buffer_load_dwordx4 v241, s[8:11], s75 offen lds
    s_mov_b32 s75, 36864
    s_add_u32 m0, s77, 155648
    s_nop 0
    buffer_load_dwordx4 v241, s[8:11], s75 offen lds
    s_mov_b32 s75, 73728
    s_add_u32 m0, s77, 159744
    s_nop 0
    buffer_load_dwordx4 v241, s[8:11], s75 offen lds
    s_mov_b32 s75, 110592
    s_add_u32 m0, s71, 2560
    s_nop 0
    buffer_load_dwordx4 v241, s[8:11], s75 offen lds
    s_mov_b32 s75, 147456
    s_add_u32 m0, s71, 3584
    s_nop 0
    buffer_load_dwordx4 v241, s[8:11], s75 offen lds
    s_mov_b32 s75, 184320
    s_add_u32 m0, s71, 4608
    s_nop 0
    buffer_load_dwordx4 v241, s[8:11], s75 offen lds
    s_mov_b32 s75, 221184
    s_add_u32 m0, s71, 8720
    s_nop 0
    buffer_load_dwordx4 v241, s[8:11], s75 offen lds
    s_mov_b32 s75, 258048
    s_add_u32 m0, s71, 9744
    s_nop 0
    buffer_load_dwordx4 v241, s[8:11], s75 offen lds
    s_mov_b32 s75, 294912
    s_add_u32 m0, s71, 10768
    s_nop 0
    buffer_load_dwordx4 v241, s[8:11], s75 offen lds
    s_mov_b32 s75, 331776
    s_add_u32 m0, s71, 14880
    s_nop 0
    buffer_load_dwordx4 v241, s[8:11], s75 offen lds
    s_mov_b32 s75, 368640
    s_add_u32 m0, s71, 15904
    s_nop 0
    buffer_load_dwordx4 v241, s[8:11], s75 offen lds
    s_mov_b32 s75, 405504
    s_add_u32 m0, s71, 16928
    s_nop 0
    buffer_load_dwordx4 v241, s[8:11], s75 offen lds
    s_mov_b32 s75, 442368
    s_add_u32 m0, s71, 21040
    s_nop 0
    buffer_load_dwordx4 v241, s[8:11], s75 offen lds
    s_mov_b32 s75, 479232
    s_add_u32 m0, s71, 22064
    s_nop 0
    buffer_load_dwordx4 v241, s[8:11], s75 offen lds
    s_mov_b32 s75, 516096
    s_add_u32 m0, s71, 23088
    s_nop 0
    buffer_load_dwordx4 v241, s[8:11], s75 offen lds
    s_mov_b32 s75, 552960
    s_add_u32 m0, s71, 27200
    s_nop 0
    buffer_load_dwordx4 v241, s[8:11], s75 offen lds
    s_mov_b32 s75, 589824
    s_add_u32 m0, s71, 28224
    s_nop 0
    buffer_load_dwordx4 v241, s[8:11], s75 offen lds
    s_mov_b32 s75, 626688
    s_add_u32 m0, s71, 29248
    s_nop 0
    buffer_load_dwordx4 v241, s[8:11], s75 offen lds
    s_waitcnt vmcnt(0)
    s_barrier
    ds_read_b128 v[20:23], v253 offset:0
    ds_read_b128 v[24:27], v253 offset:1024
    ds_read_b128 v[28:31], v253 offset:2048
    ds_read_b128 v[32:35], v253 offset:3072
    ds_read_b128 v[36:39], v253 offset:4096
    s_mov_b32 s8, s4
    s_mov_b32 s9, s5
    s_mov_b32 s10, 663552
    s_mov_b32 s11, 0x20000
    s_mov_b32 s30, 4096
    v_mov_b32 v16, s42
    s_waitcnt lgkmcnt(4)
    buffer_store_dwordx4 v[20:23], v248, s[44:47], 0 offen offset:0 sc1
    s_waitcnt lgkmcnt(3)
    buffer_store_dwordx4 v[24:27], v248, s[44:47], 0 offen offset:1024 sc1
    s_waitcnt lgkmcnt(2)
    buffer_store_dwordx4 v[28:31], v248, s[44:47], 0 offen offset:2048 sc1
    s_waitcnt lgkmcnt(1)
    buffer_store_dwordx4 v[32:35], v248, s[44:47], 0 offen offset:3072 sc1
    s_waitcnt lgkmcnt(0)
    buffer_store_dwordx4 v[36:39], v248, s[44:47], s30 offen offset:0 sc1
    s_cmp_lg_u32 s43, 0
    s_cbranch_scc1 L12_P3B_tile
    s_waitcnt vmcnt(0)
    s_mov_b64 exec, 1
    buffer_store_dword v16, v252, s[16:19], 0 offen sc1
    s_mov_b64 exec, -1
    s_branch L12_P3_fin
L12_P3B_tile:
    s_barrier
    s_mov_b32 s75, 0
    s_add_u32 m0, s77, 49152
    s_nop 0
    buffer_load_dwordx4 v241, s[8:11], s75 offen lds
    s_mov_b32 s75, 36864
    s_add_u32 m0, s77, 53248
    s_nop 0
    buffer_load_dwordx4 v241, s[8:11], s75 offen lds
    s_mov_b32 s75, 73728
    s_add_u32 m0, s77, 57344
    s_nop 0
    buffer_load_dwordx4 v241, s[8:11], s75 offen lds
    s_mov_b32 s75, 110592
    s_add_u32 m0, s77, 61440
    s_nop 0
    buffer_load_dwordx4 v241, s[8:11], s75 offen lds
    s_mov_b32 s75, 147456
    s_add_u32 m0, s77, 65536
    s_nop 0
    buffer_load_dwordx4 v241, s[8:11], s75 offen lds
    s_waitcnt vmcnt(5)
    s_mov_b64 exec, 1
    buffer_store_dword v16, v252, s[16:19], 0 offen sc1
    s_mov_b64 exec, -1
    s_mov_b32 s75, 184320
    s_add_u32 m0, s77, 69632
    s_nop 0
    buffer_load_dwordx4 v241, s[8:11], s75 offen lds
    s_mov_b32 s75, 221184
    s_add_u32 m0, s77, 73728
    s_nop 0
    buffer_load_dwordx4 v241, s[8:11], s75 offen lds
    s_mov_b32 s75, 258048
    s_add_u32 m0, s77, 77824
    s_nop 0
    buffer_load_dwordx4 v241, s[8:11], s75 offen lds
    s_mov_b32 s75, 294912
    s_add_u32 m0, s77, 81920
    s_nop 0
    buffer_load_dwordx4 v241, s[8:11], s75 offen lds
    s_mov_b32 s75, 331776
    s_add_u32 m0, s77, 86016
    s_nop 0
    buffer_load_dwordx4 v241, s[8:11], s75 offen lds
    s_mov_b32 s75, 368640
    s_add_u32 m0, s77, 90112
    s_nop 0
    buffer_load_dwordx4 v241, s[8:11], s75 offen lds
    s_mov_b32 s75, 405504
    s_add_u32 m0, s77, 94208
    s_nop 0
    buffer_load_dwordx4 v241, s[8:11], s75 offen lds
    s_mov_b32 s75, 442368
    s_add_u32 m0, s77, 98304
    s_nop 0
    buffer_load_dwordx4 v241, s[8:11], s75 offen lds
    s_mov_b32 s75, 479232
    s_add_u32 m0, s77, 102400
    s_nop 0
    buffer_load_dwordx4 v241, s[8:11], s75 offen lds
    s_mov_b32 s75, 516096
    s_add_u32 m0, s77, 106496
    s_nop 0
    buffer_load_dwordx4 v241, s[8:11], s75 offen lds
    s_mov_b32 s75, 552960
    s_add_u32 m0, s77, 110592
    s_nop 0
    buffer_load_dwordx4 v241, s[8:11], s75 offen lds
    s_mov_b32 s75, 589824
    s_add_u32 m0, s77, 114688
    s_nop 0
    buffer_load_dwordx4 v241, s[8:11], s75 offen lds
    s_mov_b32 s75, 626688
    s_add_u32 m0, s77, 118784
    s_nop 0
    buffer_load_dwordx4 v241, s[8:11], s75 offen lds
    s_waitcnt vmcnt(0)
    s_barrier
    s_cmp_lg_u32 s29, 0
    s_cbranch_scc1 L_polled_OB1
    s_mov_b64 exec, s[64:65]
    s_mov_b32 s30, 20000
L_poll_OB1:
    buffer_load_dword v17, v250, s[16:19], 0 offen sc1
    s_waitcnt vmcnt(0)
    v_cmp_ne_u32 vcc, s42, v17
    s_cbranch_vccz L_polled_OB1
    s_sleep 1
    s_sub_u32 s30, s30, 1
    s_cmp_lg_u32 s30, 0
    s_cbranch_scc1 L_poll_OB1
L_polled_OB1:
    s_mov_b64 exec, -1
    s_barrier
    s_mov_b32 s75, 2359296
    s_add_u32 m0, s77, 0
    s_nop 0
    buffer_load_dwordx4 v242, s[16:19], s75 offen sc1 lds
    s_add_u32 m0, s77, 4096
    s_nop 0
    buffer_load_dwordx4 v243, s[16:19], s75 offen sc1 lds
    s_add_u32 m0, s77, 8192
    s_nop 0
    buffer_load_dwordx4 v244, s[16:19], s75 offen sc1 lds
    s_add_u32 m0, s77, 12288
    s_nop 0
    buffer_load_dwordx4 v245, s[16:19], s75 offen sc1 lds
    s_add_u32 m0, s77, 16384
    s_nop 0
    buffer_load_dwordx4 v246, s[16:19], s75 offen sc1 lds
    s_add_u32 m0, s77, 20480
    s_nop 0
    buffer_load_dwordx4 v247, s[16:19], s75 offen sc1 lds
    s_add_u32 m0, s70, 24576
    s_mov_b64 exec, s[68:69]
    buffer_load_dwordx4 v249, s[16:19], s75 offen sc1 lds
    s_mov_b64 exec, -1
    s_mov_b32 s75, 2949120
    s_add_u32 m0, s77, 27648
    s_nop 0
    buffer_load_dwordx4 v242, s[16:19], s75 offen sc1 lds
    s_add_u32 m0, s77, 31744
    s_nop 0
    buffer_load_dwordx4 v243, s[16:19], s75 offen sc1 lds
    s_add_u32 m0, s77, 35840
    s_nop 0
    buffer_load_dwordx4 v244, s[16:19], s75 offen sc1 lds
    s_add_u32 m0, s77, 39936
    s_nop 0
    buffer_load_dwordx4 v245, s[16:19], s75 offen sc1 lds
    s_add_u32 m0, s77, 44032
    s_nop 0
    buffer_load_dwordx4 v246, s[16:19], s75 offen sc1 lds
    s_add_u32 m0, s77, 48128
    s_nop 0
    buffer_load_dwordx4 v247, s[16:19], s75 offen sc1 lds
    s_add_u32 m0, s70, 52224
    s_mov_b64 exec, s[68:69]
    buffer_load_dwordx4 v249, s[16:19], s75 offen sc1 lds
    s_mov_b64 exec, -1
    s_waitcnt vmcnt(7)
    s_barrier
    s_mov_b32 s75, 3538944
    s_add_u32 m0, s77, 55296
    s_nop 0
    buffer_load_dwordx4 v242, s[16:19], s75 offen sc1 lds
    s_add_u32 m0, s77, 59392
    s_nop 0
    buffer_load_dwordx4 v243, s[16:19], s75 offen sc1 lds
    s_add_u32 m0, s77, 63488
    s_nop 0
    buffer_load_dwordx4 v244, s[16:19], s75 offen sc1 lds
    s_add_u32 m0, s77, 67584
    s_nop 0
    buffer_load_dwordx4 v245, s[16:19], s75 offen sc1 lds
    s_add_u32 m0, s77, 71680
    s_nop 0
    buffer_load_dwordx4 v246, s[16:19], s75 offen sc1 lds
    s_add_u32 m0, s77, 75776
    s_nop 0
    buffer_load_dwordx4 v247, s[16:19], s75 offen sc1 lds
    s_add_u32 m0, s70, 79872
    s_mov_b64 exec, s[68:69]
    buffer_load_dwordx4 v249, s[16:19], s75 offen sc1 lds
    s_mov_b64 exec, -1
    s_mov_b64 exec, s[66:67]
    buffer_load_dword v17, v250, s[16:19], 0 offen sc1
    s_mov_b64 exec, -1
    s_waitcnt vmcnt(8)
    s_barrier
    s_mov_b32 s75, 4128768
    s_add_u32 m0, s77, 82944
    s_nop 0
    buffer_load_dwordx4 v242, s[16:19], s75 offen sc1 lds
    s_add_u32 m0, s77, 87040
    s_nop 0
    buffer_load_dwordx4 v243, s[16:19], s75 offen sc1 lds
    s_add_u32 m0, s77, 91136
    s_nop 0
    buffer_load_dwordx4 v244, s[16:19], s75 offen sc1 lds
    s_add_u32 m0, s77, 95232
    s_nop 0
    buffer_load_dwordx4 v245, s[16:19], s75 offen sc1 lds
    s_add_u32 m0, s77, 99328
    s_nop 0
    buffer_load_dwordx4 v246, s[16:19], s75 offen sc1 lds
    s_add_u32 m0, s77, 103424
    s_nop 0
    buffer_load_dwordx4 v247, s[16:19], s75 offen sc1 lds
    s_add_u32 m0, s70, 107520
    s_mov_b64 exec, s[68:69]
    buffer_load_dwordx4 v249, s[16:19], s75 offen sc1 lds
    s_mov_b64 exec, -1
    s_waitcnt vmcnt(7)
    s_barrier
    s_mov_b64 exec, s[66:67]
    v_cmp_ne_u32 vcc, s42, v17
    s_cbranch_vccz L12_P3B_aready
    s_waitcnt vmcnt(0)
    s_barrier
    s_mov_b32 s30, 20000
L_poll_OB2:
    buffer_load_dword v17, v250, s[16:19], 0 offen sc1
    s_waitcnt vmcnt(0)
    v_cmp_ne_u32 vcc, s42, v17
    s_cbranch_vccz L_polled_OB2
    s_sleep 1
    s_sub_u32 s30, s30, 1
    s_cmp_lg_u32 s30, 0
    s_cbranch_scc1 L_poll_OB2
L_polled_OB2:
    s_mov_b64 exec, -1
    s_mov_b32 s75, 0
    s_add_u32 m0, s77, 110592
    s_nop 0
    buffer_load_dwordx4 v242, s[16:19], s75 offen sc1 lds
    s_add_u32 m0, s77, 114688
    s_nop 0
    buffer_load_dwordx4 v243, s[16:19], s75 offen sc1 lds
    s_add_u32 m0, s77, 118784
    s_nop 0
    buffer_load_dwordx4 v244, s[16:19], s75 offen sc1 lds
    s_add_u32 m0, s77, 122880
    s_nop 0
    buffer_load_dwordx4 v245, s[16:19], s75 offen sc1 lds
    s_add_u32 m0, s77, 126976
    s_nop 0
    buffer_load_dwordx4 v246, s[16:19], s75 offen sc1 lds
    s_add_u32 m0, s77, 131072
    s_nop 0
    buffer_load_dwordx4 v247, s[16:19], s75 offen sc1 lds
    s_add_u32 m0, s70, 135168
    s_mov_b64 exec, s[68:69]
    buffer_load_dwordx4 v249, s[16:19], s75 offen sc1 lds
    s_mov_b64 exec, -1
    s_branch L12_P3B_join2
L12_P3B_aready:
    s_mov_b64 exec, -1
    s_mov_b32 s75, 0
    s_add_u32 m0, s77, 110592
    s_nop 0
    buffer_load_dwordx4 v242, s[16:19], s75 offen sc1 lds
    s_add_u32 m0, s77, 114688
    s_nop 0
    buffer_load_dwordx4 v243, s[16:19], s75 offen sc1 lds
    s_add_u32 m0, s77, 118784
    s_nop 0
    buffer_load_dwordx4 v244, s[16:19], s75 offen sc1 lds
    s_add_u32 m0, s77, 122880
    s_nop 0
    buffer_load_dwordx4 v245, s[16:19], s75 offen sc1 lds
    s_add_u32 m0, s77, 126976
    s_nop 0
    buffer_load_dwordx4 v246, s[16:19], s75 offen sc1 lds
    s_add_u32 m0, s77, 131072
    s_nop 0
    buffer_load_dwordx4 v247, s[16:19], s75 offen sc1 lds
    s_add_u32 m0, s70, 135168
    s_mov_b64 exec, s[68:69]
    buffer_load_dwordx4 v249, s[16:19], s75 offen sc1 lds
    s_mov_b64 exec, -1
    s_waitcnt vmcnt(7)
    s_barrier
L12_P3B_join2:
    s_mov_b32 s75, 589824
    s_add_u32 m0, s77, 0
    s_nop 0
    buffer_load_dwordx4 v242, s[16:19], s75 offen sc1 lds
    s_add_u32 m0, s77, 4096
    s_nop 0
    buffer_load_dwordx4 v243, s[16:19], s75 offen sc1 lds
    s_add_u32 m0, s77, 8192
    s_nop 0
    buffer_load_dwordx4 v244, s[16:19], s75 offen sc1 lds
    s_add_u32 m0, s77, 12288
    s_nop 0
    buffer_load_dwordx4 v245, s[16:19], s75 offen sc1 lds
    s_add_u32 m0, s77, 16384
    s_nop 0
    buffer_load_dwordx4 v246, s[16:19], s75 offen sc1 lds
    s_add_u32 m0, s77, 20480
    s_nop 0
    buffer_load_dwordx4 v247, s[16:19], s75 offen sc1 lds
    s_add_u32 m0, s70, 24576
    s_mov_b64 exec, s[68:69]
    buffer_load_dwordx4 v249, s[16:19], s75 offen sc1 lds
    s_mov_b64 exec, -1
    s_waitcnt vmcnt(7)
    s_barrier
    s_mov_b32 s75, 1179648
    s_add_u32 m0, s77, 27648
    s_nop 0
    buffer_load_dwordx4 v242, s[16:19], s75 offen sc1 lds
    s_add_u32 m0, s77, 31744
    s_nop 0
    buffer_load_dwordx4 v243, s[16:19], s75 offen sc1 lds
    s_add_u32 m0, s77, 35840
    s_nop 0
    buffer_load_dwordx4 v244, s[16:19], s75 offen sc1 lds
    s_add_u32 m0, s77, 39936
    s_nop 0
    buffer_load_dwordx4 v245, s[16:19], s75 offen sc1 lds
    s_add_u32 m0, s77, 44032
    s_nop 0
    buffer_load_dwordx4 v246, s[16:19], s75 offen sc1 lds
    s_add_u32 m0, s77, 48128
    s_nop 0
    buffer_load_dwordx4 v247, s[16:19], s75 offen sc1 lds
    s_add_u32 m0, s70, 52224
    s_mov_b64 exec, s[68:69]
    buffer_load_dwordx4 v249, s[16:19], s75 offen sc1 lds
    s_mov_b64 exec, -1
    s_waitcnt vmcnt(7)
    s_barrier
    s_mov_b32 s75, 1769472
    s_add_u32 m0, s77, 55296
    s_nop 0
    buffer_load_dwordx4 v242, s[16:19], s75 offen sc1 lds
    s_add_u32 m0, s77, 59392
    s_nop 0
    buffer_load_dwordx4 v243, s[16:19], s75 offen sc1 lds
    s_add_u32 m0, s77, 63488
    s_nop 0
    buffer_load_dwordx4 v244, s[16:19], s75 offen sc1 lds
    s_add_u32 m0, s77, 67584
    s_nop 0
    buffer_load_dwordx4 v245, s[16:19], s75 offen sc1 lds
    s_add_u32 m0, s77, 71680
    s_nop 0
    buffer_load_dwordx4 v246, s[16:19], s75 offen sc1 lds
    s_add_u32 m0, s77, 75776
    s_nop 0
    buffer_load_dwordx4 v247, s[16:19], s75 offen sc1 lds
    s_add_u32 m0, s70, 79872
    s_mov_b64 exec, s[68:69]
    buffer_load_dwordx4 v249, s[16:19], s75 offen sc1 lds
    s_mov_b64 exec, -1
    s_waitcnt vmcnt(7)
    s_barrier
    s_waitcnt vmcnt(0)
    s_barrier
    s_mov_b32 s20, s54
    s_mov_b32 s21, s55
    s_mov_b32 s22, 2359296
    s_mov_b32 s23, 0x20000
    s_lshl_b32 s30, s28, 3
    v_lshrrev_b32 v2, 3, v255
    v_add_u32 v2, s30, v2
    v_and_b32 v3, 7, v255
    v_lshlrev_b32 v3, 4, v3
    v_mul_u32_u24 v251, 144, v2
    s_mov_b32 s30, 24576
    v_add3_u32 v251, v251, v3, s30
    v_add_u32 v2, s84, v2
    v_mul_u32_u24 v2, 1152, v2
    s_lshl_b32 s30, s85, 7
    v_add3_u32 v252, v2, v3, s30
    s_mov_b32 s73, 73728
    s_lshl_b32 s72, s26, 2
    s_barrier
    s_barrier
L12_P3_store:
    ds_read_b128 v[8:11], v251
    ds_read_b128 v[12:15], v251 offset:9216
    s_waitcnt lgkmcnt(1)
    buffer_store_dwordx4 v[8:11], v252, s[20:23], 0 offen sc1 nt
    s_cmp_ge_u32 s28, s72
    s_cbranch_scc1 L12_P3_fin
    s_waitcnt lgkmcnt(0)
    buffer_store_dwordx4 v[12:15], v252, s[20:23], s73 offen sc1 nt
L12_P3_fin:
L12_end:
    s_endpgm
L12_last:

.section .rodata,"a"
.p2align 6
.amdhsa_kernel gated_mix__sliding_block__linear_kernel_hedgehog__prompt_kernel
  .amdhsa_next_free_vgpr 256
  .amdhsa_next_free_sgpr 102
  .amdhsa_accum_offset 256
  .amdhsa_group_segment_fixed_size 0
  .amdhsa_kernarg_size 88
  .amdhsa_user_sgpr_count 2
  .amdhsa_user_sgpr_kernarg_segment_ptr 1
  .amdhsa_system_sgpr_workgroup_id_x 1
.end_amdhsa_kernel
```
